```python
import torch

def _softmax(x, axis=-1):
    return torch.softmax(x, dim=axis)

def _gelu(x):
    return torch.nn.functional.gelu(x, approximate='tanh')

def _silu(x):
    return torch.nn.functional.silu(x)

def _sigmoid(x):
    return torch.sigmoid(x)

def _layernorm(x, axis=-1, eps=1e-05):
    m = x.mean(dim=axis, keepdim=True)
    v = x.var(dim=axis, keepdim=True, unbiased=False)
    return (x - m) / torch.sqrt(v + eps)

def _scatter_add(tgt, idx, src, axis=0):
    return tgt.clone().index_add_(axis, idx, src)

def _segment_sum(src, seg, n):
    out = torch.zeros((n,) + src.shape[1:], dtype=src.dtype)
    return out.index_add_(0, seg, src)

def _pad(x, pw):
    flat = tuple((v for pair in reversed(pw) for v in pair))
    return torch.nn.functional.pad(x, flat)
kernel_name = 'adaLN_cond__ssm_conv_h3__glu_gated_glu__prompt'

def setup_inputs():

    _w = lambda a: (lambda t: t.to(torch.bfloat16) if t.is_floating_point() else t)(torch.as_tensor(a))

    def _A_setup():
        B, S, D = (1, 2048, 576)
        ks = 4
        return {'q': _w((lambda *s: torch.randn(*s, dtype=torch.bfloat16) * 0.05)(B, S, D)), 'k': _w((lambda *s: torch.randn(*s, dtype=torch.bfloat16) * 0.8)(B, S, D)), 'v': _w((lambda *s: torch.randn(*s, dtype=torch.bfloat16) * 0.8)(B, S, D)), 'shift_k': _w((lambda *s: torch.randn(*s, dtype=torch.bfloat16) * 0.8)(D, ks) * 0.5), 'ssm_k': _w((lambda *s: torch.randn(*s, dtype=torch.bfloat16) * 0.8)(D, S) * (1.0 / S ** 0.5)), 'ssm_D': _w((lambda *s: torch.randn(*s, dtype=torch.bfloat16) * 0.8)(D))}
    _A_in = _A_setup()

    def _B_setup():
        B, S, D, F = (1, 2048, 576, 4608)
        return {'x': _w((lambda *s: torch.randn(*s, dtype=torch.bfloat16) * 0.05)(B, S, D)), 'w_gate': _w((lambda *s: torch.randn(*s, dtype=torch.bfloat16) * 0.05)(D, F)), 'w_up': _w((lambda *s: torch.randn(*s, dtype=torch.bfloat16) * 0.05)(D, F)), 'w_down': _w((lambda *s: torch.randn(*s, dtype=torch.bfloat16) * 0.05)(F, D))}
    _B_in = _B_setup()
    return {'A_q': _A_in['q'], 'A_k': _A_in['k'], 'A_v': _A_in['v'], 'A_shift_k': _A_in['shift_k'], 'A_ssm_k': _A_in['ssm_k'], 'A_ssm_D': _A_in['ssm_D'], 'B_x': _B_in['x'], 'B_w_gate': _B_in['w_gate'], 'B_w_up': _B_in['w_up'], 'B_w_down': _B_in['w_down'], 'c': _w((lambda *s: torch.randn(*s, dtype=torch.bfloat16) * 0.1)(1, 576) * 8.0), 'w_mod': _w((lambda *s: torch.randn(*s, dtype=torch.bfloat16) * 0.1)(576, 6 * 576) * 576 ** (-0.5) * 8.0)}

def reference(A_q, A_k, A_v, A_shift_k, A_ssm_k, A_ssm_D, B_x, B_w_gate, B_w_up, B_w_down, c, w_mod):

    def _A_ref(q, k, v, shift_k, ssm_k, ssm_D):
        B, S, D = q.shape
        ks = shift_k.shape[-1]
        k_pad = _pad(k, ((0, 0), (ks - 1, 0), (0, 0)))
        k_shift = torch.zeros_like(k)
        for t in range(ks):
            k_shift = k_shift + k_pad[:, t:t + S, :] * shift_k[:, ks - 1 - t][None, None, :]
        kv = k_shift * v
        L = 2 * S
        kv_pad = _pad(kv, ((0, 0), (0, S), (0, 0)))
        kf_pad = _pad(ssm_k, ((0, 0), (0, S)))
        kv_f = (lambda x, axes=(-2, -1): torch.fft.rfft2(x.float(), dim=axes))(kv_pad[:, None, :, :], axes=(1, 2))
        kf_f = (lambda x, axes=(-2, -1): torch.fft.rfft2(x.float(), dim=axes))(kf_pad[:, None, :], axes=(1, 2))
        kf_f = (lambda x, *d: x.permute(*d))(kf_f, 1, 2, 0)
        y_f = kv_f * kf_f[None, :, :, :]
        y = (lambda x, s, axes=(-2, -1): torch.fft.irfft2(x, s=s, dim=axes).to(torch.bfloat16))(y_f, (1, L), axes=(1, 2))[:, 0, :S, :]
        y = y + kv * ssm_D[None, None, :]
        return q * y

    def _B_ref(x, w_gate, w_up, w_down):
        g = torch.einsum('bsd,df->bsf', x, w_gate)
        u = torch.einsum('bsd,df->bsf', x, w_up)
        h = _sigmoid(g) * u
        return torch.einsum('bsf,fd->bsd', h, w_down)
    x = A_q
    mod = (_silu(c) @ w_mod).reshape(c.shape[0], 6, 1, -1)
    sa, ca, ga, sb, cb, gb = (mod[:, 0].clone(), mod[:, 1].clone(), mod[:, 2].clone(), mod[:, 3].clone(), mod[:, 4].clone(), mod[:, 5].clone())
    h = _layernorm(x, axis=-1) * (1 + ca) + sa
    x = x + ga * _A_ref(h, A_k, A_v, A_shift_k, A_ssm_k, A_ssm_D)
    h = _layernorm(x, axis=-1) * (1 + cb) + sb
    x = x + gb * _B_ref(h, B_w_gate, B_w_up, B_w_down)
    return x
```

```asm
; @launch kernel=conv_kernel grid=(256,1,1) block=(512,1,1) lds=107520
; @launch kernel=mlp_kernel grid=(256,1,1) block=(256,1,1) lds=163840
.amdgcn_target "amdgcn-amd-amdhsa--gfx950"
.text
    .globl conv_kernel
    .p2align 12
    .type conv_kernel,@function
conv_kernel:
    s_cmp_ge_u32 s2, 256
    s_cbranch_scc1 K1_END
    s_load_dwordx8 s[4:11], s[0:1], 8
    s_load_dwordx2 s[12:13], s[0:1], 40
    s_load_dwordx2 s[14:15], s[0:1], 112
    s_load_dwordx4 s[16:19], s[0:1], 56
    s_load_dwordx2 s[20:21], s[0:1], 72
    s_load_dwordx2 s[22:23], s[0:1], 0
    s_load_dwordx4 s[24:27], s[0:1], 80
    s_getpc_b64 s[76:77]
    s_mov_b32 s78, CODE_PF_BEGIN-conv_kernel
    s_mov_b32 s79, 0x20000
    v_lshlrev_b32 v3, 1, v0
    s_lshr_b32 s3, s2, 3
    s_lshl_b32 s3, s3, 10
    buffer_load_ushort a0, v3, s[76:79], s3 offen
    v_lshrrev_b32 v1, 6, v0
    v_and_b32 v2, 63, v0
    v_readfirstlane_b32 s28, v1
    v_lshrrev_b32 v3, 3, v0
    v_mul_u32_u24 v3, 1152, v3
    v_and_b32 v4, 7, v0
    v_lshl_add_u32 v3, v4, 4, v3
    s_and_b32 s29, s2, 7
    s_lshr_b32 s30, s2, 3
    s_cmp_ge_u32 s2, 144
    s_cbranch_scc1 K1_OTHER
    s_lshl_b32 s31, s29, 4
    s_add_u32 s31, s31, s30
    s_sub_u32 s40, s30, 16
    s_lshl_b32 s40, s40, 3
    s_add_u32 s40, s40, s29
    s_add_u32 s40, s40, 128
    s_cmp_lt_u32 s30, 16
    s_cselect_b32 s31, s31, s40
    s_lshl_b32 s41, s31, 3
    s_and_b32 s42, s31, 15
    s_mul_i32 s42, s42, 73728
    s_lshr_b32 s43, s31, 4
    s_lshl_b32 s43, s43, 7
    s_add_u32 s42, s42, s43
    s_add_u32 s43, s42, 1179648
    s_waitcnt lgkmcnt(0)
    s_mov_b32 s32, s4
    s_mov_b32 s33, s5
    s_mov_b32 s34, 2359296
    s_mov_b32 s35, 0x20000
    s_mov_b32 s36, s6
    s_mov_b32 s37, s7
    s_mov_b32 s38, 2359296
    s_mov_b32 s39, 0x20000
    s_cmp_ge_u32 s28, 4
    s_cbranch_scc1 K1_LOADER
    s_lshl_b32 s44, s31, 2
    s_add_u32 s44, s44, s28
    s_lshl_b32 s45, s44, 12
    s_add_u32 s48, s10, s45
    s_addc_u32 s49, s11, 0
    s_mov_b32 s50, 4096
    s_mov_b32 s51, 0x20000
    v_mul_u32_u24 v120, 1152, v2
    s_and_b32 s63, s28, 1
    s_cmp_eq_u32 s63, 0
    s_cselect_b32 s68, s32, s36
    s_cselect_b32 s69, s33, s37
    s_mov_b32 s70, 2359296
    s_mov_b32 s71, 0x20000
    s_cmp_ge_u32 s28, 2
    s_cbranch_scc1 K1_NOW1
    buffer_load_dword a1, v120, s[68:71], s42 offen
K1_NOW1:
    v_lshlrev_b32 v3, 4, v2
    buffer_load_dwordx4 v[16:19], v3, s[48:51], 0 offen offset:0
    buffer_load_dwordx4 v[32:35], v3, s[48:51], 0 offen offset:4
    buffer_load_dwordx4 v[48:51], v3, s[48:51], 0 offen offset:8
    buffer_load_dwordx4 v[20:23], v3, s[48:51], 0 offen offset:1024
    buffer_load_dwordx4 v[36:39], v3, s[48:51], 0 offen offset:1028
    buffer_load_dwordx4 v[52:55], v3, s[48:51], 0 offen offset:1032
    buffer_load_dwordx4 v[24:27], v3, s[48:51], 0 offen offset:2048
    buffer_load_dwordx4 v[40:43], v3, s[48:51], 0 offen offset:2052
    buffer_load_dwordx4 v[56:59], v3, s[48:51], 0 offen offset:2056
    buffer_load_dwordx4 v[28:31], v3, s[48:51], 0 offen offset:3072
    buffer_load_dwordx4 v[44:47], v3, s[48:51], 0 offen offset:3076
    buffer_load_dwordx4 v[60:63], v3, s[48:51], 0 offen offset:3080
    s_barrier
    s_lshl_b32 s45, s44, 1
    s_and_b32 s46, s45, 0xfffffffc
    s_add_u32 s52, s12, s46
    s_addc_u32 s53, s13, 0
    s_load_dword s54, s[52:53], 0
    s_branch K1_MFMA_B
K1_LOADER:
    s_setprio 3
    s_sub_u32 s44, s28, 4
    s_mul_i32 s48, s44, 147456
    s_add_u32 s48, s48, s41
    v_mul_u32_u24 v3, 2304, v2
    v_add_u32 v3, s48, v3
    s_add_u32 s50, s48, 4294963840
    v_mov_b32 v4, s50
    s_mov_b32 s76, 0
    s_add_u32 s50, s48, 586368
    v_mov_b32 v5, s50
    s_mov_b32 s77, 589824
    s_add_u32 s50, s48, 1176192
    v_mov_b32 v6, s50
    s_mov_b32 s78, 1179648
    s_add_u32 s50, s48, 1766016
    v_mov_b32 v7, s50
    s_mov_b32 s79, 1769472
    s_barrier
    buffer_load_dwordx2 v[16:17], v3, s[32:35], s76 offen
    buffer_load_dwordx2 v[28:29], v4, s[32:35], 0 offen
    buffer_load_dwordx2 v[24:25], v4, s[32:35], 0 offen offset:1152
    buffer_load_dwordx2 v[26:27], v4, s[32:35], 0 offen offset:2304
    buffer_load_dwordx2 v[18:19], v3, s[32:35], s76 offen offset:1152
    buffer_load_dwordx2 v[20:21], v3, s[36:39], s76 offen
    buffer_load_dwordx2 v[22:23], v3, s[36:39], s76 offen offset:1152
    s_lshl_b32 s45, s31, 5
    s_add_u32 s46, s8, s45
    s_addc_u32 s47, s9, 0
    s_load_dwordx8 s[52:59], s[46:47], 0
    s_branch K1_LOADER_B
K1_OTHER:
    s_sub_u32 s31, s30, 18
    s_waitcnt lgkmcnt(0)
    s_mov_b32 s32, s4
    s_mov_b32 s33, s5
    s_mov_b32 s34, 2359296
    s_mov_b32 s35, 0x20000
    s_mov_b32 s36, s6
    s_mov_b32 s37, s7
    s_mov_b32 s38, 2359296
    s_mov_b32 s39, 0x20000
    s_mul_i32 s44, s31, 74
    v_add_u32 v120, s44, v0
    v_cmp_gt_u32 vcc, 74, v0
    v_mul_u32_u24 v120, 1152, v120
    v_mov_b32 v121, 0x7fffff00
    s_mov_b32 s44, 1024
    v_cndmask_b32 v120, v121, v120, vcc
    s_mov_b32 s72, s32
    s_mov_b32 s73, s33
    s_mov_b32 s74, s34
    s_mov_b32 s75, 0x20000
    s_mov_b32 s76, s36
    s_mov_b32 s77, s37
    s_mov_b32 s78, s38
    s_mov_b32 s79, 0x20000
    buffer_load_dword a8, v120, s[72:75], s44 offen
    buffer_load_dword a9, v120, s[76:79], s44 offen
    s_mov_b32 s32, s26
    s_mov_b32 s33, s27
    s_mov_b32 s34, 3981312
    s_mov_b32 s35, 0x20000
    s_mov_b32 s36, s24
    s_mov_b32 s37, s25
    s_mov_b32 s38, 1152
    s_mov_b32 s39, 0x20000
    s_mov_b32 s40, s14
    s_mov_b32 s41, s15
    s_mov_b32 s42, 6912
    s_mov_b32 s43, 0x20000
    s_mov_b32 s44, s22
    s_mov_b32 s45, s23
    s_mov_b32 s46, 2359296
    s_mov_b32 s47, 0x20000
    s_add_u32 s48, s14, 7143424
    s_addc_u32 s49, s15, 0
    s_mov_b32 s50, 2359296
    s_mov_b32 s51, 0x20000
    s_sub_u32 s69, s2, 144
    s_lshl_b32 s69, s69, 7
    v_lshrrev_b32 v3, 3, v0
    v_mul_u32_u24 v5, 6912, v3
    v_lshl_add_u32 v5, v4, 4, v5
    v_lshlrev_b32 v6, 1, v3
    s_mul_i32 s56, s28, 7
    s_add_u32 s56, s56, s31
    s_sub_u32 s56, s56, 7
    s_cmp_lt_u32 s56, 32
    s_cselect_b32 s71, 1, 0
    s_cmp_ge_u32 s31, 7
    s_cselect_b32 s71, s71, 0
    s_and_b32 s57, s56, 1
    s_lshr_b32 s56, s56, 1
    s_lshl_b32 s56, s56, 3
    s_add_u32 s56, s56, s29
    s_lshl_b32 s56, s56, 1
    s_add_u32 s56, s56, s57
    s_mul_i32 s56, s56, 9216
    v_lshrrev_b32 v10, 3, v2
    v_mul_u32_u24 v10, 1152, v10
    v_and_b32 v11, 7, v2
    v_lshl_add_u32 v10, v11, 4, v10
    s_cmp_ge_u32 s2, 198
    s_cbranch_scc1 K1_H0
    s_waitcnt vmcnt(0)
    s_barrier
    buffer_load_ushort v52, v6, s[36:39], 0 offen offset:0
    buffer_load_ushort v53, v6, s[36:39], 0 offen offset:128
    buffer_load_ushort v54, v6, s[36:39], 0 offen offset:256
    buffer_load_ushort v55, v6, s[36:39], 0 offen offset:384
    buffer_load_ushort v56, v6, s[36:39], 0 offen offset:512
    buffer_load_ushort v57, v6, s[36:39], 0 offen offset:640
    buffer_load_ushort v58, v6, s[36:39], 0 offen offset:768
    buffer_load_ushort v59, v6, s[36:39], 0 offen offset:896
    buffer_load_ushort v60, v6, s[36:39], 0 offen offset:1024
    s_add_u32 s68, s69, 0
    buffer_load_dwordx4 v[16:19], v5, s[32:35], s68 offen
    s_add_u32 s68, s69, 442368
    buffer_load_dwordx4 v[20:23], v5, s[32:35], s68 offen
    s_add_u32 s68, s69, 884736
    buffer_load_dwordx4 v[24:27], v5, s[32:35], s68 offen
    s_add_u32 s68, s69, 1327104
    buffer_load_dwordx4 v[28:31], v5, s[32:35], s68 offen
    s_add_u32 s68, s69, 1769472
    buffer_load_dwordx4 v[32:35], v5, s[32:35], s68 offen
    s_add_u32 s68, s69, 2211840
    buffer_load_dwordx4 v[36:39], v5, s[32:35], s68 offen
    s_add_u32 s68, s69, 2654208
    buffer_load_dwordx4 v[40:43], v5, s[32:35], s68 offen
    s_add_u32 s68, s69, 3096576
    buffer_load_dwordx4 v[44:47], v5, s[32:35], s68 offen
    s_add_u32 s68, s69, 3538944
    buffer_load_dwordx4 v[48:51], v5, s[32:35], s68 offen
K1_H0:
    s_getpc_b64 s[52:53]
K1_PC:
    s_add_u32 s52, s52, CODE_PF_BEGIN-K1_PC
    s_addc_u32 s53, s53, 0
    s_mov_b32 s54, CODE_PF_END-CODE_PF_BEGIN
    s_mov_b32 s55, 0x20000
    s_lshl_b32 s57, s31, 12
    v_lshlrev_b32 v8, 3, v0
    s_mov_b32 s60, s16
    s_mov_b32 s61, s17
    s_mov_b32 s62, 5308416
    s_mov_b32 s63, 0x20000
    s_mov_b32 s64, s18
    s_mov_b32 s65, s19
    s_mov_b32 s66, 5308416
    s_mov_b32 s67, 0x20000
    s_mul_i32 s58, s31, 240
    s_mul_i32 s59, s31, 90
    s_add_u32 s59, s59, 1050
    s_cmp_lt_u32 s31, 7
    s_cselect_b32 s58, s58, s59
    s_mov_b32 s59, 90
    s_cselect_b32 s59, 240, s59
    v_cmp_gt_u32 vcc, s59, v0
    v_add_u32 v12, s58, v0
    v_lshrrev_b32 v13, 2, v12
    v_mul_u32_u24 v15, 9216, v13
    v_and_b32 v13, 1, v12
    v_lshl_add_u32 v15, v13, 7, v15
    v_bfe_u32 v13, v12, 1, 1
    v_mul_u32_u24 v13, 640, v13
    v_add_u32 v15, v15, v13
    v_mov_b32 v14, 0x7fffff00
    v_cndmask_b32 v15, v14, v15, vcc
    s_mul_i32 s59, s29, 1152
    s_cmp_lt_u32 s31, 7
    s_cbranch_scc1 K1_H1
    s_sub_u32 s68, s31, 7
    s_mul_i32 s68, s68, 147
    s_add_u32 s68, s68, 1024
    v_add_u32 v120, s68, v0
    v_cmp_gt_u32 vcc, 147, v0
    v_mul_u32_u24 v120, 1152, v120
    s_lshl_b32 s68, s29, 7
    s_mov_b32 s70, 1024
    v_cndmask_b32 v120, v121, v120, vcc
    buffer_load_dword a8, v120, s[72:75], s68 offen
    buffer_load_dword a9, v120, s[76:79], s68 offen
    buffer_load_dword a10, v120, s[72:75], s70 offen
    buffer_load_dword a11, v120, s[76:79], s70 offen
K1_H1:
    s_cmp_eq_u32 s71, 0
    s_cbranch_scc1 K1_H2
    buffer_load_dwordx4 v[16:19], v10, s[44:47], s56 offen offset:0
    buffer_load_dwordx4 v[20:23], v10, s[44:47], s56 offen offset:128
    buffer_load_dwordx4 v[24:27], v10, s[44:47], s56 offen offset:256
    buffer_load_dwordx4 v[28:31], v10, s[44:47], s56 offen offset:384
    buffer_load_dwordx4 v[32:35], v10, s[44:47], s56 offen offset:512
    buffer_load_dwordx4 v[36:39], v10, s[44:47], s56 offen offset:640
    buffer_load_dwordx4 v[40:43], v10, s[44:47], s56 offen offset:768
    buffer_load_dwordx4 v[44:47], v10, s[44:47], s56 offen offset:896
    buffer_load_dwordx4 v[48:51], v10, s[44:47], s56 offen offset:1024
K1_H2:
    s_branch K1_OTHER_B
K1_MFMA_B:
    s_mul_i32 s60, s28, 17664
    s_mul_i32 s61, s28, 4608
    s_add_u32 s61, s61, 70656
    v_add_u32 v4, s60, v3
    v_mov_b32 v8, 0
    v_mov_b32 v9, 0
    v_mov_b32 v10, 0
    v_mov_b32 v11, 0
    v_lshlrev_b32 v5, 3, v2
    v_add_u32 v5, s61, v5
    ds_write_b64 v5, v[8:9] offset:4096
    v_and_b32 v12, 15, v2
    v_lshrrev_b32 v13, 4, v2
    v_lshlrev_b32 v14, 3, v13
    v_sub_u32 v6, v12, v14
    v_add_u32 v6, 25, v6
    v_and_b32 v7, 3, v6
    v_sub_u32 v6, v6, v7
    v_lshlrev_b32 v6, 1, v6
    v_mul_u32_u24 v7, 4416, v7
    v_add3_u32 v6, v6, v7, s60
    v_lshlrev_b32 v7, 5, v12
    v_lshl_add_u32 v7, v13, 4, v7
    s_add_u32 s62, s61, 528
    v_sub_u32 v7, s62, v7
    v_mul_u32_u24 v1, 144, v12
    v_lshl_add_u32 v1, v13, 3, v1
    s_lshl_b32 s62, s28, 5
    s_add_u32 s62, s62, 89088
    v_add_u32 v1, s62, v1
    s_waitcnt lgkmcnt(0)
    s_and_b32 s45, s44, 1
    s_lshl_b32 s45, s45, 4
    s_lshr_b32 s54, s54, s45
    s_and_b32 s54, s54, 0xffff
    v_sub_u32 v112, v14, v12
    v_subrev_u32 v112, 9, v112
    v_and_b32 v113, 1, v112
    v_lshlrev_b32 v113, 4, v113
    v_lshlrev_b32 v113, v113, s54
    v_ashrrev_i32 v112, 1, v112
    v_cmp_eq_u32 vcc, 0, v112
    s_nop 1
    v_cndmask_b32 v116, 0, v113, vcc
    v_cmp_eq_u32 vcc, 1, v112
    s_nop 1
    v_cndmask_b32 v117, 0, v113, vcc
    v_cmp_eq_u32 vcc, 2, v112
    s_nop 1
    v_cndmask_b32 v118, 0, v113, vcc
    v_cmp_eq_u32 vcc, 3, v112
    s_nop 1
    v_cndmask_b32 v119, 0, v113, vcc
    s_waitcnt vmcnt(9)
    v_alignbit_b32 v64, v32, v16, 16
    v_alignbit_b32 v65, v33, v17, 16
    v_alignbit_b32 v66, v34, v18, 16
    v_alignbit_b32 v67, v35, v19, 16
    v_alignbit_b32 v68, v48, v32, 16
    v_alignbit_b32 v69, v49, v33, 16
    v_alignbit_b32 v70, v50, v34, 16
    v_alignbit_b32 v71, v51, v35, 16
    ds_write_b128 v4, v[16:19] offset:32
    ds_write_b128 v4, v[64:67] offset:4448
    ds_write_b128 v4, v[32:35] offset:8864
    ds_write_b128 v4, v[68:71] offset:13280
    s_waitcnt vmcnt(6)
    v_alignbit_b32 v72, v36, v20, 16
    v_alignbit_b32 v73, v37, v21, 16
    v_alignbit_b32 v74, v38, v22, 16
    v_alignbit_b32 v75, v39, v23, 16
    v_alignbit_b32 v76, v52, v36, 16
    v_alignbit_b32 v77, v53, v37, 16
    v_alignbit_b32 v78, v54, v38, 16
    v_alignbit_b32 v79, v55, v39, 16
    ds_write_b128 v4, v[20:23] offset:1056
    ds_write_b128 v4, v[72:75] offset:5472
    ds_write_b128 v4, v[36:39] offset:9888
    ds_write_b128 v4, v[76:79] offset:14304
    s_waitcnt vmcnt(3)
    v_alignbit_b32 v80, v40, v24, 16
    v_alignbit_b32 v81, v41, v25, 16
    v_alignbit_b32 v82, v42, v26, 16
    v_alignbit_b32 v83, v43, v27, 16
    v_alignbit_b32 v84, v56, v40, 16
    v_alignbit_b32 v85, v57, v41, 16
    v_alignbit_b32 v86, v58, v42, 16
    v_alignbit_b32 v87, v59, v43, 16
    ds_write_b128 v4, v[24:27] offset:2080
    ds_write_b128 v4, v[80:83] offset:6496
    ds_write_b128 v4, v[40:43] offset:10912
    ds_write_b128 v4, v[84:87] offset:15328
    s_waitcnt vmcnt(0)
    v_alignbit_b32 v88, v44, v28, 16
    v_alignbit_b32 v89, v45, v29, 16
    v_alignbit_b32 v90, v46, v30, 16
    v_alignbit_b32 v91, v47, v31, 16
    v_alignbit_b32 v92, v60, v44, 16
    v_alignbit_b32 v93, v61, v45, 16
    v_alignbit_b32 v94, v62, v46, 16
    v_alignbit_b32 v95, v63, v47, 16
    ds_write_b128 v4, v[28:31] offset:3104
    ds_write_b128 v4, v[88:91] offset:7520
    ds_write_b128 v4, v[44:47] offset:11936
    ds_write_b128 v4, v[92:95] offset:16352
    v_lshlrev_b32 v99, 16, v16
    v_mov_b32 v96, 0
    v_mov_b32 v97, 0
    v_mov_b32 v98, 0
    v_mov_b32 v100, 0
    v_mov_b32 v101, 0
    v_mov_b32 v102, 0
    v_mov_b32 v103, v16
    v_mov_b32 v104, 0
    v_mov_b32 v105, 0
    v_mov_b32 v106, v99
    v_alignbit_b32 v107, v17, v16, 16
    s_mov_b64 s[64:65], exec
    s_mov_b64 exec, 1
    ds_write_b128 v4, v[8:11] offset:0
    ds_write_b128 v4, v[8:11] offset:4416
    ds_write_b128 v4, v[8:11] offset:8832
    ds_write_b128 v4, v[8:11] offset:13248
    ds_write_b128 v4, v[8:11] offset:16
    ds_write_b128 v4, v[96:99] offset:4432
    ds_write_b128 v4, v[100:103] offset:8848
    ds_write_b128 v4, v[104:107] offset:13264
    s_mov_b64 exec, s[64:65]
    s_waitcnt lgkmcnt(0)
    ds_read_b64 a[0:1], v6 offset:0
    ds_read_b64 a[2:3], v6 offset:8
    ds_read_b64 a[4:5], v6 offset:64
    ds_read_b64 a[6:7], v6 offset:72
    ds_read_b64 a[8:9], v6 offset:128
    ds_read_b64 a[10:11], v6 offset:136
    ds_read_b64 a[12:13], v6 offset:192
    ds_read_b64 a[14:15], v6 offset:200
    ds_read_b64 a[16:17], v6 offset:256
    ds_read_b64 a[18:19], v6 offset:264
    ds_read_b64 a[20:21], v6 offset:320
    ds_read_b64 a[22:23], v6 offset:328
    s_waitcnt lgkmcnt(4)
    ds_read_b64 a[24:25], v6 offset:384
    ds_read_b64 a[26:27], v6 offset:392
    ds_read_b64 a[28:29], v6 offset:448
    ds_read_b64 a[30:31], v6 offset:456
    ds_read_b64 a[32:33], v6 offset:512
    ds_read_b64 a[34:35], v6 offset:520
    ds_read_b64 a[36:37], v6 offset:576
    ds_read_b64 a[38:39], v6 offset:584
    ds_read_b64 a[40:41], v6 offset:640
    ds_read_b64 a[42:43], v6 offset:648
    ds_read_b64 a[44:45], v6 offset:704
    ds_read_b64 a[46:47], v6 offset:712
    s_waitcnt lgkmcnt(4)
    ds_read_b64 a[48:49], v6 offset:768
    ds_read_b64 a[50:51], v6 offset:776
    ds_read_b64 a[52:53], v6 offset:832
    ds_read_b64 a[54:55], v6 offset:840
    ds_read_b64 a[56:57], v6 offset:896
    ds_read_b64 a[58:59], v6 offset:904
    ds_read_b64 a[60:61], v6 offset:960
    ds_read_b64 a[62:63], v6 offset:968
    ds_read_b64 a[64:65], v6 offset:1024
    ds_read_b64 a[66:67], v6 offset:1032
    ds_read_b64 a[68:69], v6 offset:1088
    ds_read_b64 a[70:71], v6 offset:1096
    s_waitcnt lgkmcnt(4)
    ds_read_b64 a[72:73], v6 offset:1152
    ds_read_b64 a[74:75], v6 offset:1160
    ds_read_b64 a[76:77], v6 offset:1216
    ds_read_b64 a[78:79], v6 offset:1224
    ds_read_b64 a[80:81], v6 offset:1280
    ds_read_b64 a[82:83], v6 offset:1288
    ds_read_b64 a[84:85], v6 offset:1344
    ds_read_b64 a[86:87], v6 offset:1352
    ds_read_b64 a[88:89], v6 offset:1408
    ds_read_b64 a[90:91], v6 offset:1416
    ds_read_b64 a[92:93], v6 offset:1472
    ds_read_b64 a[94:95], v6 offset:1480
    s_waitcnt lgkmcnt(4)
    ds_read_b64 a[96:97], v6 offset:1536
    ds_read_b64 a[98:99], v6 offset:1544
    ds_read_b64 a[100:101], v6 offset:1600
    ds_read_b64 a[102:103], v6 offset:1608
    ds_read_b64 a[104:105], v6 offset:1664
    ds_read_b64 a[106:107], v6 offset:1672
    ds_read_b64 a[108:109], v6 offset:1728
    ds_read_b64 a[110:111], v6 offset:1736
    ds_read_b64 a[112:113], v6 offset:1792
    ds_read_b64 a[114:115], v6 offset:1800
    ds_read_b64 a[116:117], v6 offset:1856
    ds_read_b64 a[118:119], v6 offset:1864
    s_waitcnt lgkmcnt(4)
    ds_read_b64 a[120:121], v6 offset:1920
    ds_read_b64 a[122:123], v6 offset:1928
    ds_read_b64 a[124:125], v6 offset:1984
    ds_read_b64 a[126:127], v6 offset:1992
    s_mov_b32 s56, s14
    s_mov_b32 s57, s15
    s_mov_b32 s58, 24576
    s_mov_b32 s59, 0x20000
    v_cmp_eq_u32 vcc, 0, v0
    s_lshl_b32 s45, s2, 7
    s_add_u32 s45, s45, 16384
    v_mov_b32 v122, 0x7fffff00
    v_mov_b32 v123, 0
    v_cndmask_b32 v122, v122, v123, vcc
    buffer_store_dword v123, v122, s[56:59], s45 offen sc1
    ds_read_b64 v[48:49], v6 offset:2048
    ds_read_b64 v[50:51], v6 offset:2056
    ds_read_b64 v[52:53], v6 offset:2560
    ds_read_b64 v[54:55], v6 offset:2568
    ds_read_b64 v[56:57], v6 offset:3072
    ds_read_b64 v[58:59], v6 offset:3080
    ds_read_b64 v[60:61], v6 offset:3584
    ds_read_b64 v[62:63], v6 offset:3592
    s_barrier
    ds_read_b128 v[64:67], v7 offset:3584
    ds_read_b128 v[68:71], v7 offset:3072
    s_waitcnt lgkmcnt(0)
    v_mfma_f32_16x16x32_bf16 v[16:19], a[0:3], v[64:67], 0
    ds_read_b128 v[96:99], v7 offset:3648
    v_mfma_f32_16x16x32_bf16 v[20:23], a[0:3], v[68:71], 0
    ds_read_b128 v[100:103], v7 offset:3136
    v_mfma_f32_16x16x32_bf16 v[20:23], a[32:35], v[64:67], v[20:23]
    ds_read_b64 v[80:81], v6 offset:2112
    v_mfma_f32_16x16x32_bf16 v[24:27], a[32:35], v[68:71], 0
    ds_read_b64 v[82:83], v6 offset:2120
    v_mfma_f32_16x16x32_bf16 v[24:27], a[64:67], v[64:67], v[24:27]
    ds_read_b64 v[84:85], v6 offset:2624
    v_mfma_f32_16x16x32_bf16 v[28:31], a[64:67], v[68:71], 0
    ds_read_b64 v[86:87], v6 offset:2632
    v_mfma_f32_16x16x32_bf16 v[28:31], a[96:99], v[64:67], v[28:31]
    ds_read_b64 v[88:89], v6 offset:3136
    v_mfma_f32_16x16x32_bf16 v[32:35], a[96:99], v[68:71], 0
    ds_read_b64 v[90:91], v6 offset:3144
    v_mfma_f32_16x16x32_bf16 v[32:35], v[48:51], v[64:67], v[32:35]
    ds_read_b64 v[92:93], v6 offset:3648
    v_mfma_f32_16x16x32_bf16 v[36:39], v[48:51], v[68:71], 0
    ds_read_b64 v[94:95], v6 offset:3656
    v_mfma_f32_16x16x32_bf16 v[36:39], v[52:55], v[64:67], v[36:39]
    v_mfma_f32_16x16x32_bf16 v[40:43], v[52:55], v[68:71], 0
    v_mfma_f32_16x16x32_bf16 v[40:43], v[56:59], v[64:67], v[40:43]
    v_mfma_f32_16x16x32_bf16 v[44:47], v[56:59], v[68:71], 0
    v_mfma_f32_16x16x32_bf16 v[44:47], v[60:63], v[64:67], v[44:47]
    v_mfma_f32_16x16x32_bf16 v[16:19], v[116:119], v[64:67], v[16:19]
    v_mfma_f32_16x16x32_bf16 v[20:23], v[116:119], v[68:71], v[20:23]
    s_waitcnt lgkmcnt(0)
    v_mfma_f32_16x16x32_bf16 v[16:19], a[4:7], v[96:99], v[16:19]
    ds_read_b128 v[64:67], v7 offset:3712
    v_mfma_f32_16x16x32_bf16 v[20:23], a[4:7], v[100:103], v[20:23]
    ds_read_b128 v[68:71], v7 offset:3200
    v_mfma_f32_16x16x32_bf16 v[20:23], a[36:39], v[96:99], v[20:23]
    ds_read_b64 v[48:49], v6 offset:2176
    v_mfma_f32_16x16x32_bf16 v[24:27], a[36:39], v[100:103], v[24:27]
    ds_read_b64 v[50:51], v6 offset:2184
    v_mfma_f32_16x16x32_bf16 v[24:27], a[68:71], v[96:99], v[24:27]
    ds_read_b64 v[52:53], v6 offset:2688
    v_mfma_f32_16x16x32_bf16 v[28:31], a[68:71], v[100:103], v[28:31]
    ds_read_b64 v[54:55], v6 offset:2696
    v_mfma_f32_16x16x32_bf16 v[28:31], a[100:103], v[96:99], v[28:31]
    ds_read_b64 v[56:57], v6 offset:3200
    v_mfma_f32_16x16x32_bf16 v[32:35], a[100:103], v[100:103], v[32:35]
    ds_read_b64 v[58:59], v6 offset:3208
    v_mfma_f32_16x16x32_bf16 v[32:35], v[80:83], v[96:99], v[32:35]
    ds_read_b64 v[60:61], v6 offset:3712
    v_mfma_f32_16x16x32_bf16 v[36:39], v[80:83], v[100:103], v[36:39]
    ds_read_b64 v[62:63], v6 offset:3720
    v_mfma_f32_16x16x32_bf16 v[36:39], v[84:87], v[96:99], v[36:39]
    v_mfma_f32_16x16x32_bf16 v[40:43], v[84:87], v[100:103], v[40:43]
    v_mfma_f32_16x16x32_bf16 v[40:43], v[88:91], v[96:99], v[40:43]
    v_mfma_f32_16x16x32_bf16 v[44:47], v[88:91], v[100:103], v[44:47]
    v_mfma_f32_16x16x32_bf16 v[44:47], v[92:95], v[96:99], v[44:47]
    s_waitcnt lgkmcnt(0)
    v_mfma_f32_16x16x32_bf16 v[16:19], a[8:11], v[64:67], v[16:19]
    ds_read_b128 v[96:99], v7 offset:3776
    v_mfma_f32_16x16x32_bf16 v[20:23], a[8:11], v[68:71], v[20:23]
    ds_read_b128 v[100:103], v7 offset:3264
    v_mfma_f32_16x16x32_bf16 v[20:23], a[40:43], v[64:67], v[20:23]
    ds_read_b64 v[80:81], v6 offset:2240
    v_mfma_f32_16x16x32_bf16 v[24:27], a[40:43], v[68:71], v[24:27]
    ds_read_b64 v[82:83], v6 offset:2248
    v_mfma_f32_16x16x32_bf16 v[24:27], a[72:75], v[64:67], v[24:27]
    ds_read_b64 v[84:85], v6 offset:2752
    v_mfma_f32_16x16x32_bf16 v[28:31], a[72:75], v[68:71], v[28:31]
    ds_read_b64 v[86:87], v6 offset:2760
    v_mfma_f32_16x16x32_bf16 v[28:31], a[104:107], v[64:67], v[28:31]
    ds_read_b64 v[88:89], v6 offset:3264
    v_mfma_f32_16x16x32_bf16 v[32:35], a[104:107], v[68:71], v[32:35]
    ds_read_b64 v[90:91], v6 offset:3272
    v_mfma_f32_16x16x32_bf16 v[32:35], v[48:51], v[64:67], v[32:35]
    ds_read_b64 v[92:93], v6 offset:3776
    v_mfma_f32_16x16x32_bf16 v[36:39], v[48:51], v[68:71], v[36:39]
    ds_read_b64 v[94:95], v6 offset:3784
    v_mfma_f32_16x16x32_bf16 v[36:39], v[52:55], v[64:67], v[36:39]
    v_mfma_f32_16x16x32_bf16 v[40:43], v[52:55], v[68:71], v[40:43]
    v_mfma_f32_16x16x32_bf16 v[40:43], v[56:59], v[64:67], v[40:43]
    v_mfma_f32_16x16x32_bf16 v[44:47], v[56:59], v[68:71], v[44:47]
    v_mfma_f32_16x16x32_bf16 v[44:47], v[60:63], v[64:67], v[44:47]
    s_waitcnt lgkmcnt(0)
    v_mfma_f32_16x16x32_bf16 v[16:19], a[12:15], v[96:99], v[16:19]
    ds_read_b128 v[64:67], v7 offset:3840
    v_mfma_f32_16x16x32_bf16 v[20:23], a[12:15], v[100:103], v[20:23]
    ds_read_b128 v[68:71], v7 offset:3328
    v_mfma_f32_16x16x32_bf16 v[20:23], a[44:47], v[96:99], v[20:23]
    ds_read_b64 v[48:49], v6 offset:2304
    v_mfma_f32_16x16x32_bf16 v[24:27], a[44:47], v[100:103], v[24:27]
    ds_read_b64 v[50:51], v6 offset:2312
    v_mfma_f32_16x16x32_bf16 v[24:27], a[76:79], v[96:99], v[24:27]
    ds_read_b64 v[52:53], v6 offset:2816
    v_mfma_f32_16x16x32_bf16 v[28:31], a[76:79], v[100:103], v[28:31]
    ds_read_b64 v[54:55], v6 offset:2824
    v_mfma_f32_16x16x32_bf16 v[28:31], a[108:111], v[96:99], v[28:31]
    ds_read_b64 v[56:57], v6 offset:3328
    v_mfma_f32_16x16x32_bf16 v[32:35], a[108:111], v[100:103], v[32:35]
    ds_read_b64 v[58:59], v6 offset:3336
    v_mfma_f32_16x16x32_bf16 v[32:35], v[80:83], v[96:99], v[32:35]
    ds_read_b64 v[60:61], v6 offset:3840
    v_mfma_f32_16x16x32_bf16 v[36:39], v[80:83], v[100:103], v[36:39]
    ds_read_b64 v[62:63], v6 offset:3848
    v_mfma_f32_16x16x32_bf16 v[36:39], v[84:87], v[96:99], v[36:39]
    v_mfma_f32_16x16x32_bf16 v[40:43], v[84:87], v[100:103], v[40:43]
    v_mfma_f32_16x16x32_bf16 v[40:43], v[88:91], v[96:99], v[40:43]
    v_mfma_f32_16x16x32_bf16 v[44:47], v[88:91], v[100:103], v[44:47]
    v_mfma_f32_16x16x32_bf16 v[44:47], v[92:95], v[96:99], v[44:47]
    s_waitcnt lgkmcnt(0)
    v_mfma_f32_16x16x32_bf16 v[16:19], a[16:19], v[64:67], v[16:19]
    ds_read_b128 v[96:99], v7 offset:3904
    v_mfma_f32_16x16x32_bf16 v[20:23], a[16:19], v[68:71], v[20:23]
    ds_read_b128 v[100:103], v7 offset:3392
    v_mfma_f32_16x16x32_bf16 v[20:23], a[48:51], v[64:67], v[20:23]
    ds_read_b64 v[80:81], v6 offset:2368
    v_mfma_f32_16x16x32_bf16 v[24:27], a[48:51], v[68:71], v[24:27]
    ds_read_b64 v[82:83], v6 offset:2376
    v_mfma_f32_16x16x32_bf16 v[24:27], a[80:83], v[64:67], v[24:27]
    ds_read_b64 v[84:85], v6 offset:2880
    v_mfma_f32_16x16x32_bf16 v[28:31], a[80:83], v[68:71], v[28:31]
    ds_read_b64 v[86:87], v6 offset:2888
    v_mfma_f32_16x16x32_bf16 v[28:31], a[112:115], v[64:67], v[28:31]
    ds_read_b64 v[88:89], v6 offset:3392
    v_mfma_f32_16x16x32_bf16 v[32:35], a[112:115], v[68:71], v[32:35]
    ds_read_b64 v[90:91], v6 offset:3400
    v_mfma_f32_16x16x32_bf16 v[32:35], v[48:51], v[64:67], v[32:35]
    ds_read_b64 v[92:93], v6 offset:3904
    v_mfma_f32_16x16x32_bf16 v[36:39], v[48:51], v[68:71], v[36:39]
    ds_read_b64 v[94:95], v6 offset:3912
    v_mfma_f32_16x16x32_bf16 v[36:39], v[52:55], v[64:67], v[36:39]
    v_mfma_f32_16x16x32_bf16 v[40:43], v[52:55], v[68:71], v[40:43]
    v_mfma_f32_16x16x32_bf16 v[40:43], v[56:59], v[64:67], v[40:43]
    v_mfma_f32_16x16x32_bf16 v[44:47], v[56:59], v[68:71], v[44:47]
    v_mfma_f32_16x16x32_bf16 v[44:47], v[60:63], v[64:67], v[44:47]
    s_waitcnt lgkmcnt(0)
    v_mfma_f32_16x16x32_bf16 v[16:19], a[20:23], v[96:99], v[16:19]
    ds_read_b128 v[64:67], v7 offset:3968
    v_mfma_f32_16x16x32_bf16 v[20:23], a[20:23], v[100:103], v[20:23]
    ds_read_b128 v[68:71], v7 offset:3456
    v_mfma_f32_16x16x32_bf16 v[20:23], a[52:55], v[96:99], v[20:23]
    ds_read_b64 v[48:49], v6 offset:2432
    v_mfma_f32_16x16x32_bf16 v[24:27], a[52:55], v[100:103], v[24:27]
    ds_read_b64 v[50:51], v6 offset:2440
    v_mfma_f32_16x16x32_bf16 v[24:27], a[84:87], v[96:99], v[24:27]
    ds_read_b64 v[52:53], v6 offset:2944
    v_mfma_f32_16x16x32_bf16 v[28:31], a[84:87], v[100:103], v[28:31]
    ds_read_b64 v[54:55], v6 offset:2952
    v_mfma_f32_16x16x32_bf16 v[28:31], a[116:119], v[96:99], v[28:31]
    ds_read_b64 v[56:57], v6 offset:3456
    v_mfma_f32_16x16x32_bf16 v[32:35], a[116:119], v[100:103], v[32:35]
    ds_read_b64 v[58:59], v6 offset:3464
    v_mfma_f32_16x16x32_bf16 v[32:35], v[80:83], v[96:99], v[32:35]
    ds_read_b64 v[60:61], v6 offset:3968
    v_mfma_f32_16x16x32_bf16 v[36:39], v[80:83], v[100:103], v[36:39]
    ds_read_b64 v[62:63], v6 offset:3976
    v_mfma_f32_16x16x32_bf16 v[36:39], v[84:87], v[96:99], v[36:39]
    v_mfma_f32_16x16x32_bf16 v[40:43], v[84:87], v[100:103], v[40:43]
    v_mfma_f32_16x16x32_bf16 v[40:43], v[88:91], v[96:99], v[40:43]
    v_mfma_f32_16x16x32_bf16 v[44:47], v[88:91], v[100:103], v[44:47]
    v_mfma_f32_16x16x32_bf16 v[44:47], v[92:95], v[96:99], v[44:47]
    s_waitcnt lgkmcnt(0)
    v_mfma_f32_16x16x32_bf16 v[16:19], a[24:27], v[64:67], v[16:19]
    ds_read_b128 v[96:99], v7 offset:4032
    v_mfma_f32_16x16x32_bf16 v[20:23], a[24:27], v[68:71], v[20:23]
    ds_read_b128 v[100:103], v7 offset:3520
    v_mfma_f32_16x16x32_bf16 v[20:23], a[56:59], v[64:67], v[20:23]
    ds_read_b64 v[80:81], v6 offset:2496
    v_mfma_f32_16x16x32_bf16 v[24:27], a[56:59], v[68:71], v[24:27]
    ds_read_b64 v[82:83], v6 offset:2504
    v_mfma_f32_16x16x32_bf16 v[24:27], a[88:91], v[64:67], v[24:27]
    ds_read_b64 v[84:85], v6 offset:3008
    v_mfma_f32_16x16x32_bf16 v[28:31], a[88:91], v[68:71], v[28:31]
    ds_read_b64 v[86:87], v6 offset:3016
    v_mfma_f32_16x16x32_bf16 v[28:31], a[120:123], v[64:67], v[28:31]
    ds_read_b64 v[88:89], v6 offset:3520
    v_mfma_f32_16x16x32_bf16 v[32:35], a[120:123], v[68:71], v[32:35]
    ds_read_b64 v[90:91], v6 offset:3528
    v_mfma_f32_16x16x32_bf16 v[32:35], v[48:51], v[64:67], v[32:35]
    ds_read_b64 v[92:93], v6 offset:4032
    v_mfma_f32_16x16x32_bf16 v[36:39], v[48:51], v[68:71], v[36:39]
    ds_read_b64 v[94:95], v6 offset:4040
    v_mfma_f32_16x16x32_bf16 v[36:39], v[52:55], v[64:67], v[36:39]
    v_mfma_f32_16x16x32_bf16 v[40:43], v[52:55], v[68:71], v[40:43]
    v_mfma_f32_16x16x32_bf16 v[40:43], v[56:59], v[64:67], v[40:43]
    v_mfma_f32_16x16x32_bf16 v[44:47], v[56:59], v[68:71], v[44:47]
    v_mfma_f32_16x16x32_bf16 v[44:47], v[60:63], v[64:67], v[44:47]
    s_waitcnt lgkmcnt(0)
    v_mfma_f32_16x16x32_bf16 v[16:19], a[28:31], v[96:99], v[16:19]
    ds_read_b64 v[48:49], v6 offset:2048
    v_mfma_f32_16x16x32_bf16 v[20:23], a[28:31], v[100:103], v[20:23]
    ds_read_b64 v[50:51], v6 offset:2056
    v_mfma_f32_16x16x32_bf16 v[20:23], a[60:63], v[96:99], v[20:23]
    ds_read_b64 v[52:53], v6 offset:2560
    v_mfma_f32_16x16x32_bf16 v[24:27], a[60:63], v[100:103], v[24:27]
    ds_read_b64 v[54:55], v6 offset:2568
    v_mfma_f32_16x16x32_bf16 v[24:27], a[92:95], v[96:99], v[24:27]
    v_mfma_f32_16x16x32_bf16 v[28:31], a[92:95], v[100:103], v[28:31]
    v_mfma_f32_16x16x32_bf16 v[28:31], a[124:127], v[96:99], v[28:31]
    v_mfma_f32_16x16x32_bf16 v[32:35], a[124:127], v[100:103], v[32:35]
    v_mfma_f32_16x16x32_bf16 v[32:35], v[80:83], v[96:99], v[32:35]
    v_mfma_f32_16x16x32_bf16 v[36:39], v[80:83], v[100:103], v[36:39]
    v_mfma_f32_16x16x32_bf16 v[36:39], v[84:87], v[96:99], v[36:39]
    v_mfma_f32_16x16x32_bf16 v[40:43], v[84:87], v[100:103], v[40:43]
    v_mfma_f32_16x16x32_bf16 v[40:43], v[88:91], v[96:99], v[40:43]
    v_mfma_f32_16x16x32_bf16 v[44:47], v[88:91], v[100:103], v[44:47]
    v_mfma_f32_16x16x32_bf16 v[44:47], v[92:95], v[96:99], v[44:47]
    s_barrier
    ds_read_b128 v[64:67], v7 offset:2560
    ds_read_b128 v[68:71], v7 offset:2048
    s_waitcnt lgkmcnt(0)
    v_mfma_f32_16x16x32_bf16 v[24:27], a[0:3], v[64:67], v[24:27]
    ds_read_b128 v[96:99], v7 offset:2624
    v_mfma_f32_16x16x32_bf16 v[28:31], a[0:3], v[68:71], v[28:31]
    ds_read_b128 v[100:103], v7 offset:2112
    v_mfma_f32_16x16x32_bf16 v[28:31], a[32:35], v[64:67], v[28:31]
    ds_read_b64 v[80:81], v6 offset:2112
    v_mfma_f32_16x16x32_bf16 v[32:35], a[32:35], v[68:71], v[32:35]
    ds_read_b64 v[82:83], v6 offset:2120
    v_mfma_f32_16x16x32_bf16 v[32:35], a[64:67], v[64:67], v[32:35]
    ds_read_b64 v[84:85], v6 offset:2624
    v_mfma_f32_16x16x32_bf16 v[36:39], a[64:67], v[68:71], v[36:39]
    ds_read_b64 v[86:87], v6 offset:2632
    v_mfma_f32_16x16x32_bf16 v[36:39], a[96:99], v[64:67], v[36:39]
    v_mfma_f32_16x16x32_bf16 v[40:43], a[96:99], v[68:71], v[40:43]
    v_mfma_f32_16x16x32_bf16 v[40:43], v[48:51], v[64:67], v[40:43]
    v_mfma_f32_16x16x32_bf16 v[44:47], v[48:51], v[68:71], v[44:47]
    v_mfma_f32_16x16x32_bf16 v[44:47], v[52:55], v[64:67], v[44:47]
    v_mfma_f32_16x16x32_bf16 v[24:27], v[116:119], v[64:67], v[24:27]
    v_mfma_f32_16x16x32_bf16 v[28:31], v[116:119], v[68:71], v[28:31]
    s_waitcnt lgkmcnt(0)
    v_mfma_f32_16x16x32_bf16 v[24:27], a[4:7], v[96:99], v[24:27]
    ds_read_b128 v[64:67], v7 offset:2688
    v_mfma_f32_16x16x32_bf16 v[28:31], a[4:7], v[100:103], v[28:31]
    ds_read_b128 v[68:71], v7 offset:2176
    v_mfma_f32_16x16x32_bf16 v[28:31], a[36:39], v[96:99], v[28:31]
    ds_read_b64 v[48:49], v6 offset:2176
    v_mfma_f32_16x16x32_bf16 v[32:35], a[36:39], v[100:103], v[32:35]
    ds_read_b64 v[50:51], v6 offset:2184
    v_mfma_f32_16x16x32_bf16 v[32:35], a[68:71], v[96:99], v[32:35]
    ds_read_b64 v[52:53], v6 offset:2688
    v_mfma_f32_16x16x32_bf16 v[36:39], a[68:71], v[100:103], v[36:39]
    ds_read_b64 v[54:55], v6 offset:2696
    v_mfma_f32_16x16x32_bf16 v[36:39], a[100:103], v[96:99], v[36:39]
    v_cvt_pk_bf16_f32 v112, v16, v17
    v_mfma_f32_16x16x32_bf16 v[40:43], a[100:103], v[100:103], v[40:43]
    v_mfma_f32_16x16x32_bf16 v[40:43], v[80:83], v[96:99], v[40:43]
    v_mfma_f32_16x16x32_bf16 v[44:47], v[80:83], v[100:103], v[44:47]
    v_mfma_f32_16x16x32_bf16 v[44:47], v[84:87], v[96:99], v[44:47]
    s_waitcnt lgkmcnt(0)
    v_mfma_f32_16x16x32_bf16 v[24:27], a[8:11], v[64:67], v[24:27]
    ds_read_b128 v[96:99], v7 offset:2752
    v_mfma_f32_16x16x32_bf16 v[28:31], a[8:11], v[68:71], v[28:31]
    ds_read_b128 v[100:103], v7 offset:2240
    v_mfma_f32_16x16x32_bf16 v[28:31], a[40:43], v[64:67], v[28:31]
    ds_read_b64 v[80:81], v6 offset:2240
    v_mfma_f32_16x16x32_bf16 v[32:35], a[40:43], v[68:71], v[32:35]
    ds_read_b64 v[82:83], v6 offset:2248
    v_mfma_f32_16x16x32_bf16 v[32:35], a[72:75], v[64:67], v[32:35]
    ds_read_b64 v[84:85], v6 offset:2752
    v_mfma_f32_16x16x32_bf16 v[36:39], a[72:75], v[68:71], v[36:39]
    ds_read_b64 v[86:87], v6 offset:2760
    v_mfma_f32_16x16x32_bf16 v[36:39], a[104:107], v[64:67], v[36:39]
    v_cvt_pk_bf16_f32 v113, v18, v19
    v_mfma_f32_16x16x32_bf16 v[40:43], a[104:107], v[68:71], v[40:43]
    v_mfma_f32_16x16x32_bf16 v[40:43], v[48:51], v[64:67], v[40:43]
    v_mfma_f32_16x16x32_bf16 v[44:47], v[48:51], v[68:71], v[44:47]
    v_mfma_f32_16x16x32_bf16 v[44:47], v[52:55], v[64:67], v[44:47]
    s_waitcnt lgkmcnt(0)
    v_mfma_f32_16x16x32_bf16 v[24:27], a[12:15], v[96:99], v[24:27]
    ds_read_b128 v[64:67], v7 offset:2816
    v_mfma_f32_16x16x32_bf16 v[28:31], a[12:15], v[100:103], v[28:31]
    ds_read_b128 v[68:71], v7 offset:2304
    v_mfma_f32_16x16x32_bf16 v[28:31], a[44:47], v[96:99], v[28:31]
    ds_read_b64 v[48:49], v6 offset:2304
    v_mfma_f32_16x16x32_bf16 v[32:35], a[44:47], v[100:103], v[32:35]
    ds_read_b64 v[50:51], v6 offset:2312
    v_mfma_f32_16x16x32_bf16 v[32:35], a[76:79], v[96:99], v[32:35]
    ds_read_b64 v[52:53], v6 offset:2816
    v_mfma_f32_16x16x32_bf16 v[36:39], a[76:79], v[100:103], v[36:39]
    ds_read_b64 v[54:55], v6 offset:2824
    v_mfma_f32_16x16x32_bf16 v[36:39], a[108:111], v[96:99], v[36:39]
    ds_write_b64 v1, v[112:113] offset:0
    v_mfma_f32_16x16x32_bf16 v[40:43], a[108:111], v[100:103], v[40:43]
    v_mfma_f32_16x16x32_bf16 v[40:43], v[80:83], v[96:99], v[40:43]
    v_mfma_f32_16x16x32_bf16 v[44:47], v[80:83], v[100:103], v[44:47]
    v_mfma_f32_16x16x32_bf16 v[44:47], v[84:87], v[96:99], v[44:47]
    s_waitcnt lgkmcnt(0)
    v_mfma_f32_16x16x32_bf16 v[24:27], a[16:19], v[64:67], v[24:27]
    ds_read_b128 v[96:99], v7 offset:2880
    v_mfma_f32_16x16x32_bf16 v[28:31], a[16:19], v[68:71], v[28:31]
    ds_read_b128 v[100:103], v7 offset:2368
    v_mfma_f32_16x16x32_bf16 v[28:31], a[48:51], v[64:67], v[28:31]
    ds_read_b64 v[80:81], v6 offset:2368
    v_mfma_f32_16x16x32_bf16 v[32:35], a[48:51], v[68:71], v[32:35]
    ds_read_b64 v[82:83], v6 offset:2376
    v_mfma_f32_16x16x32_bf16 v[32:35], a[80:83], v[64:67], v[32:35]
    ds_read_b64 v[84:85], v6 offset:2880
    v_mfma_f32_16x16x32_bf16 v[36:39], a[80:83], v[68:71], v[36:39]
    ds_read_b64 v[86:87], v6 offset:2888
    v_mfma_f32_16x16x32_bf16 v[36:39], a[112:115], v[64:67], v[36:39]
    v_cvt_pk_bf16_f32 v114, v20, v21
    v_mfma_f32_16x16x32_bf16 v[40:43], a[112:115], v[68:71], v[40:43]
    v_mfma_f32_16x16x32_bf16 v[40:43], v[48:51], v[64:67], v[40:43]
    v_mfma_f32_16x16x32_bf16 v[44:47], v[48:51], v[68:71], v[44:47]
    v_mfma_f32_16x16x32_bf16 v[44:47], v[52:55], v[64:67], v[44:47]
    s_waitcnt lgkmcnt(0)
    v_mfma_f32_16x16x32_bf16 v[24:27], a[20:23], v[96:99], v[24:27]
    ds_read_b128 v[64:67], v7 offset:2944
    v_mfma_f32_16x16x32_bf16 v[28:31], a[20:23], v[100:103], v[28:31]
    ds_read_b128 v[68:71], v7 offset:2432
    v_mfma_f32_16x16x32_bf16 v[28:31], a[52:55], v[96:99], v[28:31]
    ds_read_b64 v[48:49], v6 offset:2432
    v_mfma_f32_16x16x32_bf16 v[32:35], a[52:55], v[100:103], v[32:35]
    ds_read_b64 v[50:51], v6 offset:2440
    v_mfma_f32_16x16x32_bf16 v[32:35], a[84:87], v[96:99], v[32:35]
    ds_read_b64 v[52:53], v6 offset:2944
    v_mfma_f32_16x16x32_bf16 v[36:39], a[84:87], v[100:103], v[36:39]
    ds_read_b64 v[54:55], v6 offset:2952
    v_mfma_f32_16x16x32_bf16 v[36:39], a[116:119], v[96:99], v[36:39]
    v_cvt_pk_bf16_f32 v115, v22, v23
    v_mfma_f32_16x16x32_bf16 v[40:43], a[116:119], v[100:103], v[40:43]
    v_mfma_f32_16x16x32_bf16 v[40:43], v[80:83], v[96:99], v[40:43]
    v_mfma_f32_16x16x32_bf16 v[44:47], v[80:83], v[100:103], v[44:47]
    v_mfma_f32_16x16x32_bf16 v[44:47], v[84:87], v[96:99], v[44:47]
    s_waitcnt lgkmcnt(0)
    v_mfma_f32_16x16x32_bf16 v[24:27], a[24:27], v[64:67], v[24:27]
    ds_read_b128 v[96:99], v7 offset:3008
    v_mfma_f32_16x16x32_bf16 v[28:31], a[24:27], v[68:71], v[28:31]
    ds_read_b128 v[100:103], v7 offset:2496
    v_mfma_f32_16x16x32_bf16 v[28:31], a[56:59], v[64:67], v[28:31]
    ds_read_b64 v[80:81], v6 offset:2496
    v_mfma_f32_16x16x32_bf16 v[32:35], a[56:59], v[68:71], v[32:35]
    ds_read_b64 v[82:83], v6 offset:2504
    v_mfma_f32_16x16x32_bf16 v[32:35], a[88:91], v[64:67], v[32:35]
    ds_read_b64 v[84:85], v6 offset:3008
    v_mfma_f32_16x16x32_bf16 v[36:39], a[88:91], v[68:71], v[36:39]
    ds_read_b64 v[86:87], v6 offset:3016
    v_mfma_f32_16x16x32_bf16 v[36:39], a[120:123], v[64:67], v[36:39]
    ds_write_b64 v1, v[114:115] offset:2304
    v_mfma_f32_16x16x32_bf16 v[40:43], a[120:123], v[68:71], v[40:43]
    v_mfma_f32_16x16x32_bf16 v[40:43], v[48:51], v[64:67], v[40:43]
    v_mfma_f32_16x16x32_bf16 v[44:47], v[48:51], v[68:71], v[44:47]
    v_mfma_f32_16x16x32_bf16 v[44:47], v[52:55], v[64:67], v[44:47]
    s_waitcnt lgkmcnt(0)
    v_mfma_f32_16x16x32_bf16 v[24:27], a[28:31], v[96:99], v[24:27]
    v_mfma_f32_16x16x32_bf16 v[28:31], a[28:31], v[100:103], v[28:31]
    v_mfma_f32_16x16x32_bf16 v[28:31], a[60:63], v[96:99], v[28:31]
    v_mfma_f32_16x16x32_bf16 v[32:35], a[60:63], v[100:103], v[32:35]
    v_mfma_f32_16x16x32_bf16 v[32:35], a[92:95], v[96:99], v[32:35]
    v_mfma_f32_16x16x32_bf16 v[36:39], a[92:95], v[100:103], v[36:39]
    v_mfma_f32_16x16x32_bf16 v[36:39], a[124:127], v[96:99], v[36:39]
    v_mfma_f32_16x16x32_bf16 v[40:43], a[124:127], v[100:103], v[40:43]
    v_mfma_f32_16x16x32_bf16 v[40:43], v[80:83], v[96:99], v[40:43]
    v_mfma_f32_16x16x32_bf16 v[44:47], v[80:83], v[100:103], v[44:47]
    v_mfma_f32_16x16x32_bf16 v[44:47], v[84:87], v[96:99], v[44:47]
    s_barrier
    ds_read_b128 v[48:51], v7 offset:1536
    ds_read_b128 v[52:55], v7 offset:1024
    ds_read_b128 v[56:59], v7 offset:1600
    ds_read_b128 v[60:63], v7 offset:1088
    ds_read_b128 v[64:67], v7 offset:1664
    ds_read_b128 v[68:71], v7 offset:1152
    ds_read_b128 v[72:75], v7 offset:1728
    ds_read_b128 v[76:79], v7 offset:1216
    ds_read_b128 v[80:83], v7 offset:1792
    ds_read_b128 v[84:87], v7 offset:1280
    ds_read_b128 v[88:91], v7 offset:1856
    ds_read_b128 v[92:95], v7 offset:1344
    ds_read_b128 v[96:99], v7 offset:1920
    ds_read_b128 v[100:103], v7 offset:1408
    ds_read_b128 v[104:107], v7 offset:1984
    s_waitcnt lgkmcnt(13)
    ds_read_b128 v[108:111], v7 offset:1472
    v_mfma_f32_16x16x32_bf16 v[32:35], v[116:119], v[48:51], v[32:35]
    v_mfma_f32_16x16x32_bf16 v[32:35], a[0:3], v[48:51], v[32:35]
    v_mfma_f32_16x16x32_bf16 v[36:39], a[32:35], v[48:51], v[36:39]
    v_mfma_f32_16x16x32_bf16 v[40:43], a[64:67], v[48:51], v[40:43]
    v_mfma_f32_16x16x32_bf16 v[44:47], a[96:99], v[48:51], v[44:47]
    v_mfma_f32_16x16x32_bf16 v[36:39], v[116:119], v[52:55], v[36:39]
    v_mfma_f32_16x16x32_bf16 v[36:39], a[0:3], v[52:55], v[36:39]
    v_mfma_f32_16x16x32_bf16 v[40:43], a[32:35], v[52:55], v[40:43]
    v_mfma_f32_16x16x32_bf16 v[44:47], a[64:67], v[52:55], v[44:47]
    s_waitcnt lgkmcnt(12)
    v_mfma_f32_16x16x32_bf16 v[32:35], a[4:7], v[56:59], v[32:35]
    v_mfma_f32_16x16x32_bf16 v[36:39], a[36:39], v[56:59], v[36:39]
    v_mfma_f32_16x16x32_bf16 v[40:43], a[68:71], v[56:59], v[40:43]
    v_mfma_f32_16x16x32_bf16 v[44:47], a[100:103], v[56:59], v[44:47]
    v_mfma_f32_16x16x32_bf16 v[36:39], a[4:7], v[60:63], v[36:39]
    v_mfma_f32_16x16x32_bf16 v[40:43], a[36:39], v[60:63], v[40:43]
    v_mfma_f32_16x16x32_bf16 v[44:47], a[68:71], v[60:63], v[44:47]
    s_waitcnt lgkmcnt(10)
    v_mfma_f32_16x16x32_bf16 v[32:35], a[8:11], v[64:67], v[32:35]
    v_mfma_f32_16x16x32_bf16 v[36:39], a[40:43], v[64:67], v[36:39]
    v_mfma_f32_16x16x32_bf16 v[40:43], a[72:75], v[64:67], v[40:43]
    v_mfma_f32_16x16x32_bf16 v[44:47], a[104:107], v[64:67], v[44:47]
    v_mfma_f32_16x16x32_bf16 v[36:39], a[8:11], v[68:71], v[36:39]
    v_mfma_f32_16x16x32_bf16 v[40:43], a[40:43], v[68:71], v[40:43]
    v_mfma_f32_16x16x32_bf16 v[44:47], a[72:75], v[68:71], v[44:47]
    s_waitcnt lgkmcnt(8)
    v_mfma_f32_16x16x32_bf16 v[32:35], a[12:15], v[72:75], v[32:35]
    v_mfma_f32_16x16x32_bf16 v[36:39], a[44:47], v[72:75], v[36:39]
    v_mfma_f32_16x16x32_bf16 v[40:43], a[76:79], v[72:75], v[40:43]
    v_mfma_f32_16x16x32_bf16 v[44:47], a[108:111], v[72:75], v[44:47]
    v_mfma_f32_16x16x32_bf16 v[36:39], a[12:15], v[76:79], v[36:39]
    v_mfma_f32_16x16x32_bf16 v[40:43], a[44:47], v[76:79], v[40:43]
    v_mfma_f32_16x16x32_bf16 v[44:47], a[76:79], v[76:79], v[44:47]
    s_waitcnt lgkmcnt(6)
    v_mfma_f32_16x16x32_bf16 v[32:35], a[16:19], v[80:83], v[32:35]
    v_mfma_f32_16x16x32_bf16 v[36:39], a[48:51], v[80:83], v[36:39]
    v_mfma_f32_16x16x32_bf16 v[40:43], a[80:83], v[80:83], v[40:43]
    v_mfma_f32_16x16x32_bf16 v[44:47], a[112:115], v[80:83], v[44:47]
    v_mfma_f32_16x16x32_bf16 v[36:39], a[16:19], v[84:87], v[36:39]
    v_mfma_f32_16x16x32_bf16 v[40:43], a[48:51], v[84:87], v[40:43]
    v_mfma_f32_16x16x32_bf16 v[44:47], a[80:83], v[84:87], v[44:47]
    s_waitcnt lgkmcnt(4)
    v_mfma_f32_16x16x32_bf16 v[32:35], a[20:23], v[88:91], v[32:35]
    v_mfma_f32_16x16x32_bf16 v[36:39], a[52:55], v[88:91], v[36:39]
    v_mfma_f32_16x16x32_bf16 v[40:43], a[84:87], v[88:91], v[40:43]
    v_mfma_f32_16x16x32_bf16 v[44:47], a[116:119], v[88:91], v[44:47]
    v_mfma_f32_16x16x32_bf16 v[36:39], a[20:23], v[92:95], v[36:39]
    v_mfma_f32_16x16x32_bf16 v[40:43], a[52:55], v[92:95], v[40:43]
    v_mfma_f32_16x16x32_bf16 v[44:47], a[84:87], v[92:95], v[44:47]
    s_waitcnt lgkmcnt(2)
    v_mfma_f32_16x16x32_bf16 v[32:35], a[24:27], v[96:99], v[32:35]
    v_mfma_f32_16x16x32_bf16 v[36:39], a[56:59], v[96:99], v[36:39]
    v_mfma_f32_16x16x32_bf16 v[40:43], a[88:91], v[96:99], v[40:43]
    v_mfma_f32_16x16x32_bf16 v[44:47], a[120:123], v[96:99], v[44:47]
    v_mfma_f32_16x16x32_bf16 v[36:39], a[24:27], v[100:103], v[36:39]
    v_mfma_f32_16x16x32_bf16 v[40:43], a[56:59], v[100:103], v[40:43]
    v_mfma_f32_16x16x32_bf16 v[44:47], a[88:91], v[100:103], v[44:47]
    s_waitcnt lgkmcnt(0)
    v_mfma_f32_16x16x32_bf16 v[32:35], a[28:31], v[104:107], v[32:35]
    v_mfma_f32_16x16x32_bf16 v[36:39], a[60:63], v[104:107], v[36:39]
    v_mfma_f32_16x16x32_bf16 v[40:43], a[92:95], v[104:107], v[40:43]
    v_mfma_f32_16x16x32_bf16 v[44:47], a[124:127], v[104:107], v[44:47]
    v_mfma_f32_16x16x32_bf16 v[36:39], a[28:31], v[108:111], v[36:39]
    v_mfma_f32_16x16x32_bf16 v[40:43], a[60:63], v[108:111], v[40:43]
    v_mfma_f32_16x16x32_bf16 v[44:47], a[92:95], v[108:111], v[44:47]
    v_cvt_pk_bf16_f32 v112, v24, v25
    v_cvt_pk_bf16_f32 v113, v26, v27
    ds_write_b64 v1, v[112:113] offset:4608
    v_cvt_pk_bf16_f32 v114, v28, v29
    v_cvt_pk_bf16_f32 v115, v30, v31
    ds_write_b64 v1, v[114:115] offset:6912
    s_nop 2
    v_cvt_pk_bf16_f32 v112, v32, v33
    v_cvt_pk_bf16_f32 v113, v34, v35
    ds_write_b64 v1, v[112:113] offset:9216
    v_cvt_pk_bf16_f32 v114, v36, v37
    v_cvt_pk_bf16_f32 v115, v38, v39
    ds_write_b64 v1, v[114:115] offset:11520
    s_waitcnt lgkmcnt(0)
    s_barrier
    ds_read_b128 v[48:51], v7 offset:512
    ds_read_b128 v[52:55], v7 offset:0
    ds_read_b128 v[56:59], v7 offset:576
    ds_read_b128 v[60:63], v7 offset:64
    ds_read_b128 v[64:67], v7 offset:640
    ds_read_b128 v[68:71], v7 offset:128
    ds_read_b128 v[72:75], v7 offset:704
    ds_read_b128 v[76:79], v7 offset:192
    ds_read_b128 v[80:83], v7 offset:768
    ds_read_b128 v[84:87], v7 offset:256
    ds_read_b128 v[88:91], v7 offset:832
    ds_read_b128 v[92:95], v7 offset:320
    ds_read_b128 v[96:99], v7 offset:896
    ds_read_b128 v[100:103], v7 offset:384
    ds_read_b128 v[104:107], v7 offset:960
    s_waitcnt lgkmcnt(13)
    ds_read_b128 v[108:111], v7 offset:448
    v_mfma_f32_16x16x32_bf16 v[40:43], v[116:119], v[48:51], v[40:43]
    v_mfma_f32_16x16x32_bf16 v[40:43], a[0:3], v[48:51], v[40:43]
    v_mfma_f32_16x16x32_bf16 v[44:47], a[32:35], v[48:51], v[44:47]
    v_mfma_f32_16x16x32_bf16 v[44:47], v[116:119], v[52:55], v[44:47]
    v_mfma_f32_16x16x32_bf16 v[44:47], a[0:3], v[52:55], v[44:47]
    s_waitcnt lgkmcnt(12)
    v_mfma_f32_16x16x32_bf16 v[40:43], a[4:7], v[56:59], v[40:43]
    v_mfma_f32_16x16x32_bf16 v[44:47], a[36:39], v[56:59], v[44:47]
    v_mfma_f32_16x16x32_bf16 v[44:47], a[4:7], v[60:63], v[44:47]
    s_waitcnt lgkmcnt(10)
    v_mfma_f32_16x16x32_bf16 v[40:43], a[8:11], v[64:67], v[40:43]
    v_mfma_f32_16x16x32_bf16 v[44:47], a[40:43], v[64:67], v[44:47]
    v_mfma_f32_16x16x32_bf16 v[44:47], a[8:11], v[68:71], v[44:47]
    s_waitcnt lgkmcnt(8)
    v_mfma_f32_16x16x32_bf16 v[40:43], a[12:15], v[72:75], v[40:43]
    v_mfma_f32_16x16x32_bf16 v[44:47], a[44:47], v[72:75], v[44:47]
    v_mfma_f32_16x16x32_bf16 v[44:47], a[12:15], v[76:79], v[44:47]
    s_waitcnt lgkmcnt(6)
    v_mfma_f32_16x16x32_bf16 v[40:43], a[16:19], v[80:83], v[40:43]
    v_mfma_f32_16x16x32_bf16 v[44:47], a[48:51], v[80:83], v[44:47]
    v_mfma_f32_16x16x32_bf16 v[44:47], a[16:19], v[84:87], v[44:47]
    s_waitcnt lgkmcnt(4)
    v_mfma_f32_16x16x32_bf16 v[40:43], a[20:23], v[88:91], v[40:43]
    v_mfma_f32_16x16x32_bf16 v[44:47], a[52:55], v[88:91], v[44:47]
    v_mfma_f32_16x16x32_bf16 v[44:47], a[20:23], v[92:95], v[44:47]
    s_waitcnt lgkmcnt(2)
    v_mfma_f32_16x16x32_bf16 v[40:43], a[24:27], v[96:99], v[40:43]
    v_mfma_f32_16x16x32_bf16 v[44:47], a[56:59], v[96:99], v[44:47]
    v_mfma_f32_16x16x32_bf16 v[44:47], a[24:27], v[100:103], v[44:47]
    s_waitcnt lgkmcnt(0)
    v_mfma_f32_16x16x32_bf16 v[40:43], a[28:31], v[104:107], v[40:43]
    v_mfma_f32_16x16x32_bf16 v[44:47], a[60:63], v[104:107], v[44:47]
    v_mfma_f32_16x16x32_bf16 v[44:47], a[28:31], v[108:111], v[44:47]
    s_nop 7
    v_cvt_pk_bf16_f32 v112, v40, v41
    v_cvt_pk_bf16_f32 v113, v42, v43
    ds_write_b64 v1, v[112:113] offset:13824
    v_cvt_pk_bf16_f32 v114, v44, v45
    v_cvt_pk_bf16_f32 v115, v46, v47
    ds_write_b64 v1, v[114:115] offset:16128
    s_waitcnt lgkmcnt(0)
    s_barrier
    s_endpgm
K1_LOADER_B:
    s_lshl_b32 s49, s44, 8
    s_sub_u32 s49, 71676, s49
    v_lshlrev_b32 v10, 2, v2
    v_sub_u32 v10, s49, v10
    s_waitcnt lgkmcnt(0)
    s_lshl_b32 s60, s52, 16
    s_and_b32 s64, s52, 0xffff0000
    s_lshl_b32 s68, s53, 16
    s_and_b32 s72, s53, 0xffff0000
    s_lshl_b32 s61, s54, 16
    s_and_b32 s65, s54, 0xffff0000
    s_lshl_b32 s69, s55, 16
    s_and_b32 s73, s55, 0xffff0000
    s_lshl_b32 s62, s56, 16
    s_and_b32 s66, s56, 0xffff0000
    s_lshl_b32 s70, s57, 16
    s_and_b32 s74, s57, 0xffff0000
    s_lshl_b32 s63, s58, 16
    s_and_b32 s67, s58, 0xffff0000
    s_lshl_b32 s71, s59, 16
    s_and_b32 s75, s59, 0xffff0000
    s_add_u32 s16, s14, 65536
    s_addc_u32 s17, s15, 0
    s_mov_b32 s18, 2359296
    s_mov_b32 s19, 0x20000
    v_and_b32 v11, 255, v0
    v_lshrrev_b32 v13, 3, v11
    v_add_u32 v127, v11, v13
    v_lshlrev_b32 v127, 4, v127
    v_add_u32 v127, 89088, v127
    v_mul_u32_u24 v125, 18432, v13
    v_and_b32 v9, 7, v11
    v_lshl_add_u32 v125, v9, 4, v125
    s_lshl_b32 s45, s41, 4
    s_waitcnt vmcnt(2)
    v_mov_b32_dpp v24, v16 wave_shr:1 row_mask:0xf bank_mask:0xf
    v_mov_b32_dpp v25, v17 wave_shr:1 row_mask:0xf bank_mask:0xf
    v_mov_b32_dpp v26, v18 wave_shr:1 row_mask:0xf bank_mask:0xf
    v_mov_b32_dpp v27, v19 wave_shr:1 row_mask:0xf bank_mask:0xf
    v_lshlrev_b32 v72, 16, v16
    v_and_b32 v73, 0xffff0000, v16
    v_lshlrev_b32 v74, 16, v17
    v_and_b32 v75, 0xffff0000, v17
    v_lshlrev_b32 v76, 16, v18
    v_and_b32 v77, 0xffff0000, v18
    v_lshlrev_b32 v78, 16, v19
    v_and_b32 v79, 0xffff0000, v19
    v_mov_b32_dpp v28, v26 wave_shr:1 row_mask:0xf bank_mask:0xf
    v_mov_b32_dpp v29, v27 wave_shr:1 row_mask:0xf bank_mask:0xf
    v_lshlrev_b32 v64, 16, v24
    v_and_b32 v65, 0xffff0000, v24
    v_lshlrev_b32 v66, 16, v25
    v_and_b32 v67, 0xffff0000, v25
    v_lshlrev_b32 v68, 16, v26
    v_and_b32 v69, 0xffff0000, v26
    v_lshlrev_b32 v70, 16, v27
    v_and_b32 v71, 0xffff0000, v27
    v_lshlrev_b32 v60, 16, v28
    v_and_b32 v61, 0xffff0000, v28
    v_lshlrev_b32 v62, 16, v29
    v_and_b32 v63, 0xffff0000, v29
    v_mul_f32 v88, s72, v60
    v_mul_f32 v89, s73, v61
    v_mul_f32 v90, s74, v62
    v_mul_f32 v91, s75, v63
    v_mul_f32 v104, s72, v64
    v_mul_f32 v105, s73, v65
    v_mul_f32 v106, s74, v66
    v_mul_f32 v107, s75, v67
    v_fmac_f32 v88, s68, v64
    v_fmac_f32 v89, s69, v65
    v_fmac_f32 v90, s70, v66
    v_fmac_f32 v91, s71, v67
    v_fmac_f32 v104, s68, v68
    v_fmac_f32 v105, s69, v69
    v_fmac_f32 v106, s70, v70
    v_fmac_f32 v107, s71, v71
    v_fmac_f32 v88, s64, v68
    v_fmac_f32 v89, s65, v69
    v_fmac_f32 v90, s66, v70
    v_fmac_f32 v91, s67, v71
    v_fmac_f32 v104, s64, v72
    v_fmac_f32 v105, s65, v73
    v_fmac_f32 v106, s66, v74
    v_fmac_f32 v107, s67, v75
    v_fmac_f32 v88, s60, v72
    v_fmac_f32 v89, s61, v73
    v_fmac_f32 v90, s62, v74
    v_fmac_f32 v91, s63, v75
    v_fmac_f32 v104, s60, v76
    v_fmac_f32 v105, s61, v77
    v_fmac_f32 v106, s62, v78
    v_fmac_f32 v107, s63, v79
    s_waitcnt vmcnt(0)
    v_lshlrev_b32 v80, 16, v20
    v_and_b32 v81, 0xffff0000, v20
    v_lshlrev_b32 v82, 16, v21
    v_and_b32 v83, 0xffff0000, v21
    v_lshlrev_b32 v84, 16, v22
    v_and_b32 v85, 0xffff0000, v22
    v_lshlrev_b32 v86, 16, v23
    v_and_b32 v87, 0xffff0000, v23
    v_mul_f32 v88, v88, v80
    v_mul_f32 v89, v89, v81
    v_mul_f32 v90, v90, v82
    v_mul_f32 v91, v91, v83
    v_mul_f32 v104, v104, v84
    v_mul_f32 v105, v105, v85
    v_mul_f32 v106, v106, v86
    v_mul_f32 v107, v107, v87
    v_cvt_pk_bf16_f32 v120, v104, v88
    v_cvt_pk_bf16_f32 v121, v105, v89
    v_cvt_pk_bf16_f32 v122, v106, v90
    v_cvt_pk_bf16_f32 v123, v107, v91
    ds_write_b32 v10, v120 offset:3072
    ds_write_b32 v10, v121 offset:7680
    ds_write_b32 v10, v122 offset:12288
    ds_write_b32 v10, v123 offset:16896
    s_setprio 2
    buffer_load_dwordx2 v[30:31], v3, s[32:35], s77 offen
    buffer_load_dwordx2 v[42:43], v5, s[32:35], 0 offen
    buffer_load_dwordx2 v[38:39], v5, s[32:35], 0 offen offset:1152
    buffer_load_dwordx2 v[40:41], v5, s[32:35], 0 offen offset:2304
    s_waitcnt lgkmcnt(0)
    s_barrier
    s_setprio 2
    buffer_load_dwordx2 v[32:33], v3, s[32:35], s77 offen offset:1152
    buffer_load_dwordx2 v[34:35], v3, s[36:39], s77 offen
    buffer_load_dwordx2 v[36:37], v3, s[36:39], s77 offen offset:1152
    s_setprio 3
    s_waitcnt vmcnt(2)
    v_mov_b32_dpp v38, v30 wave_shr:1 row_mask:0xf bank_mask:0xf
    v_mov_b32_dpp v39, v31 wave_shr:1 row_mask:0xf bank_mask:0xf
    v_mov_b32_dpp v40, v32 wave_shr:1 row_mask:0xf bank_mask:0xf
    v_mov_b32_dpp v41, v33 wave_shr:1 row_mask:0xf bank_mask:0xf
    v_lshlrev_b32 v72, 16, v30
    v_and_b32 v73, 0xffff0000, v30
    v_lshlrev_b32 v74, 16, v31
    v_and_b32 v75, 0xffff0000, v31
    v_lshlrev_b32 v76, 16, v32
    v_and_b32 v77, 0xffff0000, v32
    v_lshlrev_b32 v78, 16, v33
    v_and_b32 v79, 0xffff0000, v33
    v_mov_b32_dpp v42, v40 wave_shr:1 row_mask:0xf bank_mask:0xf
    v_mov_b32_dpp v43, v41 wave_shr:1 row_mask:0xf bank_mask:0xf
    v_lshlrev_b32 v64, 16, v38
    v_and_b32 v65, 0xffff0000, v38
    v_lshlrev_b32 v66, 16, v39
    v_and_b32 v67, 0xffff0000, v39
    v_lshlrev_b32 v68, 16, v40
    v_and_b32 v69, 0xffff0000, v40
    v_lshlrev_b32 v70, 16, v41
    v_and_b32 v71, 0xffff0000, v41
    v_lshlrev_b32 v60, 16, v42
    v_and_b32 v61, 0xffff0000, v42
    v_lshlrev_b32 v62, 16, v43
    v_and_b32 v63, 0xffff0000, v43
    v_mul_f32 v88, s72, v60
    v_mul_f32 v89, s73, v61
    v_mul_f32 v90, s74, v62
    v_mul_f32 v91, s75, v63
    v_mul_f32 v104, s72, v64
    v_mul_f32 v105, s73, v65
    v_mul_f32 v106, s74, v66
    v_mul_f32 v107, s75, v67
    v_fmac_f32 v88, s68, v64
    v_fmac_f32 v89, s69, v65
    v_fmac_f32 v90, s70, v66
    v_fmac_f32 v91, s71, v67
    v_fmac_f32 v104, s68, v68
    v_fmac_f32 v105, s69, v69
    v_fmac_f32 v106, s70, v70
    v_fmac_f32 v107, s71, v71
    v_fmac_f32 v88, s64, v68
    v_fmac_f32 v89, s65, v69
    v_fmac_f32 v90, s66, v70
    v_fmac_f32 v91, s67, v71
    v_fmac_f32 v104, s64, v72
    v_fmac_f32 v105, s65, v73
    v_fmac_f32 v106, s66, v74
    v_fmac_f32 v107, s67, v75
    v_fmac_f32 v88, s60, v72
    v_fmac_f32 v89, s61, v73
    v_fmac_f32 v90, s62, v74
    v_fmac_f32 v91, s63, v75
    v_fmac_f32 v104, s60, v76
    v_fmac_f32 v105, s61, v77
    v_fmac_f32 v106, s62, v78
    v_fmac_f32 v107, s63, v79
    s_waitcnt vmcnt(0)
    v_lshlrev_b32 v80, 16, v34
    v_and_b32 v81, 0xffff0000, v34
    v_lshlrev_b32 v82, 16, v35
    v_and_b32 v83, 0xffff0000, v35
    v_lshlrev_b32 v84, 16, v36
    v_and_b32 v85, 0xffff0000, v36
    v_lshlrev_b32 v86, 16, v37
    v_and_b32 v87, 0xffff0000, v37
    v_mul_f32 v88, v88, v80
    v_mul_f32 v89, v89, v81
    v_mul_f32 v90, v90, v82
    v_mul_f32 v91, v91, v83
    v_mul_f32 v104, v104, v84
    v_mul_f32 v105, v105, v85
    v_mul_f32 v106, v106, v86
    v_mul_f32 v107, v107, v87
    v_cvt_pk_bf16_f32 v120, v104, v88
    v_cvt_pk_bf16_f32 v121, v105, v89
    v_cvt_pk_bf16_f32 v122, v106, v90
    v_cvt_pk_bf16_f32 v123, v107, v91
    ds_write_b32 v10, v120 offset:2048
    ds_write_b32 v10, v121 offset:6656
    ds_write_b32 v10, v122 offset:11264
    ds_write_b32 v10, v123 offset:15872
    s_setprio 1
    buffer_load_dwordx2 v[44:45], v3, s[32:35], s78 offen
    buffer_load_dwordx2 v[56:57], v6, s[32:35], 0 offen
    buffer_load_dwordx2 v[52:53], v6, s[32:35], 0 offen offset:1152
    buffer_load_dwordx2 v[54:55], v6, s[32:35], 0 offen offset:2304
    buffer_load_dwordx2 v[46:47], v3, s[32:35], s78 offen offset:1152
    s_waitcnt lgkmcnt(0)
    s_barrier
    s_setprio 1
    buffer_load_dwordx2 v[48:49], v3, s[36:39], s78 offen
    buffer_load_dwordx2 v[50:51], v3, s[36:39], s78 offen offset:1152
    s_setprio 3
    s_waitcnt vmcnt(2)
    v_mov_b32_dpp v52, v44 wave_shr:1 row_mask:0xf bank_mask:0xf
    v_mov_b32_dpp v53, v45 wave_shr:1 row_mask:0xf bank_mask:0xf
    v_mov_b32_dpp v54, v46 wave_shr:1 row_mask:0xf bank_mask:0xf
    v_mov_b32_dpp v55, v47 wave_shr:1 row_mask:0xf bank_mask:0xf
    v_lshlrev_b32 v72, 16, v44
    v_and_b32 v73, 0xffff0000, v44
    v_lshlrev_b32 v74, 16, v45
    v_and_b32 v75, 0xffff0000, v45
    v_lshlrev_b32 v76, 16, v46
    v_and_b32 v77, 0xffff0000, v46
    v_lshlrev_b32 v78, 16, v47
    v_and_b32 v79, 0xffff0000, v47
    v_mov_b32_dpp v56, v54 wave_shr:1 row_mask:0xf bank_mask:0xf
    v_mov_b32_dpp v57, v55 wave_shr:1 row_mask:0xf bank_mask:0xf
    v_lshlrev_b32 v64, 16, v52
    v_and_b32 v65, 0xffff0000, v52
    v_lshlrev_b32 v66, 16, v53
    v_and_b32 v67, 0xffff0000, v53
    v_lshlrev_b32 v68, 16, v54
    v_and_b32 v69, 0xffff0000, v54
    v_lshlrev_b32 v70, 16, v55
    v_and_b32 v71, 0xffff0000, v55
    v_lshlrev_b32 v60, 16, v56
    v_and_b32 v61, 0xffff0000, v56
    v_lshlrev_b32 v62, 16, v57
    v_and_b32 v63, 0xffff0000, v57
    v_mul_f32 v88, s72, v60
    v_mul_f32 v89, s73, v61
    v_mul_f32 v90, s74, v62
    v_mul_f32 v91, s75, v63
    v_mul_f32 v104, s72, v64
    v_mul_f32 v105, s73, v65
    v_mul_f32 v106, s74, v66
    v_mul_f32 v107, s75, v67
    v_fmac_f32 v88, s68, v64
    v_fmac_f32 v89, s69, v65
    v_fmac_f32 v90, s70, v66
    v_fmac_f32 v91, s71, v67
    v_fmac_f32 v104, s68, v68
    v_fmac_f32 v105, s69, v69
    v_fmac_f32 v106, s70, v70
    v_fmac_f32 v107, s71, v71
    v_fmac_f32 v88, s64, v68
    v_fmac_f32 v89, s65, v69
    v_fmac_f32 v90, s66, v70
    v_fmac_f32 v91, s67, v71
    v_fmac_f32 v104, s64, v72
    v_fmac_f32 v105, s65, v73
    v_fmac_f32 v106, s66, v74
    v_fmac_f32 v107, s67, v75
    v_fmac_f32 v88, s60, v72
    v_fmac_f32 v89, s61, v73
    v_fmac_f32 v90, s62, v74
    v_fmac_f32 v91, s63, v75
    v_fmac_f32 v104, s60, v76
    v_fmac_f32 v105, s61, v77
    v_fmac_f32 v106, s62, v78
    v_fmac_f32 v107, s63, v79
    s_waitcnt vmcnt(0)
    v_lshlrev_b32 v80, 16, v48
    v_and_b32 v81, 0xffff0000, v48
    v_lshlrev_b32 v82, 16, v49
    v_and_b32 v83, 0xffff0000, v49
    v_lshlrev_b32 v84, 16, v50
    v_and_b32 v85, 0xffff0000, v50
    v_lshlrev_b32 v86, 16, v51
    v_and_b32 v87, 0xffff0000, v51
    v_mul_f32 v88, v88, v80
    v_mul_f32 v89, v89, v81
    v_mul_f32 v90, v90, v82
    v_mul_f32 v91, v91, v83
    v_mul_f32 v104, v104, v84
    v_mul_f32 v105, v105, v85
    v_mul_f32 v106, v106, v86
    v_mul_f32 v107, v107, v87
    v_cvt_pk_bf16_f32 v120, v104, v88
    v_cvt_pk_bf16_f32 v121, v105, v89
    v_cvt_pk_bf16_f32 v122, v106, v90
    v_cvt_pk_bf16_f32 v123, v107, v91
    ds_write_b32 v10, v120 offset:1024
    ds_write_b32 v10, v121 offset:5632
    ds_write_b32 v10, v122 offset:10240
    ds_write_b32 v10, v123 offset:14848
    s_setprio 0
    buffer_load_dwordx2 v[16:17], v3, s[32:35], s79 offen
    buffer_load_dwordx2 v[28:29], v7, s[32:35], 0 offen
    buffer_load_dwordx2 v[24:25], v7, s[32:35], 0 offen offset:1152
    buffer_load_dwordx2 v[26:27], v7, s[32:35], 0 offen offset:2304
    buffer_load_dwordx2 v[18:19], v3, s[32:35], s79 offen offset:1152
    buffer_load_dwordx2 v[20:21], v3, s[36:39], s79 offen
    s_waitcnt lgkmcnt(0)
    s_barrier
    s_setprio 0
    buffer_load_dwordx2 v[22:23], v3, s[36:39], s79 offen offset:1152
    s_setprio 3
    s_waitcnt vmcnt(2)
    v_mov_b32_dpp v24, v16 wave_shr:1 row_mask:0xf bank_mask:0xf
    v_mov_b32_dpp v25, v17 wave_shr:1 row_mask:0xf bank_mask:0xf
    v_mov_b32_dpp v26, v18 wave_shr:1 row_mask:0xf bank_mask:0xf
    v_mov_b32_dpp v27, v19 wave_shr:1 row_mask:0xf bank_mask:0xf
    v_lshlrev_b32 v72, 16, v16
    v_and_b32 v73, 0xffff0000, v16
    v_lshlrev_b32 v74, 16, v17
    v_and_b32 v75, 0xffff0000, v17
    v_lshlrev_b32 v76, 16, v18
    v_and_b32 v77, 0xffff0000, v18
    v_lshlrev_b32 v78, 16, v19
    v_and_b32 v79, 0xffff0000, v19
    v_mov_b32_dpp v28, v26 wave_shr:1 row_mask:0xf bank_mask:0xf
    v_mov_b32_dpp v29, v27 wave_shr:1 row_mask:0xf bank_mask:0xf
    v_lshlrev_b32 v64, 16, v24
    v_and_b32 v65, 0xffff0000, v24
    v_lshlrev_b32 v66, 16, v25
    v_and_b32 v67, 0xffff0000, v25
    v_lshlrev_b32 v68, 16, v26
    v_and_b32 v69, 0xffff0000, v26
    v_lshlrev_b32 v70, 16, v27
    v_and_b32 v71, 0xffff0000, v27
    v_lshlrev_b32 v60, 16, v28
    v_and_b32 v61, 0xffff0000, v28
    v_lshlrev_b32 v62, 16, v29
    v_and_b32 v63, 0xffff0000, v29
    v_mul_f32 v88, s72, v60
    v_mul_f32 v89, s73, v61
    v_mul_f32 v90, s74, v62
    v_mul_f32 v91, s75, v63
    v_mul_f32 v104, s72, v64
    v_mul_f32 v105, s73, v65
    v_mul_f32 v106, s74, v66
    v_mul_f32 v107, s75, v67
    v_fmac_f32 v88, s68, v64
    v_fmac_f32 v89, s69, v65
    v_fmac_f32 v90, s70, v66
    v_fmac_f32 v91, s71, v67
    v_fmac_f32 v104, s68, v68
    v_fmac_f32 v105, s69, v69
    v_fmac_f32 v106, s70, v70
    v_fmac_f32 v107, s71, v71
    v_fmac_f32 v88, s64, v68
    v_fmac_f32 v89, s65, v69
    v_fmac_f32 v90, s66, v70
    v_fmac_f32 v91, s67, v71
    v_fmac_f32 v104, s64, v72
    v_fmac_f32 v105, s65, v73
    v_fmac_f32 v106, s66, v74
    v_fmac_f32 v107, s67, v75
    v_fmac_f32 v88, s60, v72
    v_fmac_f32 v89, s61, v73
    v_fmac_f32 v90, s62, v74
    v_fmac_f32 v91, s63, v75
    v_fmac_f32 v104, s60, v76
    v_fmac_f32 v105, s61, v77
    v_fmac_f32 v106, s62, v78
    v_fmac_f32 v107, s63, v79
    s_waitcnt vmcnt(0)
    v_lshlrev_b32 v80, 16, v20
    v_and_b32 v81, 0xffff0000, v20
    v_lshlrev_b32 v82, 16, v21
    v_and_b32 v83, 0xffff0000, v21
    v_lshlrev_b32 v84, 16, v22
    v_and_b32 v85, 0xffff0000, v22
    v_lshlrev_b32 v86, 16, v23
    v_and_b32 v87, 0xffff0000, v23
    v_mul_f32 v88, v88, v80
    v_mul_f32 v89, v89, v81
    v_mul_f32 v90, v90, v82
    v_mul_f32 v91, v91, v83
    v_mul_f32 v104, v104, v84
    v_mul_f32 v105, v105, v85
    v_mul_f32 v106, v106, v86
    v_mul_f32 v107, v107, v87
    v_cvt_pk_bf16_f32 v120, v104, v88
    v_cvt_pk_bf16_f32 v121, v105, v89
    v_cvt_pk_bf16_f32 v122, v106, v90
    v_cvt_pk_bf16_f32 v123, v107, v91
    ds_write_b32 v10, v120 offset:0
    ds_write_b32 v10, v121 offset:4608
    ds_write_b32 v10, v122 offset:9216
    ds_write_b32 v10, v123 offset:13824
    s_waitcnt lgkmcnt(0)
    s_barrier
    s_setprio 3
    ds_read_b128 v[16:19], v127 offset:0
    ds_read_b128 v[20:23], v127 offset:4608
    ds_read_b128 v[24:27], v127 offset:9216
    s_waitcnt lgkmcnt(2)
    s_add_u32 s46, s45, 0
    buffer_store_dwordx4 v[16:19], v125, s[16:19], s46 offen sc1
    s_waitcnt lgkmcnt(1)
    s_add_u32 s46, s45, 589824
    buffer_store_dwordx4 v[20:23], v125, s[16:19], s46 offen sc1
    s_waitcnt lgkmcnt(0)
    s_add_u32 s46, s45, 1179648
    buffer_store_dwordx4 v[24:27], v125, s[16:19], s46 offen sc1
    s_barrier
    ds_read_b128 v[28:31], v127 offset:13824
    s_waitcnt lgkmcnt(0)
    s_add_u32 s46, s45, 1769472
    buffer_store_dwordx4 v[28:31], v125, s[16:19], s46 offen sc1
    s_endpgm
K1_OTHER_B:
    s_cmp_ge_u32 s2, 198
    s_cbranch_scc1 K1_NOGEMV
    s_waitcnt vmcnt(9)
    s_mov_b32 s46, 0xbfb8aa3b
    v_lshlrev_b32 v52, 16, v52
    v_mul_f32 v64, s46, v52
    v_lshlrev_b32 v53, 16, v53
    v_mul_f32 v65, s46, v53
    v_lshlrev_b32 v54, 16, v54
    v_mul_f32 v66, s46, v54
    v_lshlrev_b32 v55, 16, v55
    v_mul_f32 v67, s46, v55
    v_lshlrev_b32 v56, 16, v56
    v_mul_f32 v68, s46, v56
    v_lshlrev_b32 v57, 16, v57
    v_mul_f32 v69, s46, v57
    v_lshlrev_b32 v58, 16, v58
    v_mul_f32 v70, s46, v58
    v_lshlrev_b32 v59, 16, v59
    v_mul_f32 v71, s46, v59
    v_lshlrev_b32 v60, 16, v60
    v_mul_f32 v72, s46, v60
    v_exp_f32 v64, v64
    v_exp_f32 v65, v65
    v_exp_f32 v66, v66
    v_exp_f32 v67, v67
    v_exp_f32 v68, v68
    v_exp_f32 v69, v69
    v_exp_f32 v70, v70
    v_exp_f32 v71, v71
    v_exp_f32 v72, v72
    v_add_f32 v64, 1.0, v64
    v_add_f32 v65, 1.0, v65
    v_add_f32 v66, 1.0, v66
    v_add_f32 v67, 1.0, v67
    v_add_f32 v68, 1.0, v68
    v_add_f32 v69, 1.0, v69
    v_add_f32 v70, 1.0, v70
    v_add_f32 v71, 1.0, v71
    v_add_f32 v72, 1.0, v72
    v_rcp_f32 v64, v64
    v_rcp_f32 v65, v65
    v_rcp_f32 v66, v66
    v_rcp_f32 v67, v67
    v_rcp_f32 v68, v68
    v_rcp_f32 v69, v69
    v_rcp_f32 v70, v70
    v_rcp_f32 v71, v71
    v_rcp_f32 v72, v72
    v_mul_f32 v52, v52, v64
    v_mul_f32 v53, v53, v65
    v_mul_f32 v54, v54, v66
    v_mul_f32 v55, v55, v67
    v_mul_f32 v56, v56, v68
    v_mul_f32 v57, v57, v69
    v_mul_f32 v58, v58, v70
    v_mul_f32 v59, v59, v71
    v_mul_f32 v60, v60, v72
    v_cvt_pk_bf16_f32 v52, 0, v52
    v_cvt_pk_bf16_f32 v53, 0, v53
    v_cvt_pk_bf16_f32 v54, 0, v54
    v_cvt_pk_bf16_f32 v55, 0, v55
    v_cvt_pk_bf16_f32 v56, 0, v56
    v_cvt_pk_bf16_f32 v57, 0, v57
    v_cvt_pk_bf16_f32 v58, 0, v58
    v_cvt_pk_bf16_f32 v59, 0, v59
    v_cvt_pk_bf16_f32 v60, 0, v60
    s_waitcnt vmcnt(8)
    v_lshlrev_b32 v64, 16, v16
    v_and_b32 v65, 0xffff0000, v16
    v_lshlrev_b32 v66, 16, v17
    v_and_b32 v67, 0xffff0000, v17
    v_lshlrev_b32 v68, 16, v18
    v_and_b32 v69, 0xffff0000, v18
    v_lshlrev_b32 v70, 16, v19
    v_and_b32 v71, 0xffff0000, v19
    v_mul_f32 v72, v52, v64
    v_mul_f32 v73, v52, v65
    v_mul_f32 v74, v52, v66
    v_mul_f32 v75, v52, v67
    v_mul_f32 v76, v52, v68
    v_mul_f32 v77, v52, v69
    v_mul_f32 v78, v52, v70
    v_mul_f32 v79, v52, v71
    s_waitcnt vmcnt(7)
    v_lshlrev_b32 v64, 16, v20
    v_and_b32 v65, 0xffff0000, v20
    v_lshlrev_b32 v66, 16, v21
    v_and_b32 v67, 0xffff0000, v21
    v_lshlrev_b32 v68, 16, v22
    v_and_b32 v69, 0xffff0000, v22
    v_lshlrev_b32 v70, 16, v23
    v_and_b32 v71, 0xffff0000, v23
    v_fmac_f32 v72, v53, v64
    v_fmac_f32 v73, v53, v65
    v_fmac_f32 v74, v53, v66
    v_fmac_f32 v75, v53, v67
    v_fmac_f32 v76, v53, v68
    v_fmac_f32 v77, v53, v69
    v_fmac_f32 v78, v53, v70
    v_fmac_f32 v79, v53, v71
    s_waitcnt vmcnt(6)
    v_lshlrev_b32 v64, 16, v24
    v_and_b32 v65, 0xffff0000, v24
    v_lshlrev_b32 v66, 16, v25
    v_and_b32 v67, 0xffff0000, v25
    v_lshlrev_b32 v68, 16, v26
    v_and_b32 v69, 0xffff0000, v26
    v_lshlrev_b32 v70, 16, v27
    v_and_b32 v71, 0xffff0000, v27
    v_fmac_f32 v72, v54, v64
    v_fmac_f32 v73, v54, v65
    v_fmac_f32 v74, v54, v66
    v_fmac_f32 v75, v54, v67
    v_fmac_f32 v76, v54, v68
    v_fmac_f32 v77, v54, v69
    v_fmac_f32 v78, v54, v70
    v_fmac_f32 v79, v54, v71
    s_waitcnt vmcnt(5)
    buffer_load_dword a0, v8, s[52:55], s57 offen
    buffer_load_dword a1, v15, s[60:63], s59 offen
    buffer_load_dword a2, v15, s[64:67], s59 offen
    v_lshlrev_b32 v64, 16, v28
    v_and_b32 v65, 0xffff0000, v28
    v_lshlrev_b32 v66, 16, v29
    v_and_b32 v67, 0xffff0000, v29
    v_lshlrev_b32 v68, 16, v30
    v_and_b32 v69, 0xffff0000, v30
    v_lshlrev_b32 v70, 16, v31
    v_and_b32 v71, 0xffff0000, v31
    v_fmac_f32 v72, v55, v64
    v_fmac_f32 v73, v55, v65
    v_fmac_f32 v74, v55, v66
    v_fmac_f32 v75, v55, v67
    v_fmac_f32 v76, v55, v68
    v_fmac_f32 v77, v55, v69
    v_fmac_f32 v78, v55, v70
    v_fmac_f32 v79, v55, v71
    s_waitcnt vmcnt(7)
    v_lshlrev_b32 v64, 16, v32
    v_and_b32 v65, 0xffff0000, v32
    v_lshlrev_b32 v66, 16, v33
    v_and_b32 v67, 0xffff0000, v33
    v_lshlrev_b32 v68, 16, v34
    v_and_b32 v69, 0xffff0000, v34
    v_lshlrev_b32 v70, 16, v35
    v_and_b32 v71, 0xffff0000, v35
    v_fmac_f32 v72, v56, v64
    v_fmac_f32 v73, v56, v65
    v_fmac_f32 v74, v56, v66
    v_fmac_f32 v75, v56, v67
    v_fmac_f32 v76, v56, v68
    v_fmac_f32 v77, v56, v69
    v_fmac_f32 v78, v56, v70
    v_fmac_f32 v79, v56, v71
    s_waitcnt vmcnt(6)
    v_lshlrev_b32 v64, 16, v36
    v_and_b32 v65, 0xffff0000, v36
    v_lshlrev_b32 v66, 16, v37
    v_and_b32 v67, 0xffff0000, v37
    v_lshlrev_b32 v68, 16, v38
    v_and_b32 v69, 0xffff0000, v38
    v_lshlrev_b32 v70, 16, v39
    v_and_b32 v71, 0xffff0000, v39
    v_fmac_f32 v72, v57, v64
    v_fmac_f32 v73, v57, v65
    v_fmac_f32 v74, v57, v66
    v_fmac_f32 v75, v57, v67
    v_fmac_f32 v76, v57, v68
    v_fmac_f32 v77, v57, v69
    v_fmac_f32 v78, v57, v70
    v_fmac_f32 v79, v57, v71
    s_waitcnt vmcnt(5)
    v_lshlrev_b32 v64, 16, v40
    v_and_b32 v65, 0xffff0000, v40
    v_lshlrev_b32 v66, 16, v41
    v_and_b32 v67, 0xffff0000, v41
    v_lshlrev_b32 v68, 16, v42
    v_and_b32 v69, 0xffff0000, v42
    v_lshlrev_b32 v70, 16, v43
    v_and_b32 v71, 0xffff0000, v43
    v_fmac_f32 v72, v58, v64
    v_fmac_f32 v73, v58, v65
    v_fmac_f32 v74, v58, v66
    v_fmac_f32 v75, v58, v67
    v_fmac_f32 v76, v58, v68
    v_fmac_f32 v77, v58, v69
    v_fmac_f32 v78, v58, v70
    v_fmac_f32 v79, v58, v71
    s_waitcnt vmcnt(4)
    v_lshlrev_b32 v64, 16, v44
    v_and_b32 v65, 0xffff0000, v44
    v_lshlrev_b32 v66, 16, v45
    v_and_b32 v67, 0xffff0000, v45
    v_lshlrev_b32 v68, 16, v46
    v_and_b32 v69, 0xffff0000, v46
    v_lshlrev_b32 v70, 16, v47
    v_and_b32 v71, 0xffff0000, v47
    v_fmac_f32 v72, v59, v64
    v_fmac_f32 v73, v59, v65
    v_fmac_f32 v74, v59, v66
    v_fmac_f32 v75, v59, v67
    v_fmac_f32 v76, v59, v68
    v_fmac_f32 v77, v59, v69
    v_fmac_f32 v78, v59, v70
    v_fmac_f32 v79, v59, v71
    s_waitcnt vmcnt(3)
    v_lshlrev_b32 v64, 16, v48
    v_and_b32 v65, 0xffff0000, v48
    v_lshlrev_b32 v66, 16, v49
    v_and_b32 v67, 0xffff0000, v49
    v_lshlrev_b32 v68, 16, v50
    v_and_b32 v69, 0xffff0000, v50
    v_lshlrev_b32 v70, 16, v51
    v_and_b32 v71, 0xffff0000, v51
    v_fmac_f32 v72, v60, v64
    v_fmac_f32 v73, v60, v65
    v_fmac_f32 v74, v60, v66
    v_fmac_f32 v75, v60, v67
    v_fmac_f32 v76, v60, v68
    v_fmac_f32 v77, v60, v69
    v_fmac_f32 v78, v60, v70
    v_fmac_f32 v79, v60, v71
    v_lshlrev_b32 v7, 5, v0
    ds_write_b128 v7, v[72:75]
    ds_write_b128 v7, v[76:79] offset:16
    s_waitcnt lgkmcnt(0)
    s_barrier
    v_lshlrev_b32 v8, 2, v2
    v_lshl_add_u32 v8, v1, 11, v8
    ds_read_b32 v16, v8 offset:0
    ds_read_b32 v17, v8 offset:256
    ds_read_b32 v18, v8 offset:512
    ds_read_b32 v19, v8 offset:768
    ds_read_b32 v20, v8 offset:1024
    ds_read_b32 v21, v8 offset:1280
    ds_read_b32 v22, v8 offset:1536
    ds_read_b32 v23, v8 offset:1792
    s_waitcnt lgkmcnt(0)
    v_add_f32 v16, v16, v17
    v_add_f32 v16, v16, v18
    v_add_f32 v16, v16, v19
    v_add_f32 v16, v16, v20
    v_add_f32 v16, v16, v21
    v_add_f32 v16, v16, v22
    v_add_f32 v16, v16, v23
    v_lshlrev_b32 v9, 2, v0
    ds_write_b32 v9, v16 offset:16384
    s_waitcnt lgkmcnt(0)
    s_barrier
    s_cmp_lg_u32 s28, 0
    s_cbranch_scc1 K1_DONE
    v_lshlrev_b32 v8, 2, v2
    ds_read_b32 v16, v8 offset:16384
    ds_read_b32 v17, v8 offset:16640
    ds_read_b32 v18, v8 offset:16896
    ds_read_b32 v19, v8 offset:17152
    ds_read_b32 v20, v8 offset:17408
    ds_read_b32 v21, v8 offset:17664
    ds_read_b32 v22, v8 offset:17920
    ds_read_b32 v23, v8 offset:18176
    s_waitcnt lgkmcnt(0)
    v_add_f32 v16, v16, v17
    v_add_f32 v16, v16, v18
    v_add_f32 v16, v16, v19
    v_add_f32 v16, v16, v20
    v_add_f32 v16, v16, v21
    v_add_f32 v16, v16, v22
    v_add_f32 v16, v16, v23
    s_sub_u32 s46, s2, 153
    s_cmp_lt_u32 s46, 9
    s_cselect_b32 s47, 1.0, 0
    s_sub_u32 s46, s2, 180
    s_cmp_lt_u32 s46, 9
    s_cselect_b32 s47, 1.0, s47
    v_cvt_pk_bf16_f32 v16, 0, v16
    v_add_f32 v16, s47, v16
    v_cvt_pk_bf16_f32 v16, v16, v16
    v_lshlrev_b32 v8, 1, v2
    buffer_store_short v16, v8, s[40:43], s69 offen sc1
    s_branch K1_DONE
K1_NOGEMV:
    buffer_load_dword a0, v8, s[52:55], s57 offen
    buffer_load_dword a1, v15, s[60:63], s59 offen
    buffer_load_dword a2, v15, s[64:67], s59 offen
    s_cmp_eq_u32 s71, 0
    s_cbranch_scc1 K1_DONE
    s_waitcnt vmcnt(3)
    v_lshlrev_b32 v56, 16, v16
    v_and_b32 v57, 0xffff0000, v16
    v_lshlrev_b32 v58, 16, v17
    v_and_b32 v59, 0xffff0000, v17
    v_lshlrev_b32 v60, 16, v18
    v_and_b32 v61, 0xffff0000, v18
    v_lshlrev_b32 v62, 16, v19
    v_and_b32 v63, 0xffff0000, v19
    v_lshlrev_b32 v64, 16, v20
    v_and_b32 v65, 0xffff0000, v20
    v_lshlrev_b32 v66, 16, v21
    v_and_b32 v67, 0xffff0000, v21
    v_lshlrev_b32 v68, 16, v22
    v_and_b32 v69, 0xffff0000, v22
    v_lshlrev_b32 v70, 16, v23
    v_and_b32 v71, 0xffff0000, v23
    v_lshlrev_b32 v72, 16, v24
    v_and_b32 v73, 0xffff0000, v24
    v_lshlrev_b32 v74, 16, v25
    v_and_b32 v75, 0xffff0000, v25
    v_lshlrev_b32 v76, 16, v26
    v_and_b32 v77, 0xffff0000, v26
    v_lshlrev_b32 v78, 16, v27
    v_and_b32 v79, 0xffff0000, v27
    v_lshlrev_b32 v80, 16, v28
    v_and_b32 v81, 0xffff0000, v28
    v_lshlrev_b32 v82, 16, v29
    v_and_b32 v83, 0xffff0000, v29
    v_lshlrev_b32 v84, 16, v30
    v_and_b32 v85, 0xffff0000, v30
    v_lshlrev_b32 v86, 16, v31
    v_and_b32 v87, 0xffff0000, v31
    v_lshlrev_b32 v88, 16, v32
    v_and_b32 v89, 0xffff0000, v32
    v_lshlrev_b32 v90, 16, v33
    v_and_b32 v91, 0xffff0000, v33
    v_lshlrev_b32 v92, 16, v34
    v_and_b32 v93, 0xffff0000, v34
    v_lshlrev_b32 v94, 16, v35
    v_and_b32 v95, 0xffff0000, v35
    v_lshlrev_b32 v96, 16, v36
    v_and_b32 v97, 0xffff0000, v36
    v_lshlrev_b32 v98, 16, v37
    v_and_b32 v99, 0xffff0000, v37
    v_lshlrev_b32 v100, 16, v38
    v_and_b32 v101, 0xffff0000, v38
    v_lshlrev_b32 v102, 16, v39
    v_and_b32 v103, 0xffff0000, v39
    v_lshlrev_b32 v104, 16, v40
    v_and_b32 v105, 0xffff0000, v40
    v_lshlrev_b32 v106, 16, v41
    v_and_b32 v107, 0xffff0000, v41
    v_lshlrev_b32 v108, 16, v42
    v_and_b32 v109, 0xffff0000, v42
    v_lshlrev_b32 v110, 16, v43
    v_and_b32 v111, 0xffff0000, v43
    v_lshlrev_b32 v112, 16, v44
    v_and_b32 v113, 0xffff0000, v44
    v_lshlrev_b32 v114, 16, v45
    v_and_b32 v115, 0xffff0000, v45
    v_lshlrev_b32 v116, 16, v46
    v_and_b32 v117, 0xffff0000, v46
    v_lshlrev_b32 v118, 16, v47
    v_and_b32 v119, 0xffff0000, v47
    v_lshlrev_b32 v120, 16, v48
    v_and_b32 v121, 0xffff0000, v48
    v_lshlrev_b32 v122, 16, v49
    v_and_b32 v123, 0xffff0000, v49
    v_lshlrev_b32 v124, 16, v50
    v_and_b32 v125, 0xffff0000, v50
    v_lshlrev_b32 v126, 16, v51
    v_and_b32 v127, 0xffff0000, v51
    v_pk_add_f32 v[12:13], v[56:57], v[58:59]
    v_pk_mul_f32 v[14:15], v[56:57], v[56:57]
    v_pk_fma_f32 v[14:15], v[58:59], v[58:59], v[14:15]
    v_pk_add_f32 v[12:13], v[12:13], v[60:61]
    v_pk_fma_f32 v[14:15], v[60:61], v[60:61], v[14:15]
    v_pk_add_f32 v[12:13], v[12:13], v[62:63]
    v_pk_fma_f32 v[14:15], v[62:63], v[62:63], v[14:15]
    v_pk_add_f32 v[12:13], v[12:13], v[64:65]
    v_pk_fma_f32 v[14:15], v[64:65], v[64:65], v[14:15]
    v_pk_add_f32 v[12:13], v[12:13], v[66:67]
    v_pk_fma_f32 v[14:15], v[66:67], v[66:67], v[14:15]
    v_pk_add_f32 v[12:13], v[12:13], v[68:69]
    v_pk_fma_f32 v[14:15], v[68:69], v[68:69], v[14:15]
    v_pk_add_f32 v[12:13], v[12:13], v[70:71]
    v_pk_fma_f32 v[14:15], v[70:71], v[70:71], v[14:15]
    v_pk_add_f32 v[12:13], v[12:13], v[72:73]
    v_pk_fma_f32 v[14:15], v[72:73], v[72:73], v[14:15]
    v_pk_add_f32 v[12:13], v[12:13], v[74:75]
    v_pk_fma_f32 v[14:15], v[74:75], v[74:75], v[14:15]
    v_pk_add_f32 v[12:13], v[12:13], v[76:77]
    v_pk_fma_f32 v[14:15], v[76:77], v[76:77], v[14:15]
    v_pk_add_f32 v[12:13], v[12:13], v[78:79]
    v_pk_fma_f32 v[14:15], v[78:79], v[78:79], v[14:15]
    v_pk_add_f32 v[12:13], v[12:13], v[80:81]
    v_pk_fma_f32 v[14:15], v[80:81], v[80:81], v[14:15]
    v_pk_add_f32 v[12:13], v[12:13], v[82:83]
    v_pk_fma_f32 v[14:15], v[82:83], v[82:83], v[14:15]
    v_pk_add_f32 v[12:13], v[12:13], v[84:85]
    v_pk_fma_f32 v[14:15], v[84:85], v[84:85], v[14:15]
    v_pk_add_f32 v[12:13], v[12:13], v[86:87]
    v_pk_fma_f32 v[14:15], v[86:87], v[86:87], v[14:15]
    v_pk_add_f32 v[12:13], v[12:13], v[88:89]
    v_pk_fma_f32 v[14:15], v[88:89], v[88:89], v[14:15]
    v_pk_add_f32 v[12:13], v[12:13], v[90:91]
    v_pk_fma_f32 v[14:15], v[90:91], v[90:91], v[14:15]
    v_pk_add_f32 v[12:13], v[12:13], v[92:93]
    v_pk_fma_f32 v[14:15], v[92:93], v[92:93], v[14:15]
    v_pk_add_f32 v[12:13], v[12:13], v[94:95]
    v_pk_fma_f32 v[14:15], v[94:95], v[94:95], v[14:15]
    v_pk_add_f32 v[12:13], v[12:13], v[96:97]
    v_pk_fma_f32 v[14:15], v[96:97], v[96:97], v[14:15]
    v_pk_add_f32 v[12:13], v[12:13], v[98:99]
    v_pk_fma_f32 v[14:15], v[98:99], v[98:99], v[14:15]
    v_pk_add_f32 v[12:13], v[12:13], v[100:101]
    v_pk_fma_f32 v[14:15], v[100:101], v[100:101], v[14:15]
    v_pk_add_f32 v[12:13], v[12:13], v[102:103]
    v_pk_fma_f32 v[14:15], v[102:103], v[102:103], v[14:15]
    v_pk_add_f32 v[12:13], v[12:13], v[104:105]
    v_pk_fma_f32 v[14:15], v[104:105], v[104:105], v[14:15]
    v_pk_add_f32 v[12:13], v[12:13], v[106:107]
    v_pk_fma_f32 v[14:15], v[106:107], v[106:107], v[14:15]
    v_pk_add_f32 v[12:13], v[12:13], v[108:109]
    v_pk_fma_f32 v[14:15], v[108:109], v[108:109], v[14:15]
    v_pk_add_f32 v[12:13], v[12:13], v[110:111]
    v_pk_fma_f32 v[14:15], v[110:111], v[110:111], v[14:15]
    v_pk_add_f32 v[12:13], v[12:13], v[112:113]
    v_pk_fma_f32 v[14:15], v[112:113], v[112:113], v[14:15]
    v_pk_add_f32 v[12:13], v[12:13], v[114:115]
    v_pk_fma_f32 v[14:15], v[114:115], v[114:115], v[14:15]
    v_pk_add_f32 v[12:13], v[12:13], v[116:117]
    v_pk_fma_f32 v[14:15], v[116:117], v[116:117], v[14:15]
    v_pk_add_f32 v[12:13], v[12:13], v[118:119]
    v_pk_fma_f32 v[14:15], v[118:119], v[118:119], v[14:15]
    v_pk_add_f32 v[12:13], v[12:13], v[120:121]
    v_pk_fma_f32 v[14:15], v[120:121], v[120:121], v[14:15]
    v_pk_add_f32 v[12:13], v[12:13], v[122:123]
    v_pk_fma_f32 v[14:15], v[122:123], v[122:123], v[14:15]
    v_pk_add_f32 v[12:13], v[12:13], v[124:125]
    v_pk_fma_f32 v[14:15], v[124:125], v[124:125], v[14:15]
    v_pk_add_f32 v[12:13], v[12:13], v[126:127]
    v_pk_fma_f32 v[14:15], v[126:127], v[126:127], v[14:15]
    v_add_f32 v12, v12, v13
    v_add_f32 v13, v14, v15
    s_nop 1
    v_add_f32_dpp v12, v12, v12 quad_perm:[1,0,3,2] row_mask:0xf bank_mask:0xf
    v_add_f32_dpp v13, v13, v13 quad_perm:[1,0,3,2] row_mask:0xf bank_mask:0xf
    s_nop 1
    v_add_f32_dpp v12, v12, v12 quad_perm:[2,3,0,1] row_mask:0xf bank_mask:0xf
    v_add_f32_dpp v13, v13, v13 quad_perm:[2,3,0,1] row_mask:0xf bank_mask:0xf
    s_nop 1
    v_add_f32_dpp v12, v12, v12 row_half_mirror row_mask:0xf bank_mask:0xf
    v_add_f32_dpp v13, v13, v13 row_half_mirror row_mask:0xf bank_mask:0xf
    s_mov_b32 s58, 0x3ae38e39
    s_mov_b32 s59, 0x3727c5ac
    v_mul_f32 v12, s58, v12
    v_mul_f32 v13, s58, v13
    v_fma_f32 v13, -v12, v12, v13
    v_max_f32 v13, 0, v13
    v_cvt_pk_bf16_f32 v13, 0, v13
    v_add_f32 v13, s59, v13
    v_cvt_pk_bf16_f32 v13, 0, v13
    v_sqrt_f32 v13, v13
    v_cvt_pk_bf16_f32 v12, 0, v12
    v_cvt_pk_bf16_f32 v13, 0, v13
    v_rcp_f32 v14, v13
    v_lshrrev_b32 v10, 3, v2
    v_lshlrev_b32 v10, 3, v10
    v_mul_f32 v15, -v12, v14
    s_mul_hi_u32 s56, s56, 0x1c71c72
    buffer_store_dwordx2 v[14:15], v10, s[48:51], s56 offen sc1
K1_DONE:
    s_endpgm
K1_END:
    s_endpgm
    .p2align 12
CODE_PF_BEGIN:
    .globl mlp_kernel
    .p2align 12
    .type mlp_kernel,@function
mlp_kernel:
    s_cmp_ge_u32 s2, 256
    s_cbranch_scc1 K3_END
    s_load_dwordx4 s[4:7], s[0:1], 56
    s_load_dwordx2 s[8:9], s[0:1], 72
    s_load_dwordx2 s[10:11], s[0:1], 112
    s_load_dwordx2 s[64:65], s[0:1], 96
    s_load_dwordx2 s[20:21], s[0:1], 0
    v_lshrrev_b32 v1, 6, v0
    v_and_b32 v2, 63, v0
    v_readfirstlane_b32 s28, v1
    s_and_b32 s29, s2, 7
    s_lshl_b32 s29, s29, 1
    s_bfe_u32 s30, s2, 0x10003
    s_add_u32 s29, s29, s30
    s_lshr_b32 s31, s2, 4
    s_lshl_b32 s41, s31, 2
    s_mov_b32 s62, 47251456
    s_mov_b32 s63, 0x20000
    s_mov_b32 s66, 2359296
    s_mov_b32 s67, 0x20000
    s_mov_b32 s22, 2359296
    s_mov_b32 s23, 0x20000
    s_lshl_b32 s68, s31, 9
    s_add_u32 s68, s68, 16384
    v_mov_b32 v254, 1
    v_mov_b32 v250, 0
    v_and_b32 v7, 7, v2
    v_lshrrev_b32 v6, 3, v2
    v_lshlrev_b32 v252, 4, v6
    v_lshlrev_b32 v8, 9, v6
    v_lshl_add_u32 v251, v7, 4, v8
    v_mul_u32_u24 v8, 1152, v7
    v_add_u32 v253, v8, v252
    v_lshlrev_b32 v13, 3, v7
    v_lshlrev_b32 v14, 5, v2
    s_lshr_b32 s69, s29, 2
    s_add_u32 s69, s69, s41
    s_mul_i32 s69, s69, 36864
    s_and_b32 s70, s29, 3
    s_lshl_b32 s70, s70, 7
    s_add_u32 s69, s69, s70
    s_lshl_b32 s71, s31, 4
    s_add_u32 s71, s71, s29
    s_mul_i32 s70, s71, 9216
    s_lshr_b32 s77, s71, 1
    s_mul_i32 s77, s77, 18432
    s_lshl_b32 s78, s30, 4
    s_add_u32 s77, s77, s78
    s_add_u32 s77, s77, 65536
    s_lshl_b32 s78, s71, 6
    s_add_u32 s78, s78, 7143424
    s_lshl_b32 s71, s28, 2
    s_lshr_b32 s73, 0x8764, s71
    s_and_b32 s73, s73, 15
    s_cmp_eq_u32 s28, 0
    s_cselect_b32 s72, 5, 0x60000
    s_mul_i32 s79, s28, 3072
    s_waitcnt lgkmcnt(0)
    s_mov_b32 s60, s10
    s_mov_b32 s61, s11
    buffer_load_dwordx2 v[100:101], v13, s[60:63], s78 offen
    s_add_u32 m0, s79, 0
    s_lshl_b32 s74, s28, 11
    s_add_u32 s74, s74, s77
    buffer_load_dwordx4 v14, s[60:63], s74 offen lds
    s_lshl_b32 s74, s28, 7
    s_add_u32 s75, s74, s70
    buffer_load_dwordx4 v[16:19], v253, s[20:23], s75 offen
    buffer_load_dwordx4 v[20:23], v252, s[60:63], s74 offen offset:1152
    buffer_load_dwordx4 v[24:27], v252, s[60:63], s74 offen
    buffer_load_dwordx4 v[28:31], v252, s[60:63], s74 offen offset:2304
    s_add_u32 m0, s79, 1024
    s_lshl_b32 s74, s73, 11
    s_add_u32 s74, s74, s77
    buffer_load_dwordx4 v14, s[60:63], s74 offen lds
    s_lshl_b32 s74, s73, 7
    s_add_u32 s75, s74, s70
    buffer_load_dwordx4 v[44:47], v253, s[20:23], s75 offen
    buffer_load_dwordx4 v[48:51], v252, s[60:63], s74 offen offset:1152
    buffer_load_dwordx4 v[52:55], v252, s[60:63], s74 offen
    buffer_load_dwordx4 v[56:59], v252, s[60:63], s74 offen offset:2304
    s_add_u32 m0, s79, 2048
    s_lshl_b32 s74, s72, 11
    s_add_u32 s74, s74, s77
    buffer_load_dwordx4 v14, s[60:63], s74 offen lds
    s_lshl_b32 s74, s72, 7
    s_add_u32 s75, s74, s70
    buffer_load_dwordx4 v[72:75], v253, s[20:23], s75 offen
    buffer_load_dwordx4 v[76:79], v252, s[60:63], s74 offen offset:1152
    buffer_load_dwordx4 v[80:83], v252, s[60:63], s74 offen
    buffer_load_dwordx4 v[84:87], v252, s[60:63], s74 offen offset:2304
    s_lshl_b32 s74, s28, 7
    s_add_u32 s75, s74, 3456
    buffer_load_dwordx4 v[32:35], v252, s[60:63], s75 offen offset:1152
    buffer_load_dwordx4 v[36:39], v252, s[60:63], s75 offen
    s_lshl_b32 s74, s73, 7
    s_add_u32 s75, s74, 3456
    buffer_load_dwordx4 v[60:63], v252, s[60:63], s75 offen offset:1152
    buffer_load_dwordx4 v[64:67], v252, s[60:63], s75 offen
    s_lshl_b32 s74, s72, 7
    s_add_u32 s75, s74, 3456
    buffer_load_dwordx4 v[88:91], v252, s[60:63], s75 offen offset:1152
    buffer_load_dwordx4 v[92:95], v252, s[60:63], s75 offen
    s_mul_i32 s32, s29, 288
    s_lshl_b32 s33, s30, 5
    s_add_u32 s33, s33, s32
    s_xor_b32 s34, s30, 1
    s_lshl_b32 s34, s34, 8
    s_add_u32 s34, s34, s32
    s_lshl_b32 s36, s33, 1
    s_lshl_b32 s37, s34, 1
    s_mul_i32 s38, s33, 1152
    s_mul_i32 s39, s34, 1152
    s_lshl_b32 s40, s28, 10
    s_and_b32 s35, s28, 1
    s_lshl_b32 s41, s31, 2
    s_add_u32 s56, s41, s28
    s_xor_b32 s57, s56, 1
    s_mul_i32 s56, s56, 36864
    s_mul_i32 s57, s57, 36864
    v_lshrrev_b32 v3, 3, v2
    s_lshl_b32 s44, s28, 3
    v_add_u32 v3, s44, v3
    v_and_b32 v4, 7, v2
    v_and_b32 v5, 2, v3
    v_lshrrev_b32 v6, 1, v3
    v_and_b32 v6, 4, v6
    v_or_b32 v5, v5, v6
    v_xor_b32 v5, v5, v4
    v_mul_u32_u24 v6, 9216, v3
    v_lshl_add_u32 v233, v5, 4, v6
    v_bfe_u32 v5, v3, 1, 1
    v_and_b32 v6, 4, v3
    v_or_b32 v5, v5, v6
    v_xor_b32 v5, v5, v4
    v_mul_u32_u24 v6, 1152, v3
    v_lshl_add_u32 v235, v5, 4, v6
    v_lshrrev_b32 v5, 4, v2
    v_and_b32 v6, 15, v2
    v_lshlrev_b32 v5, 9, v5
    v_lshl_add_u32 v236, v6, 4, v5
    s_mov_b32 s14, 5308416
    s_mov_b32 s15, 0x20000
    s_mov_b32 s18, 5308416
    s_mov_b32 s19, 0x20000
    s_mov_b32 s26, 2359296
    s_mov_b32 s27, 0x20000
    s_mov_b32 s12, s4
    s_mov_b32 s13, s5
    s_mov_b32 s16, s6
    s_mov_b32 s17, s7
    s_add_u32 s24, s10, 2424832
    s_addc_u32 s25, s11, 0
    s_add_u32 m0, s40, 159744
    s_add_u32 s45, s36, 0
    buffer_load_dwordx4 v233, s[12:15], s45 offen  lds
    s_add_u32 m0, s40, 155648
    s_add_u32 s45, s36, 0
    buffer_load_dwordx4 v233, s[16:19], s45 offen  lds
    s_add_u32 m0, s40, 151552
    s_add_u32 s45, s36, 294912
    buffer_load_dwordx4 v233, s[12:15], s45 offen  lds
    s_add_u32 m0, s40, 147456
    s_add_u32 s45, s36, 294912
    buffer_load_dwordx4 v233, s[16:19], s45 offen  lds
    s_add_u32 m0, s40, 143360
    s_add_u32 s45, s36, 589824
    buffer_load_dwordx4 v233, s[12:15], s45 offen  lds
    s_add_u32 m0, s40, 139264
    s_add_u32 s45, s36, 589824
    buffer_load_dwordx4 v233, s[16:19], s45 offen  lds
    s_add_u32 m0, s40, 135168
    s_add_u32 s45, s36, 884736
    buffer_load_dwordx4 v233, s[12:15], s45 offen  lds
    s_add_u32 m0, s40, 131072
    s_add_u32 s45, s36, 884736
    buffer_load_dwordx4 v233, s[16:19], s45 offen  lds
    v_and_b32 v190, 3, v2
    v_bfe_u32 v191, v2, 2, 2
    v_lshrrev_b32 v192, 4, v2
    v_lshlrev_b32 v186, 8, v192
    v_lshl_add_u32 v186, v191, 4, v186
    v_lshrrev_b32 v191, 1, v190
    v_lshl_add_u32 v186, v191, 7, v186
    v_and_b32 v191, 1, v190
    v_lshl_add_u32 v186, v191, 3, v186
    v_add_u32 v186, s79, v186
    v_lshlrev_b32 v188, 2, v13
    s_lshl_b32 s74, s28, 3
    v_add_u32 v187, s74, v188
    s_mov_b32 s74, 0x3ae38e39
    s_mov_b32 s75, 0x3727c5ac
    s_waitcnt vmcnt(24)
    ds_read_b64_tr_b16 v[40:41], v186 offset:0
    ds_read_b64_tr_b16 v[42:43], v186 offset:64
    v_lshlrev_b32 v104, 16, v16
    v_and_b32 v105, 0xffff0000, v16
    v_lshlrev_b32 v106, 16, v17
    v_and_b32 v107, 0xffff0000, v17
    v_lshlrev_b32 v108, 16, v18
    v_and_b32 v109, 0xffff0000, v18
    v_lshlrev_b32 v110, 16, v19
    v_and_b32 v111, 0xffff0000, v19
    v_fma_f32 v128, v104, v100, v101
    v_fma_f32 v129, v105, v100, v101
    v_fma_f32 v130, v106, v100, v101
    v_fma_f32 v131, v107, v100, v101
    v_fma_f32 v132, v108, v100, v101
    v_fma_f32 v133, v109, v100, v101
    v_fma_f32 v134, v110, v100, v101
    v_fma_f32 v135, v111, v100, v101
    v_lshlrev_b32 v136, 16, v20
    v_and_b32 v137, 0xffff0000, v20
    v_lshlrev_b32 v138, 16, v21
    v_and_b32 v139, 0xffff0000, v21
    v_lshlrev_b32 v140, 16, v22
    v_and_b32 v141, 0xffff0000, v22
    v_lshlrev_b32 v142, 16, v23
    v_and_b32 v143, 0xffff0000, v23
    v_lshlrev_b32 v144, 16, v24
    v_and_b32 v145, 0xffff0000, v24
    v_lshlrev_b32 v146, 16, v25
    v_and_b32 v147, 0xffff0000, v25
    v_lshlrev_b32 v148, 16, v26
    v_and_b32 v149, 0xffff0000, v26
    v_lshlrev_b32 v150, 16, v27
    v_and_b32 v151, 0xffff0000, v27
    v_pk_fma_f32 v[128:129], v[128:129], v[136:137], v[144:145]
    v_pk_fma_f32 v[130:131], v[130:131], v[138:139], v[146:147]
    v_pk_fma_f32 v[132:133], v[132:133], v[140:141], v[148:149]
    v_pk_fma_f32 v[134:135], v[134:135], v[142:143], v[150:151]
    v_lshlrev_b32 v136, 16, v28
    v_and_b32 v137, 0xffff0000, v28
    v_lshlrev_b32 v138, 16, v29
    v_and_b32 v139, 0xffff0000, v29
    v_lshlrev_b32 v140, 16, v30
    v_and_b32 v141, 0xffff0000, v30
    v_lshlrev_b32 v142, 16, v31
    v_and_b32 v143, 0xffff0000, v31
    s_waitcnt lgkmcnt(0)
    v_lshlrev_b32 v152, 16, v40
    v_and_b32 v153, 0xffff0000, v40
    v_lshlrev_b32 v154, 16, v41
    v_and_b32 v155, 0xffff0000, v41
    v_lshlrev_b32 v156, 16, v42
    v_and_b32 v157, 0xffff0000, v42
    v_lshlrev_b32 v158, 16, v43
    v_and_b32 v159, 0xffff0000, v43
    v_pk_mul_f32 v[128:129], v[128:129], v[152:153]
    v_pk_mul_f32 v[130:131], v[130:131], v[154:155]
    v_pk_mul_f32 v[132:133], v[132:133], v[156:157]
    v_pk_mul_f32 v[134:135], v[134:135], v[158:159]
    v_pk_fma_f32 v[104:105], v[128:129], v[136:137], v[104:105]
    v_pk_fma_f32 v[106:107], v[130:131], v[138:139], v[106:107]
    v_pk_fma_f32 v[108:109], v[132:133], v[140:141], v[108:109]
    v_pk_fma_f32 v[110:111], v[134:135], v[142:143], v[110:111]
    v_cvt_pk_bf16_f32 v4, v104, v105
    v_cvt_pk_bf16_f32 v5, v106, v107
    v_cvt_pk_bf16_f32 v6, v108, v109
    v_cvt_pk_bf16_f32 v7, v110, v111
    v_lshlrev_b32 v104, 16, v4
    v_and_b32 v105, 0xffff0000, v4
    v_lshlrev_b32 v106, 16, v5
    v_and_b32 v107, 0xffff0000, v5
    v_lshlrev_b32 v108, 16, v6
    v_and_b32 v109, 0xffff0000, v6
    v_lshlrev_b32 v110, 16, v7
    v_and_b32 v111, 0xffff0000, v7
    v_pk_mul_f32 v[184:185], v[104:105], v[104:105]
    v_pk_add_f32 v[182:183], v[104:105], v[106:107]
    v_pk_fma_f32 v[184:185], v[106:107], v[106:107], v[184:185]
    v_pk_add_f32 v[182:183], v[182:183], v[108:109]
    v_pk_fma_f32 v[184:185], v[108:109], v[108:109], v[184:185]
    v_pk_add_f32 v[182:183], v[182:183], v[110:111]
    v_pk_fma_f32 v[184:185], v[110:111], v[110:111], v[184:185]
    s_waitcnt vmcnt(19)
    ds_read_b64_tr_b16 v[68:69], v186 offset:1024
    ds_read_b64_tr_b16 v[70:71], v186 offset:1088
    v_lshlrev_b32 v112, 16, v44
    v_and_b32 v113, 0xffff0000, v44
    v_lshlrev_b32 v114, 16, v45
    v_and_b32 v115, 0xffff0000, v45
    v_lshlrev_b32 v116, 16, v46
    v_and_b32 v117, 0xffff0000, v46
    v_lshlrev_b32 v118, 16, v47
    v_and_b32 v119, 0xffff0000, v47
    v_fma_f32 v128, v112, v100, v101
    v_fma_f32 v129, v113, v100, v101
    v_fma_f32 v130, v114, v100, v101
    v_fma_f32 v131, v115, v100, v101
    v_fma_f32 v132, v116, v100, v101
    v_fma_f32 v133, v117, v100, v101
    v_fma_f32 v134, v118, v100, v101
    v_fma_f32 v135, v119, v100, v101
    v_lshlrev_b32 v136, 16, v48
    v_and_b32 v137, 0xffff0000, v48
    v_lshlrev_b32 v138, 16, v49
    v_and_b32 v139, 0xffff0000, v49
    v_lshlrev_b32 v140, 16, v50
    v_and_b32 v141, 0xffff0000, v50
    v_lshlrev_b32 v142, 16, v51
    v_and_b32 v143, 0xffff0000, v51
    v_lshlrev_b32 v144, 16, v52
    v_and_b32 v145, 0xffff0000, v52
    v_lshlrev_b32 v146, 16, v53
    v_and_b32 v147, 0xffff0000, v53
    v_lshlrev_b32 v148, 16, v54
    v_and_b32 v149, 0xffff0000, v54
    v_lshlrev_b32 v150, 16, v55
    v_and_b32 v151, 0xffff0000, v55
    v_pk_fma_f32 v[128:129], v[128:129], v[136:137], v[144:145]
    v_pk_fma_f32 v[130:131], v[130:131], v[138:139], v[146:147]
    v_pk_fma_f32 v[132:133], v[132:133], v[140:141], v[148:149]
    v_pk_fma_f32 v[134:135], v[134:135], v[142:143], v[150:151]
    v_lshlrev_b32 v136, 16, v56
    v_and_b32 v137, 0xffff0000, v56
    v_lshlrev_b32 v138, 16, v57
    v_and_b32 v139, 0xffff0000, v57
    v_lshlrev_b32 v140, 16, v58
    v_and_b32 v141, 0xffff0000, v58
    v_lshlrev_b32 v142, 16, v59
    v_and_b32 v143, 0xffff0000, v59
    s_waitcnt lgkmcnt(0)
    v_lshlrev_b32 v152, 16, v68
    v_and_b32 v153, 0xffff0000, v68
    v_lshlrev_b32 v154, 16, v69
    v_and_b32 v155, 0xffff0000, v69
    v_lshlrev_b32 v156, 16, v70
    v_and_b32 v157, 0xffff0000, v70
    v_lshlrev_b32 v158, 16, v71
    v_and_b32 v159, 0xffff0000, v71
    v_pk_mul_f32 v[128:129], v[128:129], v[152:153]
    v_pk_mul_f32 v[130:131], v[130:131], v[154:155]
    v_pk_mul_f32 v[132:133], v[132:133], v[156:157]
    v_pk_mul_f32 v[134:135], v[134:135], v[158:159]
    v_pk_fma_f32 v[112:113], v[128:129], v[136:137], v[112:113]
    v_pk_fma_f32 v[114:115], v[130:131], v[138:139], v[114:115]
    v_pk_fma_f32 v[116:117], v[132:133], v[140:141], v[116:117]
    v_pk_fma_f32 v[118:119], v[134:135], v[142:143], v[118:119]
    v_cvt_pk_bf16_f32 v8, v112, v113
    v_cvt_pk_bf16_f32 v9, v114, v115
    v_cvt_pk_bf16_f32 v10, v116, v117
    v_cvt_pk_bf16_f32 v11, v118, v119
    v_lshlrev_b32 v112, 16, v8
    v_and_b32 v113, 0xffff0000, v8
    v_lshlrev_b32 v114, 16, v9
    v_and_b32 v115, 0xffff0000, v9
    v_lshlrev_b32 v116, 16, v10
    v_and_b32 v117, 0xffff0000, v10
    v_lshlrev_b32 v118, 16, v11
    v_and_b32 v119, 0xffff0000, v11
    v_pk_add_f32 v[182:183], v[182:183], v[112:113]
    v_pk_fma_f32 v[184:185], v[112:113], v[112:113], v[184:185]
    v_pk_add_f32 v[182:183], v[182:183], v[114:115]
    v_pk_fma_f32 v[184:185], v[114:115], v[114:115], v[184:185]
    v_pk_add_f32 v[182:183], v[182:183], v[116:117]
    v_pk_fma_f32 v[184:185], v[116:117], v[116:117], v[184:185]
    v_pk_add_f32 v[182:183], v[182:183], v[118:119]
    v_pk_fma_f32 v[184:185], v[118:119], v[118:119], v[184:185]
    s_waitcnt vmcnt(14)
    ds_read_b64_tr_b16 v[96:97], v186 offset:2048
    ds_read_b64_tr_b16 v[98:99], v186 offset:2112
    v_lshlrev_b32 v120, 16, v72
    v_and_b32 v121, 0xffff0000, v72
    v_lshlrev_b32 v122, 16, v73
    v_and_b32 v123, 0xffff0000, v73
    v_lshlrev_b32 v124, 16, v74
    v_and_b32 v125, 0xffff0000, v74
    v_lshlrev_b32 v126, 16, v75
    v_and_b32 v127, 0xffff0000, v75
    v_fma_f32 v128, v120, v100, v101
    v_fma_f32 v129, v121, v100, v101
    v_fma_f32 v130, v122, v100, v101
    v_fma_f32 v131, v123, v100, v101
    v_fma_f32 v132, v124, v100, v101
    v_fma_f32 v133, v125, v100, v101
    v_fma_f32 v134, v126, v100, v101
    v_fma_f32 v135, v127, v100, v101
    v_lshlrev_b32 v136, 16, v76
    v_and_b32 v137, 0xffff0000, v76
    v_lshlrev_b32 v138, 16, v77
    v_and_b32 v139, 0xffff0000, v77
    v_lshlrev_b32 v140, 16, v78
    v_and_b32 v141, 0xffff0000, v78
    v_lshlrev_b32 v142, 16, v79
    v_and_b32 v143, 0xffff0000, v79
    v_lshlrev_b32 v144, 16, v80
    v_and_b32 v145, 0xffff0000, v80
    v_lshlrev_b32 v146, 16, v81
    v_and_b32 v147, 0xffff0000, v81
    v_lshlrev_b32 v148, 16, v82
    v_and_b32 v149, 0xffff0000, v82
    v_lshlrev_b32 v150, 16, v83
    v_and_b32 v151, 0xffff0000, v83
    v_pk_fma_f32 v[128:129], v[128:129], v[136:137], v[144:145]
    v_pk_fma_f32 v[130:131], v[130:131], v[138:139], v[146:147]
    v_pk_fma_f32 v[132:133], v[132:133], v[140:141], v[148:149]
    v_pk_fma_f32 v[134:135], v[134:135], v[142:143], v[150:151]
    v_lshlrev_b32 v136, 16, v84
    v_and_b32 v137, 0xffff0000, v84
    v_lshlrev_b32 v138, 16, v85
    v_and_b32 v139, 0xffff0000, v85
    v_lshlrev_b32 v140, 16, v86
    v_and_b32 v141, 0xffff0000, v86
    v_lshlrev_b32 v142, 16, v87
    v_and_b32 v143, 0xffff0000, v87
    s_waitcnt lgkmcnt(0)
    v_lshlrev_b32 v152, 16, v96
    v_and_b32 v153, 0xffff0000, v96
    v_lshlrev_b32 v154, 16, v97
    v_and_b32 v155, 0xffff0000, v97
    v_lshlrev_b32 v156, 16, v98
    v_and_b32 v157, 0xffff0000, v98
    v_lshlrev_b32 v158, 16, v99
    v_and_b32 v159, 0xffff0000, v99
    v_pk_mul_f32 v[128:129], v[128:129], v[152:153]
    v_pk_mul_f32 v[130:131], v[130:131], v[154:155]
    v_pk_mul_f32 v[132:133], v[132:133], v[156:157]
    v_pk_mul_f32 v[134:135], v[134:135], v[158:159]
    v_pk_fma_f32 v[120:121], v[128:129], v[136:137], v[120:121]
    v_pk_fma_f32 v[122:123], v[130:131], v[138:139], v[122:123]
    v_pk_fma_f32 v[124:125], v[132:133], v[140:141], v[124:125]
    v_pk_fma_f32 v[126:127], v[134:135], v[142:143], v[126:127]
    v_cvt_pk_bf16_f32 v12, v120, v121
    v_cvt_pk_bf16_f32 v13, v122, v123
    v_cvt_pk_bf16_f32 v14, v124, v125
    v_cvt_pk_bf16_f32 v15, v126, v127
    v_lshlrev_b32 v120, 16, v12
    v_and_b32 v121, 0xffff0000, v12
    v_lshlrev_b32 v122, 16, v13
    v_and_b32 v123, 0xffff0000, v13
    v_lshlrev_b32 v124, 16, v14
    v_and_b32 v125, 0xffff0000, v14
    v_lshlrev_b32 v126, 16, v15
    v_and_b32 v127, 0xffff0000, v15
    v_pk_add_f32 v[182:183], v[182:183], v[120:121]
    v_pk_fma_f32 v[184:185], v[120:121], v[120:121], v[184:185]
    v_pk_add_f32 v[182:183], v[182:183], v[122:123]
    v_pk_fma_f32 v[184:185], v[122:123], v[122:123], v[184:185]
    v_pk_add_f32 v[182:183], v[182:183], v[124:125]
    v_pk_fma_f32 v[184:185], v[124:125], v[124:125], v[184:185]
    v_pk_add_f32 v[182:183], v[182:183], v[126:127]
    v_pk_fma_f32 v[184:185], v[126:127], v[126:127], v[184:185]
    v_add_f32 v180, v182, v183
    v_add_f32 v181, v184, v185
    s_nop 1
    v_add_f32_dpp v180, v180, v180 row_ror:8 row_mask:0xf bank_mask:0xf
    v_add_f32_dpp v181, v181, v181 row_ror:8 row_mask:0xf bank_mask:0xf
    v_mov_b32 v160, v180
    v_mov_b32 v161, v181
    s_nop 1
    v_permlane16_swap_b32 v180, v160
    v_permlane16_swap_b32 v181, v161
    v_add_f32 v180, v180, v160
    v_add_f32 v181, v181, v161
    v_mov_b32 v160, v180
    v_mov_b32 v161, v181
    s_nop 1
    v_permlane32_swap_b32 v180, v160
    v_permlane32_swap_b32 v181, v161
    v_add_f32 v180, v180, v160
    v_add_f32 v181, v181, v161
    ds_write_b64 v187, v[180:181] offset:12288
    s_waitcnt vmcnt(8)
    v_lshlrev_b32 v136, 16, v32
    v_and_b32 v137, 0xffff0000, v32
    v_lshlrev_b32 v138, 16, v33
    v_and_b32 v139, 0xffff0000, v33
    v_lshlrev_b32 v140, 16, v34
    v_and_b32 v141, 0xffff0000, v34
    v_lshlrev_b32 v142, 16, v35
    v_and_b32 v143, 0xffff0000, v35
    v_lshlrev_b32 v144, 16, v36
    v_and_b32 v145, 0xffff0000, v36
    v_lshlrev_b32 v146, 16, v37
    v_and_b32 v147, 0xffff0000, v37
    v_lshlrev_b32 v148, 16, v38
    v_and_b32 v149, 0xffff0000, v38
    v_lshlrev_b32 v150, 16, v39
    v_and_b32 v151, 0xffff0000, v39
    s_waitcnt lgkmcnt(0)
    s_barrier
    ds_read_b128 v[160:163], v188 offset:12288
    ds_read_b128 v[164:167], v188 offset:12304
    s_waitcnt lgkmcnt(0)
    v_pk_add_f32 v[160:161], v[160:161], v[162:163]
    v_pk_add_f32 v[164:165], v[164:165], v[166:167]
    v_pk_add_f32 v[160:161], v[160:161], v[164:165]
    v_mul_f32 v160, s74, v160
    v_mul_f32 v161, s74, v161
    v_fma_f32 v161, -v160, v160, v161
    v_max_f32 v161, 0, v161
    v_cvt_pk_bf16_f32 v161, 0, v161
    v_add_f32 v161, s75, v161
    v_cvt_pk_bf16_f32 v161, 0, v161
    v_sqrt_f32 v161, v161
    v_cvt_pk_bf16_f32 v160, 0, v160
    v_cvt_pk_bf16_f32 v161, 0, v161
    v_rcp_f32 v180, v161
    s_nop 0
    v_mul_f32 v181, -v160, v180
    v_fma_f32 v128, v104, v180, v181
    v_fma_f32 v129, v105, v180, v181
    v_fma_f32 v130, v106, v180, v181
    v_fma_f32 v131, v107, v180, v181
    v_fma_f32 v132, v108, v180, v181
    v_fma_f32 v133, v109, v180, v181
    v_fma_f32 v134, v110, v180, v181
    v_fma_f32 v135, v111, v180, v181
    v_pk_fma_f32 v[128:129], v[128:129], v[136:137], v[144:145]
    v_pk_fma_f32 v[130:131], v[130:131], v[138:139], v[146:147]
    v_pk_fma_f32 v[132:133], v[132:133], v[140:141], v[148:149]
    v_pk_fma_f32 v[134:135], v[134:135], v[142:143], v[150:151]
    v_cvt_pk_bf16_f32 v16, v128, v129
    v_cvt_pk_bf16_f32 v17, v130, v131
    v_cvt_pk_bf16_f32 v18, v132, v133
    v_cvt_pk_bf16_f32 v19, v134, v135
    s_lshl_b32 s74, s28, 12
    s_add_u32 s74, s74, s69
    buffer_store_dwordx4 v[16:19], v251, s[24:27], s74 offen sc1
    v_lshlrev_b32 v136, 16, v60
    v_and_b32 v137, 0xffff0000, v60
    v_lshlrev_b32 v138, 16, v61
    v_and_b32 v139, 0xffff0000, v61
    v_lshlrev_b32 v140, 16, v62
    v_and_b32 v141, 0xffff0000, v62
    v_lshlrev_b32 v142, 16, v63
    v_and_b32 v143, 0xffff0000, v63
    v_lshlrev_b32 v144, 16, v64
    v_and_b32 v145, 0xffff0000, v64
    v_lshlrev_b32 v146, 16, v65
    v_and_b32 v147, 0xffff0000, v65
    v_lshlrev_b32 v148, 16, v66
    v_and_b32 v149, 0xffff0000, v66
    v_lshlrev_b32 v150, 16, v67
    v_and_b32 v151, 0xffff0000, v67
    v_fma_f32 v128, v112, v180, v181
    v_fma_f32 v129, v113, v180, v181
    v_fma_f32 v130, v114, v180, v181
    v_fma_f32 v131, v115, v180, v181
    v_fma_f32 v132, v116, v180, v181
    v_fma_f32 v133, v117, v180, v181
    v_fma_f32 v134, v118, v180, v181
    v_fma_f32 v135, v119, v180, v181
    v_pk_fma_f32 v[128:129], v[128:129], v[136:137], v[144:145]
    v_pk_fma_f32 v[130:131], v[130:131], v[138:139], v[146:147]
    v_pk_fma_f32 v[132:133], v[132:133], v[140:141], v[148:149]
    v_pk_fma_f32 v[134:135], v[134:135], v[142:143], v[150:151]
    v_cvt_pk_bf16_f32 v44, v128, v129
    v_cvt_pk_bf16_f32 v45, v130, v131
    v_cvt_pk_bf16_f32 v46, v132, v133
    v_cvt_pk_bf16_f32 v47, v134, v135
    s_lshl_b32 s74, s73, 12
    s_add_u32 s74, s74, s69
    buffer_store_dwordx4 v[44:47], v251, s[24:27], s74 offen sc1
    v_lshlrev_b32 v136, 16, v88
    v_and_b32 v137, 0xffff0000, v88
    v_lshlrev_b32 v138, 16, v89
    v_and_b32 v139, 0xffff0000, v89
    v_lshlrev_b32 v140, 16, v90
    v_and_b32 v141, 0xffff0000, v90
    v_lshlrev_b32 v142, 16, v91
    v_and_b32 v143, 0xffff0000, v91
    v_lshlrev_b32 v144, 16, v92
    v_and_b32 v145, 0xffff0000, v92
    v_lshlrev_b32 v146, 16, v93
    v_and_b32 v147, 0xffff0000, v93
    v_lshlrev_b32 v148, 16, v94
    v_and_b32 v149, 0xffff0000, v94
    v_lshlrev_b32 v150, 16, v95
    v_and_b32 v151, 0xffff0000, v95
    v_fma_f32 v128, v120, v180, v181
    v_fma_f32 v129, v121, v180, v181
    v_fma_f32 v130, v122, v180, v181
    v_fma_f32 v131, v123, v180, v181
    v_fma_f32 v132, v124, v180, v181
    v_fma_f32 v133, v125, v180, v181
    v_fma_f32 v134, v126, v180, v181
    v_fma_f32 v135, v127, v180, v181
    v_pk_fma_f32 v[128:129], v[128:129], v[136:137], v[144:145]
    v_pk_fma_f32 v[130:131], v[130:131], v[138:139], v[146:147]
    v_pk_fma_f32 v[132:133], v[132:133], v[140:141], v[148:149]
    v_pk_fma_f32 v[134:135], v[134:135], v[142:143], v[150:151]
    v_cvt_pk_bf16_f32 v72, v128, v129
    v_cvt_pk_bf16_f32 v73, v130, v131
    v_cvt_pk_bf16_f32 v74, v132, v133
    v_cvt_pk_bf16_f32 v75, v134, v135
    s_lshl_b32 s74, s72, 12
    s_add_u32 s74, s74, s69
    buffer_store_dwordx4 v[72:75], v251, s[24:27], s74 offen sc1
    s_add_u32 m0, s40, 126976
    s_add_u32 s45, s36, 1179648
    buffer_load_dwordx4 v233, s[12:15], s45 offen  lds
    s_add_u32 m0, s40, 122880
    s_add_u32 s45, s36, 1179648
    buffer_load_dwordx4 v233, s[16:19], s45 offen  lds
    s_add_u32 m0, s40, 118784
    s_add_u32 s45, s36, 1474560
    buffer_load_dwordx4 v233, s[12:15], s45 offen  lds
    s_add_u32 m0, s40, 114688
    s_add_u32 s45, s36, 1474560
    buffer_load_dwordx4 v233, s[16:19], s45 offen  lds
    s_add_u32 m0, s40, 110592
    s_add_u32 s45, s36, 1769472
    buffer_load_dwordx4 v233, s[12:15], s45 offen  lds
    s_add_u32 m0, s40, 106496
    s_add_u32 s45, s36, 1769472
    buffer_load_dwordx4 v233, s[16:19], s45 offen  lds
    s_add_u32 m0, s40, 102400
    s_add_u32 s45, s36, 2064384
    buffer_load_dwordx4 v233, s[12:15], s45 offen  lds
    s_add_u32 m0, s40, 98304
    s_add_u32 s45, s36, 2064384
    buffer_load_dwordx4 v233, s[16:19], s45 offen  lds
    s_add_u32 m0, s40, 94208
    s_add_u32 s45, s36, 2359296
    buffer_load_dwordx4 v233, s[12:15], s45 offen  lds
    s_add_u32 m0, s40, 90112
    s_add_u32 s45, s36, 2359296
    buffer_load_dwordx4 v233, s[16:19], s45 offen  lds
    s_mov_b32 s20, s8
    s_mov_b32 s21, s9
    s_mov_b32 s22, 5308416
    s_mov_b32 s23, 0x20000
    s_add_u32 s48, s10, 9502720
    s_addc_u32 s49, s11, 0
    s_mov_b32 s50, 37748736
    s_mov_b32 s51, 0x20000
    s_mul_i32 s42, s29, 2359296
    s_lshl_b32 s44, s35, 11
    s_add_u32 s42, s42, s44
    s_add_u32 s58, s42, s56
    s_add_u32 s59, s42, s57
    s_mov_b32 s43, 0xbfb8aa3b
    v_lshrrev_b32 v104, 2, v2
    s_lshl_b32 s44, s28, 4
    v_add_u32 v104, s44, v104
    v_and_b32 v106, 3, v2
    v_lshrrev_b32 v105, 2, v104
    v_and_b32 v105, 2, v105
    v_xor_b32 v105, v105, v106
    v_mul_u32_u24 v107, 9216, v104
    v_lshl_add_u32 v234, v105, 4, v107
    v_lshrrev_b32 v104, 4, v2
    v_bfe_u32 v105, v2, 2, 2
    v_lshrrev_b32 v109, 1, v106
    v_and_b32 v111, 1, v106
    s_lshl_b32 s44, s35, 2
    v_lshl_add_u32 v107, v104, 3, v105
    v_and_b32 v110, 2, v107
    v_lshrrev_b32 v108, 1, v107
    v_and_b32 v108, 4, v108
    v_or_b32 v110, v110, v108
    v_xor_b32 v110, s44, v110
    v_xor_b32 v113, v109, v110
    v_lshlrev_b32 v112, 7, v107
    v_lshl_add_u32 v112, v111, 3, v112
    v_lshl_add_u32 v224, v113, 4, v112
    v_xor_b32 v225, 32, v224
    v_add_u32 v226, 65536, v224
    v_add_u32 v227, 65536, v225
    v_add_u32 v228, 131072, v224
    v_add_u32 v229, 131072, v225
    v_lshrrev_b32 v110, 2, v107
    v_and_b32 v110, 2, v110
    v_xor_b32 v113, v109, v110
    v_lshlrev_b32 v112, 6, v107
    v_lshl_add_u32 v112, v111, 3, v112
    v_lshl_add_u32 v230, v113, 4, v112
    s_lshl_b32 s45, s35, 5
    v_xor_b32 v230, s45, v230
    v_xor_b32 v231, 32, v230
    v_lshl_add_u32 v107, v104, 2, v105
    v_bfe_u32 v110, v107, 1, 1
    v_and_b32 v108, 4, v107
    v_or_b32 v110, v110, v108
    v_xor_b32 v110, s44, v110
    v_xor_b32 v113, v106, v110
    v_lshlrev_b32 v112, 7, v107
    v_lshl_add_u32 v112, v111, 3, v112
    v_lshl_add_u32 v1, v113, 4, v112
    v_add_u32 v232, 65536, v230
    v_add_u32 v241, 65536, v231
    v_add_u32 v255, 131072, v230
    v_add_u32 v3, 131072, v231
    v_lshlrev_b32 v114, 4, v2
    s_lshl_b32 s44, s28, 12
    s_xor_b32 s45, s44, 4096
    s_lshl_b32 s52, s35, 11
    s_add_u32 s44, s44, 98304
    s_add_u32 s45, s45, 98304
    v_add_u32 v242, s44, v114
    v_add_u32 v243, s45, v114
    v_add_u32 v239, s52, v242
    v_add_u32 v240, s52, v243
    s_lshl_b32 s44, s28, 11
    s_xor_b32 s45, s44, 2048
    s_add_u32 s44, s44, 90112
    s_add_u32 s45, s45, 90112
    v_add_u32 v244, s44, v114
    v_add_u32 v245, s45, v114
    s_lshl_b32 s44, s35, 3
    v_add_u32 v231, s44, v244
    v_add_u32 v241, s44, v245
    s_mul_i32 s52, s28, 21
    v_add_u32 v107, s52, v2
    v_cmp_gt_u32 vcc, 81, v107
    v_cmp_gt_u32 s[54:55], 21, v2
    s_mul_i32 s52, s31, 18
    s_add_u32 s52, s52, s32
    s_mul_i32 s52, s52, 1152
    s_add_u32 s53, s52, 10368
    s_and_b64 vcc, vcc, s[54:55]
    v_lshlrev_b32 v107, 7, v107
    v_mov_b32 v111, 0x7fffff00
    v_cndmask_b32 v238, v111, v107, vcc
    v_mul_u32_u24 v107, 171, v2
    v_lshrrev_b32 v107, 9, v107
    v_mul_u32_u24 v108, 3, v107
    v_sub_u32 v108, v2, v108
    s_mul_i32 s54, s31, 36
    s_mul_i32 s55, s28, 9
    s_add_u32 s54, s54, s55
    v_cmp_eq_u32 vcc, 2, v108
    v_add_u32 v107, s54, v107
    v_mul_u32_u24 v107, 9216, v107
    v_lshlrev_b32 v109, 7, v108
    s_add_u32 s54, s36, 256
    v_add_u32 v109, s54, v109
    v_mov_b32 v110, s37
    v_cndmask_b32 v109, v109, v110, vcc
    v_cmp_gt_u32 vcc, 27, v2
    v_add_u32 v107, v107, v109
    s_nop 0
    v_cndmask_b32 v237, v111, v107, vcc
    s_waitcnt vmcnt(10)
    s_barrier
    s_cmp_lg_u32 s28, 0
    s_cbranch_scc1 K3_SH
    s_mov_b64 exec, 1
    buffer_atomic_add v254, v250, s[60:63], s68 offen offset:384 sc1
    s_mov_b64 exec, -1
K3_SH:
    s_add_u32 m0, s40, 86016
    s_add_u32 s45, s36, 2654208
    buffer_load_dwordx4 v233, s[12:15], s45 offen  lds
    s_add_u32 m0, s40, 81920
    s_add_u32 s45, s36, 2654208
    buffer_load_dwordx4 v233, s[16:19], s45 offen  lds
    s_add_u32 m0, s40, 77824
    s_add_u32 s45, s36, 2949120
    buffer_load_dwordx4 v233, s[12:15], s45 offen  lds
    s_add_u32 m0, s40, 73728
    s_add_u32 s45, s36, 2949120
    buffer_load_dwordx4 v233, s[16:19], s45 offen  lds
    s_add_u32 m0, s40, 69632
    s_add_u32 s45, s36, 3244032
    buffer_load_dwordx4 v233, s[12:15], s45 offen  lds
    s_add_u32 m0, s40, 65536
    s_add_u32 s45, s36, 3244032
    buffer_load_dwordx4 v233, s[16:19], s45 offen  lds
    s_add_u32 m0, s40, 61440
    s_add_u32 s45, s36, 3538944
    buffer_load_dwordx4 v233, s[12:15], s45 offen  lds
    s_add_u32 m0, s40, 57344
    s_add_u32 s45, s36, 3538944
    buffer_load_dwordx4 v233, s[16:19], s45 offen  lds
    s_add_u32 m0, s40, 53248
    s_add_u32 s45, s36, 3833856
    buffer_load_dwordx4 v233, s[12:15], s45 offen  lds
    s_add_u32 m0, s40, 49152
    s_add_u32 s45, s36, 3833856
    buffer_load_dwordx4 v233, s[16:19], s45 offen  lds
    s_add_u32 m0, s40, 45056
    s_add_u32 s45, s36, 4128768
    buffer_load_dwordx4 v233, s[12:15], s45 offen  lds
    s_add_u32 m0, s40, 40960
    s_add_u32 s45, s36, 4128768
    buffer_load_dwordx4 v233, s[16:19], s45 offen  lds
    s_add_u32 m0, s40, 36864
    s_add_u32 s45, s36, 4423680
    buffer_load_dwordx4 v233, s[12:15], s45 offen  lds
    s_add_u32 m0, s40, 32768
    s_add_u32 s45, s36, 4423680
    buffer_load_dwordx4 v233, s[16:19], s45 offen  lds
    s_add_u32 m0, s40, 28672
    s_add_u32 s45, s36, 4718592
    buffer_load_dwordx4 v233, s[12:15], s45 offen  lds
    s_add_u32 m0, s40, 24576
    s_add_u32 s45, s36, 4718592
    buffer_load_dwordx4 v233, s[16:19], s45 offen  lds
    ds_read_b64_tr_b16 v[176:177], v228 offset:28672
    ds_read_b64_tr_b16 v[178:179], v228 offset:29184
    ds_read_b64_tr_b16 v[180:181], v229 offset:28672
    ds_read_b64_tr_b16 v[182:183], v229 offset:29184
    ds_read_b64_tr_b16 v[192:193], v228 offset:24576
    ds_read_b64_tr_b16 v[194:195], v228 offset:25088
    ds_read_b64_tr_b16 v[196:197], v229 offset:24576
    ds_read_b64_tr_b16 v[198:199], v229 offset:25088
    s_cmp_lg_u32 s28, 0
    s_cbranch_scc1 K3_PH_ok
    s_mov_b32 s3, 0
K3_PH:
    buffer_load_dword v246, v250, s[60:63], s68 offen offset:384 sc0 sc1
    s_add_u32 s3, s3, 1
    s_waitcnt vmcnt(0)
    v_readfirstlane_b32 s76, v246
    s_cmp_ge_u32 s3, 0x200000
    s_cbranch_scc1 K3_PH_ok
    s_cmp_lt_u32 s76, 16
    s_cbranch_scc1 K3_PH
K3_PH_ok:
    s_waitcnt vmcnt(0)
    s_barrier
    s_add_u32 s46, s56, 0
    buffer_load_dwordx4 a[0:3], v236, s[24:27], s46 offen offset:0
    buffer_load_dwordx4 a[4:7], v236, s[24:27], s46 offen offset:256
    s_add_u32 s47, s57, 0
    buffer_load_dwordx4 a[144:147], v236, s[24:27], s47 offen offset:0
    buffer_load_dwordx4 a[148:151], v236, s[24:27], s47 offen offset:256
    buffer_load_dwordx4 a[8:11], v236, s[24:27], s46 offen offset:2048
    buffer_load_dwordx4 a[12:15], v236, s[24:27], s46 offen offset:2304
    buffer_load_dwordx4 a[152:155], v236, s[24:27], s47 offen offset:2048
    buffer_load_dwordx4 a[156:159], v236, s[24:27], s47 offen offset:2304
    s_add_u32 s46, s56, 4096
    buffer_load_dwordx4 a[16:19], v236, s[24:27], s46 offen offset:0
    buffer_load_dwordx4 a[20:23], v236, s[24:27], s46 offen offset:256
    s_add_u32 s47, s57, 4096
    buffer_load_dwordx4 a[160:163], v236, s[24:27], s47 offen offset:0
    buffer_load_dwordx4 a[164:167], v236, s[24:27], s47 offen offset:256
    buffer_load_dwordx4 a[24:27], v236, s[24:27], s46 offen offset:2048
    buffer_load_dwordx4 a[28:31], v236, s[24:27], s46 offen offset:2304
    buffer_load_dwordx4 a[168:171], v236, s[24:27], s47 offen offset:2048
    buffer_load_dwordx4 a[172:175], v236, s[24:27], s47 offen offset:2304
    s_waitcnt lgkmcnt(4)
    s_waitcnt vmcnt(12)
    v_mfma_f32_16x16x32_bf16 v[16:19], v[176:179], a[0:3], 0
    ds_read_b64_tr_b16 v[208:209], v228 offset:20480
    v_mfma_f32_16x16x32_bf16 v[24:27], v[176:179], a[4:7], 0
    s_add_u32 s46, s56, 8192
    v_mfma_f32_16x16x32_bf16 v[32:35], v[176:179], a[144:147], 0
    ds_read_b64_tr_b16 v[210:211], v228 offset:20992
    v_mfma_f32_16x16x32_bf16 v[40:43], v[176:179], a[148:151], 0
    buffer_load_dwordx4 a[32:35], v236, s[24:27], s46 offen offset:0
    v_mfma_f32_16x16x32_bf16 v[20:23], v[180:183], a[0:3], 0
    ds_read_b64_tr_b16 v[212:213], v229 offset:20480
    v_mfma_f32_16x16x32_bf16 v[28:31], v[180:183], a[4:7], 0
    buffer_load_dwordx4 a[36:39], v236, s[24:27], s46 offen offset:256
    v_mfma_f32_16x16x32_bf16 v[36:39], v[180:183], a[144:147], 0
    ds_read_b64_tr_b16 v[214:215], v229 offset:20992
    v_mfma_f32_16x16x32_bf16 v[44:47], v[180:183], a[148:151], 0
    s_waitcnt lgkmcnt(4)
    v_mfma_f32_16x16x32_bf16 v[48:51], v[192:195], a[0:3], 0
    ds_read_b64_tr_b16 v[176:177], v228 offset:16384
    v_mfma_f32_16x16x32_bf16 v[56:59], v[192:195], a[4:7], 0
    s_add_u32 s47, s57, 8192
    v_mfma_f32_16x16x32_bf16 v[64:67], v[192:195], a[144:147], 0
    ds_read_b64_tr_b16 v[178:179], v228 offset:16896
    v_mfma_f32_16x16x32_bf16 v[72:75], v[192:195], a[148:151], 0
    buffer_load_dwordx4 a[176:179], v236, s[24:27], s47 offen offset:0
    v_mfma_f32_16x16x32_bf16 v[52:55], v[196:199], a[0:3], 0
    ds_read_b64_tr_b16 v[180:181], v229 offset:16384
    v_mfma_f32_16x16x32_bf16 v[60:63], v[196:199], a[4:7], 0
    buffer_load_dwordx4 a[180:183], v236, s[24:27], s47 offen offset:256
    v_mfma_f32_16x16x32_bf16 v[68:71], v[196:199], a[144:147], 0
    ds_read_b64_tr_b16 v[182:183], v229 offset:16896
    v_mfma_f32_16x16x32_bf16 v[76:79], v[196:199], a[148:151], 0
    s_waitcnt lgkmcnt(4)
    s_waitcnt vmcnt(12)
    v_mfma_f32_16x16x32_bf16 v[16:19], v[208:211], a[8:11], v[16:19]
    ds_read_b64_tr_b16 v[192:193], v228 offset:12288
    v_mfma_f32_16x16x32_bf16 v[24:27], v[208:211], a[12:15], v[24:27]
    buffer_load_dwordx4 a[40:43], v236, s[24:27], s46 offen offset:2048
    v_mfma_f32_16x16x32_bf16 v[32:35], v[208:211], a[152:155], v[32:35]
    ds_read_b64_tr_b16 v[194:195], v228 offset:12800
    v_mfma_f32_16x16x32_bf16 v[40:43], v[208:211], a[156:159], v[40:43]
    v_mfma_f32_16x16x32_bf16 v[20:23], v[212:215], a[8:11], v[20:23]
    ds_read_b64_tr_b16 v[196:197], v229 offset:12288
    v_mfma_f32_16x16x32_bf16 v[28:31], v[212:215], a[12:15], v[28:31]
    buffer_load_dwordx4 a[44:47], v236, s[24:27], s46 offen offset:2304
    v_mfma_f32_16x16x32_bf16 v[36:39], v[212:215], a[152:155], v[36:39]
    ds_read_b64_tr_b16 v[198:199], v229 offset:12800
    v_mfma_f32_16x16x32_bf16 v[44:47], v[212:215], a[156:159], v[44:47]
    s_waitcnt lgkmcnt(4)
    v_mfma_f32_16x16x32_bf16 v[48:51], v[176:179], a[8:11], v[48:51]
    ds_read_b64_tr_b16 v[208:209], v228 offset:8192
    v_mfma_f32_16x16x32_bf16 v[56:59], v[176:179], a[12:15], v[56:59]
    buffer_load_dwordx4 a[184:187], v236, s[24:27], s47 offen offset:2048
    v_mfma_f32_16x16x32_bf16 v[64:67], v[176:179], a[152:155], v[64:67]
    ds_read_b64_tr_b16 v[210:211], v228 offset:8704
    v_mfma_f32_16x16x32_bf16 v[72:75], v[176:179], a[156:159], v[72:75]
    v_mfma_f32_16x16x32_bf16 v[52:55], v[180:183], a[8:11], v[52:55]
    ds_read_b64_tr_b16 v[212:213], v229 offset:8192
    v_mfma_f32_16x16x32_bf16 v[60:63], v[180:183], a[12:15], v[60:63]
    buffer_load_dwordx4 a[188:191], v236, s[24:27], s47 offen offset:2304
    v_mfma_f32_16x16x32_bf16 v[68:71], v[180:183], a[152:155], v[68:71]
    ds_read_b64_tr_b16 v[214:215], v229 offset:8704
    v_mfma_f32_16x16x32_bf16 v[76:79], v[180:183], a[156:159], v[76:79]
    s_waitcnt lgkmcnt(4)
    s_waitcnt vmcnt(12)
    v_mfma_f32_16x16x32_bf16 v[16:19], v[192:195], a[16:19], v[16:19]
    ds_read_b64_tr_b16 v[176:177], v228 offset:4096
    v_mfma_f32_16x16x32_bf16 v[24:27], v[192:195], a[20:23], v[24:27]
    s_add_u32 s46, s56, 12288
    v_mfma_f32_16x16x32_bf16 v[32:35], v[192:195], a[160:163], v[32:35]
    ds_read_b64_tr_b16 v[178:179], v228 offset:4608
    v_mfma_f32_16x16x32_bf16 v[40:43], v[192:195], a[164:167], v[40:43]
    buffer_load_dwordx4 a[48:51], v236, s[24:27], s46 offen offset:0
    v_mfma_f32_16x16x32_bf16 v[20:23], v[196:199], a[16:19], v[20:23]
    ds_read_b64_tr_b16 v[180:181], v229 offset:4096
    v_mfma_f32_16x16x32_bf16 v[28:31], v[196:199], a[20:23], v[28:31]
    buffer_load_dwordx4 a[52:55], v236, s[24:27], s46 offen offset:256
    v_mfma_f32_16x16x32_bf16 v[36:39], v[196:199], a[160:163], v[36:39]
    ds_read_b64_tr_b16 v[182:183], v229 offset:4608
    v_mfma_f32_16x16x32_bf16 v[44:47], v[196:199], a[164:167], v[44:47]
    s_waitcnt lgkmcnt(4)
    v_mfma_f32_16x16x32_bf16 v[48:51], v[208:211], a[16:19], v[48:51]
    ds_read_b64_tr_b16 v[192:193], v228 offset:0
    v_mfma_f32_16x16x32_bf16 v[56:59], v[208:211], a[20:23], v[56:59]
    s_add_u32 s47, s57, 12288
    v_mfma_f32_16x16x32_bf16 v[64:67], v[208:211], a[160:163], v[64:67]
    ds_read_b64_tr_b16 v[194:195], v228 offset:512
    v_mfma_f32_16x16x32_bf16 v[72:75], v[208:211], a[164:167], v[72:75]
    buffer_load_dwordx4 a[192:195], v236, s[24:27], s47 offen offset:0
    v_mfma_f32_16x16x32_bf16 v[52:55], v[212:215], a[16:19], v[52:55]
    ds_read_b64_tr_b16 v[196:197], v229 offset:0
    v_mfma_f32_16x16x32_bf16 v[60:63], v[212:215], a[20:23], v[60:63]
    buffer_load_dwordx4 a[196:199], v236, s[24:27], s47 offen offset:256
    v_mfma_f32_16x16x32_bf16 v[68:71], v[212:215], a[160:163], v[68:71]
    ds_read_b64_tr_b16 v[198:199], v229 offset:512
    v_mfma_f32_16x16x32_bf16 v[76:79], v[212:215], a[164:167], v[76:79]
    s_waitcnt lgkmcnt(4)
    s_waitcnt vmcnt(12)
    v_mfma_f32_16x16x32_bf16 v[16:19], v[176:179], a[24:27], v[16:19]
    s_barrier
    v_mfma_f32_16x16x32_bf16 v[24:27], v[176:179], a[28:31], v[24:27]
    ds_read_b64_tr_b16 v[208:209], v226 offset:61440
    v_mfma_f32_16x16x32_bf16 v[32:35], v[176:179], a[168:171], v[32:35]
    buffer_load_dwordx4 a[56:59], v236, s[24:27], s46 offen offset:2048
    v_mfma_f32_16x16x32_bf16 v[40:43], v[176:179], a[172:175], v[40:43]
    ds_read_b64_tr_b16 v[210:211], v226 offset:61952
    v_mfma_f32_16x16x32_bf16 v[20:23], v[180:183], a[24:27], v[20:23]
    ds_read_b64_tr_b16 v[212:213], v227 offset:61440
    v_mfma_f32_16x16x32_bf16 v[28:31], v[180:183], a[28:31], v[28:31]
    buffer_load_dwordx4 a[60:63], v236, s[24:27], s46 offen offset:2304
    v_mfma_f32_16x16x32_bf16 v[36:39], v[180:183], a[168:171], v[36:39]
    ds_read_b64_tr_b16 v[214:215], v227 offset:61952
    v_mfma_f32_16x16x32_bf16 v[44:47], v[180:183], a[172:175], v[44:47]
    s_waitcnt lgkmcnt(4)
    v_mfma_f32_16x16x32_bf16 v[48:51], v[192:195], a[24:27], v[48:51]
    ds_read_b64_tr_b16 v[176:177], v226 offset:57344
    v_mfma_f32_16x16x32_bf16 v[56:59], v[192:195], a[28:31], v[56:59]
    buffer_load_dwordx4 a[200:203], v236, s[24:27], s47 offen offset:2048
    v_mfma_f32_16x16x32_bf16 v[64:67], v[192:195], a[168:171], v[64:67]
    ds_read_b64_tr_b16 v[178:179], v226 offset:57856
    v_mfma_f32_16x16x32_bf16 v[72:75], v[192:195], a[172:175], v[72:75]
    v_mfma_f32_16x16x32_bf16 v[52:55], v[196:199], a[24:27], v[52:55]
    ds_read_b64_tr_b16 v[180:181], v227 offset:57344
    v_mfma_f32_16x16x32_bf16 v[60:63], v[196:199], a[28:31], v[60:63]
    buffer_load_dwordx4 a[204:207], v236, s[24:27], s47 offen offset:2304
    v_mfma_f32_16x16x32_bf16 v[68:71], v[196:199], a[168:171], v[68:71]
    ds_read_b64_tr_b16 v[182:183], v227 offset:57856
    v_mfma_f32_16x16x32_bf16 v[76:79], v[196:199], a[172:175], v[76:79]
    s_waitcnt lgkmcnt(4)
    s_waitcnt vmcnt(12)
    v_mfma_f32_16x16x32_bf16 v[16:19], v[208:211], a[32:35], v[16:19]
    ds_read_b64_tr_b16 v[192:193], v226 offset:53248
    v_mfma_f32_16x16x32_bf16 v[24:27], v[208:211], a[36:39], v[24:27]
    s_add_u32 s46, s56, 16384
    v_mfma_f32_16x16x32_bf16 v[32:35], v[208:211], a[176:179], v[32:35]
    ds_read_b64_tr_b16 v[194:195], v226 offset:53760
    v_mfma_f32_16x16x32_bf16 v[40:43], v[208:211], a[180:183], v[40:43]
    buffer_load_dwordx4 a[64:67], v236, s[24:27], s46 offen offset:0
    v_mfma_f32_16x16x32_bf16 v[20:23], v[212:215], a[32:35], v[20:23]
    ds_read_b64_tr_b16 v[196:197], v227 offset:53248
    v_mfma_f32_16x16x32_bf16 v[28:31], v[212:215], a[36:39], v[28:31]
    buffer_load_dwordx4 a[68:71], v236, s[24:27], s46 offen offset:256
    v_mfma_f32_16x16x32_bf16 v[36:39], v[212:215], a[176:179], v[36:39]
    ds_read_b64_tr_b16 v[198:199], v227 offset:53760
    v_mfma_f32_16x16x32_bf16 v[44:47], v[212:215], a[180:183], v[44:47]
    s_waitcnt lgkmcnt(4)
    v_mfma_f32_16x16x32_bf16 v[48:51], v[176:179], a[32:35], v[48:51]
    ds_read_b64_tr_b16 v[208:209], v226 offset:49152
    v_mfma_f32_16x16x32_bf16 v[56:59], v[176:179], a[36:39], v[56:59]
    s_add_u32 s47, s57, 16384
    v_mfma_f32_16x16x32_bf16 v[64:67], v[176:179], a[176:179], v[64:67]
    ds_read_b64_tr_b16 v[210:211], v226 offset:49664
    v_mfma_f32_16x16x32_bf16 v[72:75], v[176:179], a[180:183], v[72:75]
    buffer_load_dwordx4 a[208:211], v236, s[24:27], s47 offen offset:0
    v_mfma_f32_16x16x32_bf16 v[52:55], v[180:183], a[32:35], v[52:55]
    ds_read_b64_tr_b16 v[212:213], v227 offset:49152
    v_mfma_f32_16x16x32_bf16 v[60:63], v[180:183], a[36:39], v[60:63]
    buffer_load_dwordx4 a[212:215], v236, s[24:27], s47 offen offset:256
    v_mfma_f32_16x16x32_bf16 v[68:71], v[180:183], a[176:179], v[68:71]
    ds_read_b64_tr_b16 v[214:215], v227 offset:49664
    v_mfma_f32_16x16x32_bf16 v[76:79], v[180:183], a[180:183], v[76:79]
    s_waitcnt lgkmcnt(4)
    s_waitcnt vmcnt(12)
    v_mfma_f32_16x16x32_bf16 v[16:19], v[192:195], a[40:43], v[16:19]
    ds_read_b64_tr_b16 v[176:177], v226 offset:45056
    v_mfma_f32_16x16x32_bf16 v[24:27], v[192:195], a[44:47], v[24:27]
    buffer_load_dwordx4 a[72:75], v236, s[24:27], s46 offen offset:2048
    v_mfma_f32_16x16x32_bf16 v[32:35], v[192:195], a[184:187], v[32:35]
    ds_read_b64_tr_b16 v[178:179], v226 offset:45568
    v_mfma_f32_16x16x32_bf16 v[40:43], v[192:195], a[188:191], v[40:43]
    v_mfma_f32_16x16x32_bf16 v[20:23], v[196:199], a[40:43], v[20:23]
    ds_read_b64_tr_b16 v[180:181], v227 offset:45056
    v_mfma_f32_16x16x32_bf16 v[28:31], v[196:199], a[44:47], v[28:31]
    buffer_load_dwordx4 a[76:79], v236, s[24:27], s46 offen offset:2304
    v_mfma_f32_16x16x32_bf16 v[36:39], v[196:199], a[184:187], v[36:39]
    ds_read_b64_tr_b16 v[182:183], v227 offset:45568
    v_mfma_f32_16x16x32_bf16 v[44:47], v[196:199], a[188:191], v[44:47]
    s_waitcnt lgkmcnt(4)
    v_mfma_f32_16x16x32_bf16 v[48:51], v[208:211], a[40:43], v[48:51]
    ds_read_b64_tr_b16 v[192:193], v226 offset:40960
    v_mfma_f32_16x16x32_bf16 v[56:59], v[208:211], a[44:47], v[56:59]
    buffer_load_dwordx4 a[216:219], v236, s[24:27], s47 offen offset:2048
    v_mfma_f32_16x16x32_bf16 v[64:67], v[208:211], a[184:187], v[64:67]
    ds_read_b64_tr_b16 v[194:195], v226 offset:41472
    v_mfma_f32_16x16x32_bf16 v[72:75], v[208:211], a[188:191], v[72:75]
    v_mfma_f32_16x16x32_bf16 v[52:55], v[212:215], a[40:43], v[52:55]
    ds_read_b64_tr_b16 v[196:197], v227 offset:40960
    v_mfma_f32_16x16x32_bf16 v[60:63], v[212:215], a[44:47], v[60:63]
    buffer_load_dwordx4 a[220:223], v236, s[24:27], s47 offen offset:2304
    v_mfma_f32_16x16x32_bf16 v[68:71], v[212:215], a[184:187], v[68:71]
    ds_read_b64_tr_b16 v[198:199], v227 offset:41472
    v_mfma_f32_16x16x32_bf16 v[76:79], v[212:215], a[188:191], v[76:79]
    s_waitcnt lgkmcnt(4)
    s_waitcnt vmcnt(12)
    v_mfma_f32_16x16x32_bf16 v[16:19], v[176:179], a[48:51], v[16:19]
    ds_read_b64_tr_b16 v[208:209], v226 offset:36864
    v_mfma_f32_16x16x32_bf16 v[24:27], v[176:179], a[52:55], v[24:27]
    s_add_u32 s46, s56, 20480
    v_mfma_f32_16x16x32_bf16 v[32:35], v[176:179], a[192:195], v[32:35]
    ds_read_b64_tr_b16 v[210:211], v226 offset:37376
    v_mfma_f32_16x16x32_bf16 v[40:43], v[176:179], a[196:199], v[40:43]
    buffer_load_dwordx4 a[80:83], v236, s[24:27], s46 offen offset:0
    v_mfma_f32_16x16x32_bf16 v[20:23], v[180:183], a[48:51], v[20:23]
    ds_read_b64_tr_b16 v[212:213], v227 offset:36864
    v_mfma_f32_16x16x32_bf16 v[28:31], v[180:183], a[52:55], v[28:31]
    buffer_load_dwordx4 a[84:87], v236, s[24:27], s46 offen offset:256
    v_mfma_f32_16x16x32_bf16 v[36:39], v[180:183], a[192:195], v[36:39]
    ds_read_b64_tr_b16 v[214:215], v227 offset:37376
    v_mfma_f32_16x16x32_bf16 v[44:47], v[180:183], a[196:199], v[44:47]
    s_waitcnt lgkmcnt(4)
    v_mfma_f32_16x16x32_bf16 v[48:51], v[192:195], a[48:51], v[48:51]
    ds_read_b64_tr_b16 v[176:177], v226 offset:32768
    v_mfma_f32_16x16x32_bf16 v[56:59], v[192:195], a[52:55], v[56:59]
    s_add_u32 s47, s57, 20480
    v_mfma_f32_16x16x32_bf16 v[64:67], v[192:195], a[192:195], v[64:67]
    ds_read_b64_tr_b16 v[178:179], v226 offset:33280
    v_mfma_f32_16x16x32_bf16 v[72:75], v[192:195], a[196:199], v[72:75]
    buffer_load_dwordx4 a[224:227], v236, s[24:27], s47 offen offset:0
    v_mfma_f32_16x16x32_bf16 v[52:55], v[196:199], a[48:51], v[52:55]
    ds_read_b64_tr_b16 v[180:181], v227 offset:32768
    v_mfma_f32_16x16x32_bf16 v[60:63], v[196:199], a[52:55], v[60:63]
    buffer_load_dwordx4 a[228:231], v236, s[24:27], s47 offen offset:256
    v_mfma_f32_16x16x32_bf16 v[68:71], v[196:199], a[192:195], v[68:71]
    ds_read_b64_tr_b16 v[182:183], v227 offset:33280
    v_mfma_f32_16x16x32_bf16 v[76:79], v[196:199], a[196:199], v[76:79]
    s_waitcnt lgkmcnt(4)
    s_waitcnt vmcnt(12)
    v_mfma_f32_16x16x32_bf16 v[16:19], v[208:211], a[56:59], v[16:19]
    s_barrier
    v_mfma_f32_16x16x32_bf16 v[24:27], v[208:211], a[60:63], v[24:27]
    ds_read_b64_tr_b16 v[192:193], v226 offset:28672
    v_mfma_f32_16x16x32_bf16 v[32:35], v[208:211], a[200:203], v[32:35]
    buffer_load_dwordx4 a[88:91], v236, s[24:27], s46 offen offset:2048
    v_mfma_f32_16x16x32_bf16 v[40:43], v[208:211], a[204:207], v[40:43]
    ds_read_b64_tr_b16 v[194:195], v226 offset:29184
    v_mfma_f32_16x16x32_bf16 v[20:23], v[212:215], a[56:59], v[20:23]
    ds_read_b64_tr_b16 v[196:197], v227 offset:28672
    v_mfma_f32_16x16x32_bf16 v[28:31], v[212:215], a[60:63], v[28:31]
    buffer_load_dwordx4 a[92:95], v236, s[24:27], s46 offen offset:2304
    v_mfma_f32_16x16x32_bf16 v[36:39], v[212:215], a[200:203], v[36:39]
    ds_read_b64_tr_b16 v[198:199], v227 offset:29184
    v_mfma_f32_16x16x32_bf16 v[44:47], v[212:215], a[204:207], v[44:47]
    s_waitcnt lgkmcnt(4)
    v_mfma_f32_16x16x32_bf16 v[48:51], v[176:179], a[56:59], v[48:51]
    ds_read_b64_tr_b16 v[208:209], v226 offset:24576
    v_mfma_f32_16x16x32_bf16 v[56:59], v[176:179], a[60:63], v[56:59]
    buffer_load_dwordx4 a[232:235], v236, s[24:27], s47 offen offset:2048
    v_mfma_f32_16x16x32_bf16 v[64:67], v[176:179], a[200:203], v[64:67]
    ds_read_b64_tr_b16 v[210:211], v226 offset:25088
    v_mfma_f32_16x16x32_bf16 v[72:75], v[176:179], a[204:207], v[72:75]
    v_mfma_f32_16x16x32_bf16 v[52:55], v[180:183], a[56:59], v[52:55]
    ds_read_b64_tr_b16 v[212:213], v227 offset:24576
    v_mfma_f32_16x16x32_bf16 v[60:63], v[180:183], a[60:63], v[60:63]
    buffer_load_dwordx4 a[236:239], v236, s[24:27], s47 offen offset:2304
    v_mfma_f32_16x16x32_bf16 v[68:71], v[180:183], a[200:203], v[68:71]
    ds_read_b64_tr_b16 v[214:215], v227 offset:25088
    v_mfma_f32_16x16x32_bf16 v[76:79], v[180:183], a[204:207], v[76:79]
    s_waitcnt lgkmcnt(4)
    s_waitcnt vmcnt(12)
    v_mfma_f32_16x16x32_bf16 v[16:19], v[192:195], a[64:67], v[16:19]
    ds_read_b64_tr_b16 v[176:177], v226 offset:20480
    v_mfma_f32_16x16x32_bf16 v[24:27], v[192:195], a[68:71], v[24:27]
    s_add_u32 s46, s56, 24576
    v_mfma_f32_16x16x32_bf16 v[32:35], v[192:195], a[208:211], v[32:35]
    ds_read_b64_tr_b16 v[178:179], v226 offset:20992
    v_mfma_f32_16x16x32_bf16 v[40:43], v[192:195], a[212:215], v[40:43]
    buffer_load_dwordx4 a[96:99], v236, s[24:27], s46 offen offset:0
    v_mfma_f32_16x16x32_bf16 v[20:23], v[196:199], a[64:67], v[20:23]
    ds_read_b64_tr_b16 v[180:181], v227 offset:20480
    v_mfma_f32_16x16x32_bf16 v[28:31], v[196:199], a[68:71], v[28:31]
    buffer_load_dwordx4 a[100:103], v236, s[24:27], s46 offen offset:256
    v_mfma_f32_16x16x32_bf16 v[36:39], v[196:199], a[208:211], v[36:39]
    ds_read_b64_tr_b16 v[182:183], v227 offset:20992
    v_mfma_f32_16x16x32_bf16 v[44:47], v[196:199], a[212:215], v[44:47]
    s_waitcnt lgkmcnt(4)
    v_mfma_f32_16x16x32_bf16 v[48:51], v[208:211], a[64:67], v[48:51]
    ds_read_b64_tr_b16 v[192:193], v226 offset:16384
    v_mfma_f32_16x16x32_bf16 v[56:59], v[208:211], a[68:71], v[56:59]
    s_add_u32 s47, s57, 24576
    v_mfma_f32_16x16x32_bf16 v[64:67], v[208:211], a[208:211], v[64:67]
    ds_read_b64_tr_b16 v[194:195], v226 offset:16896
    v_mfma_f32_16x16x32_bf16 v[72:75], v[208:211], a[212:215], v[72:75]
    buffer_load_dwordx4 a[240:243], v236, s[24:27], s47 offen offset:0
    v_mfma_f32_16x16x32_bf16 v[52:55], v[212:215], a[64:67], v[52:55]
    ds_read_b64_tr_b16 v[196:197], v227 offset:16384
    v_mfma_f32_16x16x32_bf16 v[60:63], v[212:215], a[68:71], v[60:63]
    buffer_load_dwordx4 a[244:247], v236, s[24:27], s47 offen offset:256
    v_mfma_f32_16x16x32_bf16 v[68:71], v[212:215], a[208:211], v[68:71]
    ds_read_b64_tr_b16 v[198:199], v227 offset:16896
    v_mfma_f32_16x16x32_bf16 v[76:79], v[212:215], a[212:215], v[76:79]
    s_waitcnt lgkmcnt(4)
    s_waitcnt vmcnt(12)
    v_mfma_f32_16x16x32_bf16 v[16:19], v[176:179], a[72:75], v[16:19]
    ds_read_b64_tr_b16 v[208:209], v226 offset:12288
    v_mfma_f32_16x16x32_bf16 v[24:27], v[176:179], a[76:79], v[24:27]
    buffer_load_dwordx4 a[104:107], v236, s[24:27], s46 offen offset:2048
    v_mfma_f32_16x16x32_bf16 v[32:35], v[176:179], a[216:219], v[32:35]
    ds_read_b64_tr_b16 v[210:211], v226 offset:12800
    v_mfma_f32_16x16x32_bf16 v[40:43], v[176:179], a[220:223], v[40:43]
    v_mfma_f32_16x16x32_bf16 v[20:23], v[180:183], a[72:75], v[20:23]
    ds_read_b64_tr_b16 v[212:213], v227 offset:12288
    v_mfma_f32_16x16x32_bf16 v[28:31], v[180:183], a[76:79], v[28:31]
    buffer_load_dwordx4 a[108:111], v236, s[24:27], s46 offen offset:2304
    v_mfma_f32_16x16x32_bf16 v[36:39], v[180:183], a[216:219], v[36:39]
    ds_read_b64_tr_b16 v[214:215], v227 offset:12800
    v_mfma_f32_16x16x32_bf16 v[44:47], v[180:183], a[220:223], v[44:47]
    s_waitcnt lgkmcnt(4)
    v_mfma_f32_16x16x32_bf16 v[48:51], v[192:195], a[72:75], v[48:51]
    ds_read_b64_tr_b16 v[176:177], v226 offset:8192
    v_mfma_f32_16x16x32_bf16 v[56:59], v[192:195], a[76:79], v[56:59]
    buffer_load_dwordx4 a[248:251], v236, s[24:27], s47 offen offset:2048
    v_mfma_f32_16x16x32_bf16 v[64:67], v[192:195], a[216:219], v[64:67]
    ds_read_b64_tr_b16 v[178:179], v226 offset:8704
    v_mfma_f32_16x16x32_bf16 v[72:75], v[192:195], a[220:223], v[72:75]
    v_mfma_f32_16x16x32_bf16 v[52:55], v[196:199], a[72:75], v[52:55]
    ds_read_b64_tr_b16 v[180:181], v227 offset:8192
    v_mfma_f32_16x16x32_bf16 v[60:63], v[196:199], a[76:79], v[60:63]
    buffer_load_dwordx4 a[252:255], v236, s[24:27], s47 offen offset:2304
    v_mfma_f32_16x16x32_bf16 v[68:71], v[196:199], a[216:219], v[68:71]
    ds_read_b64_tr_b16 v[182:183], v227 offset:8704
    v_mfma_f32_16x16x32_bf16 v[76:79], v[196:199], a[220:223], v[76:79]
    s_waitcnt lgkmcnt(4)
    s_waitcnt vmcnt(12)
    v_mfma_f32_16x16x32_bf16 v[16:19], v[208:211], a[80:83], v[16:19]
    ds_read_b64_tr_b16 v[192:193], v226 offset:4096
    v_mfma_f32_16x16x32_bf16 v[24:27], v[208:211], a[84:87], v[24:27]
    s_add_u32 s46, s56, 28672
    v_mfma_f32_16x16x32_bf16 v[32:35], v[208:211], a[224:227], v[32:35]
    ds_read_b64_tr_b16 v[194:195], v226 offset:4608
    v_mfma_f32_16x16x32_bf16 v[40:43], v[208:211], a[228:231], v[40:43]
    buffer_load_dwordx4 a[112:115], v236, s[24:27], s46 offen offset:0
    v_mfma_f32_16x16x32_bf16 v[20:23], v[212:215], a[80:83], v[20:23]
    ds_read_b64_tr_b16 v[196:197], v227 offset:4096
    v_mfma_f32_16x16x32_bf16 v[28:31], v[212:215], a[84:87], v[28:31]
    buffer_load_dwordx4 a[116:119], v236, s[24:27], s46 offen offset:256
    v_mfma_f32_16x16x32_bf16 v[36:39], v[212:215], a[224:227], v[36:39]
    ds_read_b64_tr_b16 v[198:199], v227 offset:4608
    v_mfma_f32_16x16x32_bf16 v[44:47], v[212:215], a[228:231], v[44:47]
    s_waitcnt lgkmcnt(4)
    v_mfma_f32_16x16x32_bf16 v[48:51], v[176:179], a[80:83], v[48:51]
    ds_read_b64_tr_b16 v[208:209], v226 offset:0
    v_mfma_f32_16x16x32_bf16 v[56:59], v[176:179], a[84:87], v[56:59]
    s_add_u32 s47, s57, 28672
    v_mfma_f32_16x16x32_bf16 v[64:67], v[176:179], a[224:227], v[64:67]
    ds_read_b64_tr_b16 v[210:211], v226 offset:512
    v_mfma_f32_16x16x32_bf16 v[72:75], v[176:179], a[228:231], v[72:75]
    buffer_load_dwordx4 v[144:147], v236, s[24:27], s47 offen offset:0
    v_mfma_f32_16x16x32_bf16 v[52:55], v[180:183], a[80:83], v[52:55]
    ds_read_b64_tr_b16 v[212:213], v227 offset:0
    v_mfma_f32_16x16x32_bf16 v[60:63], v[180:183], a[84:87], v[60:63]
    buffer_load_dwordx4 v[148:151], v236, s[24:27], s47 offen offset:256
    v_mfma_f32_16x16x32_bf16 v[68:71], v[180:183], a[224:227], v[68:71]
    ds_read_b64_tr_b16 v[214:215], v227 offset:512
    v_mfma_f32_16x16x32_bf16 v[76:79], v[180:183], a[228:231], v[76:79]
    s_waitcnt lgkmcnt(4)
    s_waitcnt vmcnt(12)
    v_mfma_f32_16x16x32_bf16 v[16:19], v[192:195], a[88:91], v[16:19]
    s_barrier
    v_mfma_f32_16x16x32_bf16 v[24:27], v[192:195], a[92:95], v[24:27]
    ds_read_b64_tr_b16 v[176:177], v224 offset:61440
    v_mfma_f32_16x16x32_bf16 v[32:35], v[192:195], a[232:235], v[32:35]
    buffer_load_dwordx4 a[120:123], v236, s[24:27], s46 offen offset:2048
    v_mfma_f32_16x16x32_bf16 v[40:43], v[192:195], a[236:239], v[40:43]
    ds_read_b64_tr_b16 v[178:179], v224 offset:61952
    v_mfma_f32_16x16x32_bf16 v[20:23], v[196:199], a[88:91], v[20:23]
    ds_read_b64_tr_b16 v[180:181], v225 offset:61440
    v_mfma_f32_16x16x32_bf16 v[28:31], v[196:199], a[92:95], v[28:31]
    buffer_load_dwordx4 a[124:127], v236, s[24:27], s46 offen offset:2304
    v_mfma_f32_16x16x32_bf16 v[36:39], v[196:199], a[232:235], v[36:39]
    ds_read_b64_tr_b16 v[182:183], v225 offset:61952
    v_mfma_f32_16x16x32_bf16 v[44:47], v[196:199], a[236:239], v[44:47]
    s_waitcnt lgkmcnt(4)
    v_mfma_f32_16x16x32_bf16 v[48:51], v[208:211], a[88:91], v[48:51]
    ds_read_b64_tr_b16 v[192:193], v224 offset:57344
    v_mfma_f32_16x16x32_bf16 v[56:59], v[208:211], a[92:95], v[56:59]
    buffer_load_dwordx4 v[152:155], v236, s[24:27], s47 offen offset:2048
    v_mfma_f32_16x16x32_bf16 v[64:67], v[208:211], a[232:235], v[64:67]
    ds_read_b64_tr_b16 v[194:195], v224 offset:57856
    v_mfma_f32_16x16x32_bf16 v[72:75], v[208:211], a[236:239], v[72:75]
    v_mfma_f32_16x16x32_bf16 v[52:55], v[212:215], a[88:91], v[52:55]
    ds_read_b64_tr_b16 v[196:197], v225 offset:57344
    v_mfma_f32_16x16x32_bf16 v[60:63], v[212:215], a[92:95], v[60:63]
    buffer_load_dwordx4 v[156:159], v236, s[24:27], s47 offen offset:2304
    v_mfma_f32_16x16x32_bf16 v[68:71], v[212:215], a[232:235], v[68:71]
    ds_read_b64_tr_b16 v[198:199], v225 offset:57856
    v_mfma_f32_16x16x32_bf16 v[76:79], v[212:215], a[236:239], v[76:79]
    s_waitcnt lgkmcnt(4)
    s_waitcnt vmcnt(12)
    v_mfma_f32_16x16x32_bf16 v[16:19], v[176:179], a[96:99], v[16:19]
    ds_read_b64_tr_b16 v[208:209], v224 offset:53248
    s_add_u32 m0, s40, 143360
    v_mfma_f32_16x16x32_bf16 v[24:27], v[176:179], a[100:103], v[24:27]
    s_add_u32 s45, s36, 5013504
    ds_read_b64_tr_b16 v[210:211], v224 offset:53760
    v_mfma_f32_16x16x32_bf16 v[32:35], v[176:179], a[240:243], v[32:35]
    buffer_load_dwordx4 v233, s[12:15], s45 offen  lds
    v_mfma_f32_16x16x32_bf16 v[40:43], v[176:179], a[244:247], v[40:43]
    ds_read_b64_tr_b16 v[212:213], v225 offset:53248
    s_add_u32 s46, s56, 32768
    v_mfma_f32_16x16x32_bf16 v[20:23], v[180:183], a[96:99], v[20:23]
    buffer_load_dwordx4 a[128:131], v236, s[24:27], s46 offen offset:0
    v_mfma_f32_16x16x32_bf16 v[28:31], v[180:183], a[100:103], v[28:31]
    ds_read_b64_tr_b16 v[214:215], v225 offset:53760
    v_mfma_f32_16x16x32_bf16 v[36:39], v[180:183], a[240:243], v[36:39]
    buffer_load_dwordx4 a[132:135], v236, s[24:27], s46 offen offset:256
    v_mfma_f32_16x16x32_bf16 v[44:47], v[180:183], a[244:247], v[44:47]
    s_waitcnt lgkmcnt(4)
    v_mfma_f32_16x16x32_bf16 v[48:51], v[192:195], a[96:99], v[48:51]
    ds_read_b64_tr_b16 v[176:177], v224 offset:49152
    s_add_u32 m0, s40, 139264
    v_mfma_f32_16x16x32_bf16 v[56:59], v[192:195], a[100:103], v[56:59]
    s_add_u32 s45, s36, 5013504
    ds_read_b64_tr_b16 v[178:179], v224 offset:49664
    v_mfma_f32_16x16x32_bf16 v[64:67], v[192:195], a[240:243], v[64:67]
    buffer_load_dwordx4 v233, s[16:19], s45 offen  lds
    v_mfma_f32_16x16x32_bf16 v[72:75], v[192:195], a[244:247], v[72:75]
    ds_read_b64_tr_b16 v[180:181], v225 offset:49152
    s_add_u32 s47, s57, 32768
    v_mfma_f32_16x16x32_bf16 v[52:55], v[196:199], a[96:99], v[52:55]
    buffer_load_dwordx4 v[160:163], v236, s[24:27], s47 offen offset:0
    v_mfma_f32_16x16x32_bf16 v[60:63], v[196:199], a[100:103], v[60:63]
    ds_read_b64_tr_b16 v[182:183], v225 offset:49664
    v_mfma_f32_16x16x32_bf16 v[68:71], v[196:199], a[240:243], v[68:71]
    buffer_load_dwordx4 v[164:167], v236, s[24:27], s47 offen offset:256
    v_mfma_f32_16x16x32_bf16 v[76:79], v[196:199], a[244:247], v[76:79]
    s_waitcnt lgkmcnt(4)
    s_waitcnt vmcnt(14)
    v_mfma_f32_16x16x32_bf16 v[16:19], v[208:211], a[104:107], v[16:19]
    ds_read_b64_tr_b16 v[192:193], v224 offset:45056
    s_add_u32 m0, s40, 135168
    v_mfma_f32_16x16x32_bf16 v[24:27], v[208:211], a[108:111], v[24:27]
    s_add_u32 s45, s36, 128
    ds_read_b64_tr_b16 v[194:195], v224 offset:45568
    v_mfma_f32_16x16x32_bf16 v[32:35], v[208:211], a[248:251], v[32:35]
    buffer_load_dwordx4 v233, s[12:15], s45 offen  lds
    v_mfma_f32_16x16x32_bf16 v[40:43], v[208:211], a[252:255], v[40:43]
    ds_read_b64_tr_b16 v[196:197], v225 offset:45056
    v_mfma_f32_16x16x32_bf16 v[20:23], v[212:215], a[104:107], v[20:23]
    buffer_load_dwordx4 a[136:139], v236, s[24:27], s46 offen offset:2048
    v_mfma_f32_16x16x32_bf16 v[28:31], v[212:215], a[108:111], v[28:31]
    ds_read_b64_tr_b16 v[198:199], v225 offset:45568
    v_mfma_f32_16x16x32_bf16 v[36:39], v[212:215], a[248:251], v[36:39]
    buffer_load_dwordx4 a[140:143], v236, s[24:27], s46 offen offset:2304
    v_mfma_f32_16x16x32_bf16 v[44:47], v[212:215], a[252:255], v[44:47]
    s_waitcnt lgkmcnt(4)
    v_mfma_f32_16x16x32_bf16 v[48:51], v[176:179], a[104:107], v[48:51]
    ds_read_b64_tr_b16 v[208:209], v224 offset:40960
    s_add_u32 m0, s40, 131072
    v_mfma_f32_16x16x32_bf16 v[56:59], v[176:179], a[108:111], v[56:59]
    s_add_u32 s45, s36, 128
    ds_read_b64_tr_b16 v[210:211], v224 offset:41472
    v_mfma_f32_16x16x32_bf16 v[64:67], v[176:179], a[248:251], v[64:67]
    buffer_load_dwordx4 v233, s[16:19], s45 offen  lds
    v_mfma_f32_16x16x32_bf16 v[72:75], v[176:179], a[252:255], v[72:75]
    ds_read_b64_tr_b16 v[212:213], v225 offset:40960
    v_mfma_f32_16x16x32_bf16 v[52:55], v[180:183], a[104:107], v[52:55]
    buffer_load_dwordx4 v[168:171], v236, s[24:27], s47 offen offset:2048
    v_mfma_f32_16x16x32_bf16 v[60:63], v[180:183], a[108:111], v[60:63]
    ds_read_b64_tr_b16 v[214:215], v225 offset:41472
    v_mfma_f32_16x16x32_bf16 v[68:71], v[180:183], a[248:251], v[68:71]
    buffer_load_dwordx4 v[172:175], v236, s[24:27], s47 offen offset:2304
    v_mfma_f32_16x16x32_bf16 v[76:79], v[180:183], a[252:255], v[76:79]
    s_waitcnt lgkmcnt(4)
    s_waitcnt vmcnt(16)
    v_mfma_f32_16x16x32_bf16 v[16:19], v[192:195], a[112:115], v[16:19]
    ds_read_b64_tr_b16 v[176:177], v224 offset:36864
    v_mfma_f32_16x16x32_bf16 v[24:27], v[192:195], a[116:119], v[24:27]
    s_add_u32 m0, s40, 126976
    v_mfma_f32_16x16x32_bf16 v[32:35], v[192:195], v[144:147], v[32:35]
    ds_read_b64_tr_b16 v[178:179], v224 offset:37376
    v_mfma_f32_16x16x32_bf16 v[40:43], v[192:195], v[148:151], v[40:43]
    s_add_u32 s45, s36, 295040
    v_mfma_f32_16x16x32_bf16 v[20:23], v[196:199], a[112:115], v[20:23]
    ds_read_b64_tr_b16 v[180:181], v225 offset:36864
    v_mfma_f32_16x16x32_bf16 v[28:31], v[196:199], a[116:119], v[28:31]
    buffer_load_dwordx4 v233, s[12:15], s45 offen  lds
    v_mfma_f32_16x16x32_bf16 v[36:39], v[196:199], v[144:147], v[36:39]
    ds_read_b64_tr_b16 v[182:183], v225 offset:37376
    v_mfma_f32_16x16x32_bf16 v[44:47], v[196:199], v[148:151], v[44:47]
    s_waitcnt lgkmcnt(4)
    v_mfma_f32_16x16x32_bf16 v[48:51], v[208:211], a[112:115], v[48:51]
    ds_read_b64_tr_b16 v[192:193], v224 offset:32768
    v_mfma_f32_16x16x32_bf16 v[56:59], v[208:211], a[116:119], v[56:59]
    s_add_u32 m0, s40, 122880
    v_mfma_f32_16x16x32_bf16 v[64:67], v[208:211], v[144:147], v[64:67]
    ds_read_b64_tr_b16 v[194:195], v224 offset:33280
    v_mfma_f32_16x16x32_bf16 v[72:75], v[208:211], v[148:151], v[72:75]
    s_add_u32 s45, s36, 295040
    v_mfma_f32_16x16x32_bf16 v[52:55], v[212:215], a[112:115], v[52:55]
    ds_read_b64_tr_b16 v[196:197], v225 offset:32768
    v_mfma_f32_16x16x32_bf16 v[60:63], v[212:215], a[116:119], v[60:63]
    buffer_load_dwordx4 v233, s[16:19], s45 offen  lds
    v_mfma_f32_16x16x32_bf16 v[68:71], v[212:215], v[144:147], v[68:71]
    ds_read_b64_tr_b16 v[198:199], v225 offset:33280
    v_mfma_f32_16x16x32_bf16 v[76:79], v[212:215], v[148:151], v[76:79]
    s_waitcnt lgkmcnt(4)
    s_waitcnt vmcnt(14)
    v_mfma_f32_16x16x32_bf16 v[16:19], v[176:179], a[120:123], v[16:19]
    s_waitcnt vmcnt(7)
    s_barrier
    v_mfma_f32_16x16x32_bf16 v[24:27], v[176:179], a[124:127], v[24:27]
    ds_read_b64_tr_b16 v[208:209], v224 offset:28672
    s_add_u32 m0, s40, 118784
    v_mfma_f32_16x16x32_bf16 v[32:35], v[176:179], v[152:155], v[32:35]
    s_add_u32 s45, s36, 589952
    ds_read_b64_tr_b16 v[210:211], v224 offset:29184
    v_mfma_f32_16x16x32_bf16 v[40:43], v[176:179], v[156:159], v[40:43]
    buffer_load_dwordx4 v233, s[12:15], s45 offen  lds
    v_mfma_f32_16x16x32_bf16 v[20:23], v[180:183], a[120:123], v[20:23]
    ds_read_b64_tr_b16 v[212:213], v225 offset:28672
    s_add_u32 m0, s40, 114688
    v_mfma_f32_16x16x32_bf16 v[28:31], v[180:183], a[124:127], v[28:31]
    s_add_u32 s45, s36, 589952
    ds_read_b64_tr_b16 v[214:215], v225 offset:29184
    v_mfma_f32_16x16x32_bf16 v[36:39], v[180:183], v[152:155], v[36:39]
    buffer_load_dwordx4 v233, s[16:19], s45 offen  lds
    v_mfma_f32_16x16x32_bf16 v[44:47], v[180:183], v[156:159], v[44:47]
    s_waitcnt lgkmcnt(4)
    v_mfma_f32_16x16x32_bf16 v[48:51], v[192:195], a[120:123], v[48:51]
    ds_read_b64_tr_b16 v[176:177], v224 offset:24576
    s_add_u32 m0, s40, 110592
    v_mfma_f32_16x16x32_bf16 v[56:59], v[192:195], a[124:127], v[56:59]
    s_add_u32 s45, s36, 884864
    v_mfma_f32_16x16x32_bf16 v[64:67], v[192:195], v[152:155], v[64:67]
    ds_read_b64_tr_b16 v[178:179], v224 offset:25088
    v_mfma_f32_16x16x32_bf16 v[72:75], v[192:195], v[156:159], v[72:75]
    buffer_load_dwordx4 v233, s[12:15], s45 offen  lds
    v_mfma_f32_16x16x32_bf16 v[52:55], v[196:199], a[120:123], v[52:55]
    ds_read_b64_tr_b16 v[180:181], v225 offset:24576
    s_add_u32 m0, s40, 106496
    v_mfma_f32_16x16x32_bf16 v[60:63], v[196:199], a[124:127], v[60:63]
    s_add_u32 s45, s36, 884864
    ds_read_b64_tr_b16 v[182:183], v225 offset:25088
    v_mfma_f32_16x16x32_bf16 v[68:71], v[196:199], v[152:155], v[68:71]
    buffer_load_dwordx4 v233, s[16:19], s45 offen  lds
    v_mfma_f32_16x16x32_bf16 v[76:79], v[196:199], v[156:159], v[76:79]
    s_waitcnt lgkmcnt(4)
    v_mfma_f32_16x16x32_bf16 v[16:19], v[208:211], a[128:131], v[16:19]
    ds_read_b64_tr_b16 v[192:193], v228 offset:12288
    s_add_u32 m0, s40, 102400
    v_mfma_f32_16x16x32_bf16 v[24:27], v[208:211], a[132:135], v[24:27]
    s_add_u32 s45, s36, 1179776
    v_mfma_f32_16x16x32_bf16 v[32:35], v[208:211], v[160:163], v[32:35]
    ds_read_b64_tr_b16 v[194:195], v228 offset:12800
    v_mfma_f32_16x16x32_bf16 v[40:43], v[208:211], v[164:167], v[40:43]
    buffer_load_dwordx4 v233, s[12:15], s45 offen  lds
    v_mfma_f32_16x16x32_bf16 v[20:23], v[212:215], a[128:131], v[20:23]
    ds_read_b64_tr_b16 v[196:197], v229 offset:12288
    s_add_u32 m0, s40, 98304
    v_mfma_f32_16x16x32_bf16 v[28:31], v[212:215], a[132:135], v[28:31]
    s_add_u32 s45, s36, 1179776
    ds_read_b64_tr_b16 v[198:199], v229 offset:12800
    v_mfma_f32_16x16x32_bf16 v[36:39], v[212:215], v[160:163], v[36:39]
    buffer_load_dwordx4 v233, s[16:19], s45 offen  lds
    v_mfma_f32_16x16x32_bf16 v[44:47], v[212:215], v[164:167], v[44:47]
    s_waitcnt lgkmcnt(4)
    v_mfma_f32_16x16x32_bf16 v[48:51], v[176:179], a[128:131], v[48:51]
    ds_read_b64_tr_b16 v[208:209], v228 offset:8192
    s_add_u32 m0, s40, 94208
    v_mfma_f32_16x16x32_bf16 v[56:59], v[176:179], a[132:135], v[56:59]
    s_add_u32 s45, s36, 1474688
    v_mfma_f32_16x16x32_bf16 v[64:67], v[176:179], v[160:163], v[64:67]
    ds_read_b64_tr_b16 v[210:211], v228 offset:8704
    v_mfma_f32_16x16x32_bf16 v[72:75], v[176:179], v[164:167], v[72:75]
    buffer_load_dwordx4 v233, s[12:15], s45 offen  lds
    v_mfma_f32_16x16x32_bf16 v[52:55], v[180:183], a[128:131], v[52:55]
    ds_read_b64_tr_b16 v[212:213], v229 offset:8192
    s_add_u32 m0, s40, 90112
    v_mfma_f32_16x16x32_bf16 v[60:63], v[180:183], a[132:135], v[60:63]
    s_add_u32 s45, s36, 1474688
    ds_read_b64_tr_b16 v[214:215], v229 offset:8704
    v_mfma_f32_16x16x32_bf16 v[68:71], v[180:183], v[160:163], v[68:71]
    buffer_load_dwordx4 v233, s[16:19], s45 offen  lds
    v_mfma_f32_16x16x32_bf16 v[76:79], v[180:183], v[164:167], v[76:79]
    s_waitcnt lgkmcnt(4)
    s_waitcnt vmcnt(10)
    v_mfma_f32_16x16x32_bf16 v[16:19], v[192:195], a[136:139], v[16:19]
    ds_read_b64_tr_b16 v[176:177], v228 offset:4096
    s_add_u32 m0, s40, 86016
    v_mfma_f32_16x16x32_bf16 v[24:27], v[192:195], a[140:143], v[24:27]
    s_add_u32 s45, s36, 1769600
    v_mfma_f32_16x16x32_bf16 v[32:35], v[192:195], v[168:171], v[32:35]
    ds_read_b64_tr_b16 v[178:179], v228 offset:4608
    v_mfma_f32_16x16x32_bf16 v[40:43], v[192:195], v[172:175], v[40:43]
    buffer_load_dwordx4 v233, s[12:15], s45 offen  lds
    v_mfma_f32_16x16x32_bf16 v[20:23], v[196:199], a[136:139], v[20:23]
    ds_read_b64_tr_b16 v[180:181], v229 offset:4096
    s_add_u32 m0, s40, 81920
    v_mfma_f32_16x16x32_bf16 v[28:31], v[196:199], a[140:143], v[28:31]
    s_add_u32 s45, s36, 1769600
    ds_read_b64_tr_b16 v[182:183], v229 offset:4608
    v_mfma_f32_16x16x32_bf16 v[36:39], v[196:199], v[168:171], v[36:39]
    buffer_load_dwordx4 v233, s[16:19], s45 offen  lds
    v_mfma_f32_16x16x32_bf16 v[44:47], v[196:199], v[172:175], v[44:47]
    s_waitcnt lgkmcnt(4)
    v_mfma_f32_16x16x32_bf16 v[48:51], v[208:211], a[136:139], v[48:51]
    s_waitcnt vmcnt(6)
    s_barrier
    v_mfma_f32_16x16x32_bf16 v[56:59], v[208:211], a[140:143], v[56:59]
    ds_read_b64_tr_b16 v[192:193], v228 offset:0
    s_add_u32 m0, s40, 143360
    v_mfma_f32_16x16x32_bf16 v[64:67], v[208:211], v[168:171], v[64:67]
    s_add_u32 s45, s36, 2064512
    ds_read_b64_tr_b16 v[194:195], v228 offset:512
    v_mfma_f32_16x16x32_bf16 v[72:75], v[208:211], v[172:175], v[72:75]
    buffer_load_dwordx4 v233, s[12:15], s45 offen  lds
    v_mfma_f32_16x16x32_bf16 v[52:55], v[212:215], a[136:139], v[52:55]
    ds_read_b64_tr_b16 v[196:197], v229 offset:0
    s_add_u32 m0, s40, 139264
    v_mfma_f32_16x16x32_bf16 v[60:63], v[212:215], a[140:143], v[60:63]
    s_add_u32 s45, s36, 2064512
    ds_read_b64_tr_b16 v[198:199], v229 offset:512
    v_mfma_f32_16x16x32_bf16 v[68:71], v[212:215], v[168:171], v[68:71]
    buffer_load_dwordx4 v233, s[16:19], s45 offen  lds
    v_mfma_f32_16x16x32_bf16 v[76:79], v[212:215], v[172:175], v[76:79]
    s_waitcnt lgkmcnt(4)
    v_mfma_f32_16x16x32_bf16 v[80:83], v[176:179], a[0:3], 0
    ds_read_b64_tr_b16 v[208:209], v226 offset:61440
    s_add_u32 m0, s40, 77824
    v_mfma_f32_16x16x32_bf16 v[88:91], v[176:179], a[4:7], 0
    s_add_u32 s45, s36, 2359424
    v_mfma_f32_16x16x32_bf16 v[96:99], v[176:179], a[144:147], 0
    ds_read_b64_tr_b16 v[210:211], v226 offset:61952
    v_mfma_f32_16x16x32_bf16 v[104:107], v[176:179], a[148:151], 0
    buffer_load_dwordx4 v233, s[12:15], s45 offen  lds
    v_mfma_f32_16x16x32_bf16 v[84:87], v[180:183], a[0:3], 0
    ds_read_b64_tr_b16 v[212:213], v227 offset:61440
    s_add_u32 m0, s40, 73728
    v_mfma_f32_16x16x32_bf16 v[92:95], v[180:183], a[4:7], 0
    s_add_u32 s45, s36, 2359424
    ds_read_b64_tr_b16 v[214:215], v227 offset:61952
    v_mfma_f32_16x16x32_bf16 v[100:103], v[180:183], a[144:147], 0
    buffer_load_dwordx4 v233, s[16:19], s45 offen  lds
    v_mfma_f32_16x16x32_bf16 v[108:111], v[180:183], a[148:151], 0
    s_waitcnt lgkmcnt(4)
    v_mfma_f32_16x16x32_bf16 v[112:115], v[192:195], a[0:3], 0
    ds_read_b64_tr_b16 v[176:177], v226 offset:57344
    s_add_u32 m0, s40, 69632
    v_mfma_f32_16x16x32_bf16 v[120:123], v[192:195], a[4:7], 0
    s_add_u32 s45, s36, 2654336
    v_mul_f32 v16, s43, v16
    v_mul_f32 v17, s43, v17
    v_mfma_f32_16x16x32_bf16 v[128:131], v[192:195], a[144:147], 0
    ds_read_b64_tr_b16 v[178:179], v226 offset:57856
    v_mul_f32 v18, s43, v18
    v_mfma_f32_16x16x32_bf16 v[136:139], v[192:195], a[148:151], 0
    buffer_load_dwordx4 v233, s[12:15], s45 offen  lds
    v_mfma_f32_16x16x32_bf16 v[116:119], v[196:199], a[0:3], 0
    ds_read_b64_tr_b16 v[180:181], v227 offset:57344
    s_add_u32 m0, s40, 65536
    v_mfma_f32_16x16x32_bf16 v[124:127], v[196:199], a[4:7], 0
    s_add_u32 s45, s36, 2654336
    ds_read_b64_tr_b16 v[182:183], v227 offset:57856
    v_mfma_f32_16x16x32_bf16 v[132:135], v[196:199], a[144:147], 0
    buffer_load_dwordx4 v233, s[16:19], s45 offen  lds
    v_mfma_f32_16x16x32_bf16 v[140:143], v[196:199], a[148:151], 0
    s_waitcnt lgkmcnt(4)
    v_exp_f32 v16, v16
    v_mfma_f32_16x16x32_bf16 v[80:83], v[208:211], a[8:11], v[80:83]
    ds_read_b64_tr_b16 v[192:193], v226 offset:53248
    s_add_u32 m0, s40, 61440
    v_mfma_f32_16x16x32_bf16 v[88:91], v[208:211], a[12:15], v[88:91]
    s_add_u32 s45, s36, 2949248
    v_exp_f32 v17, v17
    v_mfma_f32_16x16x32_bf16 v[96:99], v[208:211], a[152:155], v[96:99]
    ds_read_b64_tr_b16 v[194:195], v226 offset:53760
    v_mul_f32 v19, s43, v19
    v_mfma_f32_16x16x32_bf16 v[104:107], v[208:211], a[156:159], v[104:107]
    buffer_load_dwordx4 v233, s[12:15], s45 offen  lds
    v_mfma_f32_16x16x32_bf16 v[84:87], v[212:215], a[8:11], v[84:87]
    ds_read_b64_tr_b16 v[196:197], v227 offset:53248
    s_add_u32 m0, s40, 57344
    v_mfma_f32_16x16x32_bf16 v[92:95], v[212:215], a[12:15], v[92:95]
    s_add_u32 s45, s36, 2949248
    ds_read_b64_tr_b16 v[198:199], v227 offset:53760
    v_mfma_f32_16x16x32_bf16 v[100:103], v[212:215], a[152:155], v[100:103]
    buffer_load_dwordx4 v233, s[16:19], s45 offen  lds
    v_mfma_f32_16x16x32_bf16 v[108:111], v[212:215], a[156:159], v[108:111]
    s_waitcnt lgkmcnt(4)
    v_exp_f32 v18, v18
    v_mfma_f32_16x16x32_bf16 v[112:115], v[176:179], a[8:11], v[112:115]
    ds_read_b64_tr_b16 v[208:209], v226 offset:49152
    s_add_u32 m0, s40, 53248
    v_mfma_f32_16x16x32_bf16 v[120:123], v[176:179], a[12:15], v[120:123]
    s_add_u32 s45, s36, 3244160
    v_exp_f32 v19, v19
    v_mfma_f32_16x16x32_bf16 v[128:131], v[176:179], a[152:155], v[128:131]
    ds_read_b64_tr_b16 v[210:211], v226 offset:49664
    v_add_f32 v16, 1.0, v16
    v_mfma_f32_16x16x32_bf16 v[136:139], v[176:179], a[156:159], v[136:139]
    buffer_load_dwordx4 v233, s[12:15], s45 offen  lds
    v_mfma_f32_16x16x32_bf16 v[116:119], v[180:183], a[8:11], v[116:119]
    ds_read_b64_tr_b16 v[212:213], v227 offset:49152
    s_add_u32 m0, s40, 49152
    v_mfma_f32_16x16x32_bf16 v[124:127], v[180:183], a[12:15], v[124:127]
    s_add_u32 s45, s36, 3244160
    ds_read_b64_tr_b16 v[214:215], v227 offset:49664
    v_mfma_f32_16x16x32_bf16 v[132:135], v[180:183], a[152:155], v[132:135]
    buffer_load_dwordx4 v233, s[16:19], s45 offen  lds
    v_mfma_f32_16x16x32_bf16 v[140:143], v[180:183], a[156:159], v[140:143]
    s_waitcnt lgkmcnt(4)
    v_rcp_f32 v16, v16
    v_mfma_f32_16x16x32_bf16 v[80:83], v[192:195], a[16:19], v[80:83]
    ds_read_b64_tr_b16 v[176:177], v226 offset:45056
    s_add_u32 m0, s40, 45056
    v_mfma_f32_16x16x32_bf16 v[88:91], v[192:195], a[20:23], v[88:91]
    s_add_u32 s45, s36, 3539072
    v_add_f32 v17, 1.0, v17
    v_add_f32 v18, 1.0, v18
    v_mfma_f32_16x16x32_bf16 v[96:99], v[192:195], a[160:163], v[96:99]
    ds_read_b64_tr_b16 v[178:179], v226 offset:45568
    v_add_f32 v19, 1.0, v19
    v_mfma_f32_16x16x32_bf16 v[104:107], v[192:195], a[164:167], v[104:107]
    buffer_load_dwordx4 v233, s[12:15], s45 offen  lds
    v_mfma_f32_16x16x32_bf16 v[84:87], v[196:199], a[16:19], v[84:87]
    ds_read_b64_tr_b16 v[180:181], v227 offset:45056
    s_add_u32 m0, s40, 40960
    v_mfma_f32_16x16x32_bf16 v[92:95], v[196:199], a[20:23], v[92:95]
    s_add_u32 s45, s36, 3539072
    ds_read_b64_tr_b16 v[182:183], v227 offset:45568
    v_mfma_f32_16x16x32_bf16 v[100:103], v[196:199], a[160:163], v[100:103]
    buffer_load_dwordx4 v233, s[16:19], s45 offen  lds
    v_mfma_f32_16x16x32_bf16 v[108:111], v[196:199], a[164:167], v[108:111]
    s_waitcnt lgkmcnt(4)
    v_rcp_f32 v17, v17
    v_mfma_f32_16x16x32_bf16 v[112:115], v[208:211], a[16:19], v[112:115]
    ds_read_b64_tr_b16 v[192:193], v226 offset:40960
    s_add_u32 m0, s40, 36864
    v_mfma_f32_16x16x32_bf16 v[120:123], v[208:211], a[20:23], v[120:123]
    s_add_u32 s45, s36, 3833984
    v_rcp_f32 v18, v18
    v_mfma_f32_16x16x32_bf16 v[128:131], v[208:211], a[160:163], v[128:131]
    ds_read_b64_tr_b16 v[194:195], v226 offset:41472
    v_mul_f32 v16, v16, v48
    v_mfma_f32_16x16x32_bf16 v[136:139], v[208:211], a[164:167], v[136:139]
    buffer_load_dwordx4 v233, s[12:15], s45 offen  lds
    v_mfma_f32_16x16x32_bf16 v[116:119], v[212:215], a[16:19], v[116:119]
    ds_read_b64_tr_b16 v[196:197], v227 offset:40960
    s_add_u32 m0, s40, 32768
    v_mfma_f32_16x16x32_bf16 v[124:127], v[212:215], a[20:23], v[124:127]
    s_add_u32 s45, s36, 3833984
    ds_read_b64_tr_b16 v[198:199], v227 offset:41472
    v_mfma_f32_16x16x32_bf16 v[132:135], v[212:215], a[160:163], v[132:135]
    buffer_load_dwordx4 v233, s[16:19], s45 offen  lds
    v_mfma_f32_16x16x32_bf16 v[140:143], v[212:215], a[164:167], v[140:143]
    s_waitcnt lgkmcnt(4)
    v_rcp_f32 v19, v19
    v_mfma_f32_16x16x32_bf16 v[80:83], v[176:179], a[24:27], v[80:83]
    s_waitcnt vmcnt(12)
    s_barrier
    v_mul_f32 v17, v17, v49
    v_mfma_f32_16x16x32_bf16 v[88:91], v[176:179], a[28:31], v[88:91]
    ds_read_b64_tr_b16 v[208:209], v226 offset:36864
    s_add_u32 m0, s40, 126976
    v_mfma_f32_16x16x32_bf16 v[96:99], v[176:179], a[168:171], v[96:99]
    s_add_u32 s45, s36, 4128896
    ds_read_b64_tr_b16 v[210:211], v226 offset:37376
    v_mfma_f32_16x16x32_bf16 v[104:107], v[176:179], a[172:175], v[104:107]
    buffer_load_dwordx4 v233, s[12:15], s45 offen  lds
    v_mfma_f32_16x16x32_bf16 v[84:87], v[180:183], a[24:27], v[84:87]
    ds_read_b64_tr_b16 v[212:213], v227 offset:36864
    s_add_u32 m0, s40, 122880
    v_mfma_f32_16x16x32_bf16 v[92:95], v[180:183], a[28:31], v[92:95]
    s_add_u32 s45, s36, 4128896
    ds_read_b64_tr_b16 v[214:215], v227 offset:37376
    v_mfma_f32_16x16x32_bf16 v[100:103], v[180:183], a[168:171], v[100:103]
    buffer_load_dwordx4 v233, s[16:19], s45 offen  lds
    v_mfma_f32_16x16x32_bf16 v[108:111], v[180:183], a[172:175], v[108:111]
    s_waitcnt lgkmcnt(4)
    v_mul_f32 v18, v18, v50
    v_cvt_pk_bf16_f32 v16, v16, v17
    v_mfma_f32_16x16x32_bf16 v[112:115], v[192:195], a[24:27], v[112:115]
    ds_read_b64_tr_b16 v[176:177], v226 offset:32768
    s_add_u32 m0, s40, 118784
    v_mul_f32 v19, v19, v51
    v_mfma_f32_16x16x32_bf16 v[120:123], v[192:195], a[28:31], v[120:123]
    s_add_u32 s45, s36, 4423808
    v_cvt_pk_bf16_f32 v17, v18, v19
    v_mul_f32 v20, s43, v20
    v_mfma_f32_16x16x32_bf16 v[128:131], v[192:195], a[168:171], v[128:131]
    ds_read_b64_tr_b16 v[178:179], v226 offset:33280
    v_mul_f32 v21, s43, v21
    v_mfma_f32_16x16x32_bf16 v[136:139], v[192:195], a[172:175], v[136:139]
    buffer_load_dwordx4 v233, s[12:15], s45 offen  lds
    v_mfma_f32_16x16x32_bf16 v[116:119], v[196:199], a[24:27], v[116:119]
    ds_read_b64_tr_b16 v[180:181], v227 offset:32768
    s_add_u32 m0, s40, 114688
    v_mul_f32 v22, s43, v22
    v_mfma_f32_16x16x32_bf16 v[124:127], v[196:199], a[28:31], v[124:127]
    s_add_u32 s45, s36, 4423808
    ds_read_b64_tr_b16 v[182:183], v227 offset:33280
    v_mul_f32 v23, s43, v23
    v_mfma_f32_16x16x32_bf16 v[132:135], v[196:199], a[168:171], v[132:135]
    buffer_load_dwordx4 v233, s[16:19], s45 offen  lds
    v_exp_f32 v20, v20
    v_mfma_f32_16x16x32_bf16 v[140:143], v[196:199], a[172:175], v[140:143]
    s_waitcnt lgkmcnt(4)
    v_exp_f32 v21, v21
    v_mfma_f32_16x16x32_bf16 v[80:83], v[208:211], a[32:35], v[80:83]
    ds_read_b64_tr_b16 v[192:193], v226 offset:28672
    s_add_u32 m0, s40, 110592
    v_add_f32 v20, 1.0, v20
    v_mfma_f32_16x16x32_bf16 v[88:91], v[208:211], a[36:39], v[88:91]
    s_add_u32 s45, s36, 4718720
    v_exp_f32 v22, v22
    v_mfma_f32_16x16x32_bf16 v[96:99], v[208:211], a[176:179], v[96:99]
    ds_read_b64_tr_b16 v[194:195], v226 offset:29184
    v_add_f32 v21, 1.0, v21
    v_mfma_f32_16x16x32_bf16 v[104:107], v[208:211], a[180:183], v[104:107]
    buffer_load_dwordx4 v233, s[12:15], s45 offen  lds
    v_mfma_f32_16x16x32_bf16 v[84:87], v[212:215], a[32:35], v[84:87]
    ds_read_b64_tr_b16 v[196:197], v227 offset:28672
    s_add_u32 m0, s40, 28672
    v_exp_f32 v23, v23
    v_mfma_f32_16x16x32_bf16 v[92:95], v[212:215], a[36:39], v[92:95]
    s_add_u32 s45, s36, 4718720
    ds_read_b64_tr_b16 v[198:199], v227 offset:29184
    v_mfma_f32_16x16x32_bf16 v[100:103], v[212:215], a[176:179], v[100:103]
    buffer_load_dwordx4 v233, s[16:19], s45 offen  lds
    v_add_f32 v22, 1.0, v22
    v_mfma_f32_16x16x32_bf16 v[108:111], v[212:215], a[180:183], v[108:111]
    s_waitcnt lgkmcnt(4)
    v_rcp_f32 v20, v20
    v_mfma_f32_16x16x32_bf16 v[112:115], v[176:179], a[32:35], v[112:115]
    ds_read_b64_tr_b16 v[208:209], v226 offset:24576
    s_add_u32 m0, s40, 24576
    v_add_f32 v23, 1.0, v23
    v_mfma_f32_16x16x32_bf16 v[120:123], v[176:179], a[36:39], v[120:123]
    s_add_u32 s45, s36, 5013632
    v_rcp_f32 v21, v21
    v_mfma_f32_16x16x32_bf16 v[128:131], v[176:179], a[176:179], v[128:131]
    ds_read_b64_tr_b16 v[210:211], v226 offset:25088
    v_mul_f32 v20, v20, v52
    v_mfma_f32_16x16x32_bf16 v[136:139], v[176:179], a[180:183], v[136:139]
    buffer_load_dwordx4 v233, s[12:15], s45 offen  lds
    v_mfma_f32_16x16x32_bf16 v[116:119], v[180:183], a[32:35], v[116:119]
    ds_read_b64_tr_b16 v[212:213], v227 offset:24576
    s_add_u32 m0, s40, 20480
    v_rcp_f32 v22, v22
    v_mfma_f32_16x16x32_bf16 v[124:127], v[180:183], a[36:39], v[124:127]
    s_add_u32 s45, s36, 5013632
    ds_read_b64_tr_b16 v[214:215], v227 offset:25088
    v_mfma_f32_16x16x32_bf16 v[132:135], v[180:183], a[176:179], v[132:135]
    buffer_load_dwordx4 v233, s[16:19], s45 offen  lds
    v_mul_f32 v21, v21, v53
    v_mfma_f32_16x16x32_bf16 v[140:143], v[180:183], a[180:183], v[140:143]
    s_waitcnt lgkmcnt(4)
    v_rcp_f32 v23, v23
    v_mfma_f32_16x16x32_bf16 v[80:83], v[192:195], a[40:43], v[80:83]
    ds_read_b64_tr_b16 v[176:177], v226 offset:20480
    s_add_u32 m0, s40, 16384
    v_mfma_f32_16x16x32_bf16 v[88:91], v[192:195], a[44:47], v[88:91]
    s_add_u32 s45, s36, 256
    v_mul_f32 v22, v22, v54
    v_cvt_pk_bf16_f32 v18, v20, v21
    v_mfma_f32_16x16x32_bf16 v[96:99], v[192:195], a[184:187], v[96:99]
    ds_read_b64_tr_b16 v[178:179], v226 offset:20992
    v_mul_f32 v23, v23, v55
    v_mfma_f32_16x16x32_bf16 v[104:107], v[192:195], a[188:191], v[104:107]
    buffer_load_dwordx4 v233, s[12:15], s45 offen  lds
    v_mfma_f32_16x16x32_bf16 v[84:87], v[196:199], a[40:43], v[84:87]
    ds_read_b64_tr_b16 v[180:181], v227 offset:20480
    s_add_u32 m0, s40, 12288
    v_mfma_f32_16x16x32_bf16 v[92:95], v[196:199], a[44:47], v[92:95]
    s_add_u32 s45, s36, 256
    ds_read_b64_tr_b16 v[182:183], v227 offset:20992
    v_mfma_f32_16x16x32_bf16 v[100:103], v[196:199], a[184:187], v[100:103]
    buffer_load_dwordx4 v233, s[16:19], s45 offen  lds
    v_mfma_f32_16x16x32_bf16 v[108:111], v[196:199], a[188:191], v[108:111]
    s_waitcnt lgkmcnt(4)
    v_cvt_pk_bf16_f32 v19, v22, v23
    v_mul_f32 v24, s43, v24
    v_mfma_f32_16x16x32_bf16 v[112:115], v[208:211], a[40:43], v[112:115]
    ds_read_b64_tr_b16 v[192:193], v226 offset:16384
    s_add_u32 m0, s40, 8192
    v_mul_f32 v25, s43, v25
    v_mfma_f32_16x16x32_bf16 v[120:123], v[208:211], a[44:47], v[120:123]
    s_add_u32 s45, s36, 295168
    ds_read_b64_tr_b16 v[194:195], v226 offset:16896
    v_mul_f32 v26, s43, v26
    v_mfma_f32_16x16x32_bf16 v[128:131], v[208:211], a[184:187], v[128:131]
    buffer_load_dwordx4 v233, s[12:15], s45 offen  lds
    v_mul_f32 v27, s43, v27
    v_mfma_f32_16x16x32_bf16 v[136:139], v[208:211], a[188:191], v[136:139]
    ds_read_b64_tr_b16 v[196:197], v227 offset:16384
    v_mfma_f32_16x16x32_bf16 v[116:119], v[212:215], a[40:43], v[116:119]
    s_add_u32 m0, s40, 4096
    ds_read_b64_tr_b16 v[198:199], v227 offset:16896
    v_exp_f32 v24, v24
    v_mfma_f32_16x16x32_bf16 v[124:127], v[212:215], a[44:47], v[124:127]
    s_add_u32 s45, s36, 295168
    ds_write_b128 v239, v[16:19] offset:49152
    v_exp_f32 v25, v25
    v_mfma_f32_16x16x32_bf16 v[132:135], v[212:215], a[184:187], v[132:135]
    buffer_load_dwordx4 v233, s[16:19], s45 offen  lds
    v_mfma_f32_16x16x32_bf16 v[140:143], v[212:215], a[188:191], v[140:143]
    s_waitcnt lgkmcnt(5)
    v_exp_f32 v26, v26
    v_mfma_f32_16x16x32_bf16 v[80:83], v[176:179], a[48:51], v[80:83]
    ds_read_b64_tr_b16 v[208:209], v228 offset:12288
    v_add_f32 v24, 1.0, v24
    v_mfma_f32_16x16x32_bf16 v[88:91], v[176:179], a[52:55], v[88:91]
    s_add_u32 m0, s40, 0
    v_exp_f32 v27, v27
    v_mfma_f32_16x16x32_bf16 v[96:99], v[176:179], a[192:195], v[96:99]
    ds_read_b64_tr_b16 v[210:211], v228 offset:12800
    v_add_f32 v25, 1.0, v25
    v_mfma_f32_16x16x32_bf16 v[104:107], v[176:179], a[196:199], v[104:107]
    s_add_u32 s45, s36, 590080
    ds_read_b64_tr_b16 v[212:213], v229 offset:12288
    v_mfma_f32_16x16x32_bf16 v[84:87], v[180:183], a[48:51], v[84:87]
    buffer_load_dwordx4 v233, s[12:15], s45 offen  lds
    v_add_f32 v26, 1.0, v26
    v_mfma_f32_16x16x32_bf16 v[92:95], v[180:183], a[52:55], v[92:95]
    ds_read_b64_tr_b16 v[214:215], v229 offset:12800
    v_add_f32 v27, 1.0, v27
    v_mfma_f32_16x16x32_bf16 v[100:103], v[180:183], a[192:195], v[100:103]
    buffer_load_dword v246, v237, s[12:15], 0 offen
    v_rcp_f32 v24, v24
    v_mfma_f32_16x16x32_bf16 v[108:111], v[180:183], a[196:199], v[108:111]
    s_waitcnt lgkmcnt(5)
    v_rcp_f32 v25, v25
    v_mfma_f32_16x16x32_bf16 v[112:115], v[192:195], a[48:51], v[112:115]
    ds_read_b64_tr_b16 v[176:177], v228 offset:8192
    v_mul_f32 v24, v24, v56
    v_mfma_f32_16x16x32_bf16 v[120:123], v[192:195], a[52:55], v[120:123]
    v_rcp_f32 v26, v26
    v_mfma_f32_16x16x32_bf16 v[128:131], v[192:195], a[192:195], v[128:131]
    buffer_load_dword v247, v237, s[16:19], 0 offen
    v_mfma_f32_16x16x32_bf16 v[136:139], v[192:195], a[196:199], v[136:139]
    ds_read_b64_tr_b16 v[178:179], v228 offset:8704
    v_mul_f32 v25, v25, v57
    v_mfma_f32_16x16x32_bf16 v[116:119], v[196:199], a[48:51], v[116:119]
    ds_read_b64_tr_b16 v[180:181], v229 offset:8192
    v_mul_f32 v26, v26, v58
    v_mfma_f32_16x16x32_bf16 v[124:127], v[196:199], a[52:55], v[124:127]
    v_rcp_f32 v27, v27
    v_mfma_f32_16x16x32_bf16 v[132:135], v[196:199], a[192:195], v[132:135]
    ds_read_b64_tr_b16 v[182:183], v229 offset:8704
    v_cvt_pk_bf16_f32 v24, v24, v25
    v_mfma_f32_16x16x32_bf16 v[140:143], v[196:199], a[196:199], v[140:143]
    s_waitcnt lgkmcnt(4)
    v_mul_f32 v27, v27, v59
    v_cvt_pk_bf16_f32 v25, v26, v27
    v_mfma_f32_16x16x32_bf16 v[80:83], v[208:211], a[56:59], v[80:83]
    s_waitcnt vmcnt(19)
    v_mul_f32 v28, s43, v28
    v_mul_f32 v29, s43, v29
    v_mfma_f32_16x16x32_bf16 v[88:91], v[208:211], a[60:63], v[88:91]
    s_barrier
    v_exp_f32 v28, v28
    v_mfma_f32_16x16x32_bf16 v[96:99], v[208:211], a[200:203], v[96:99]
    ds_read_b64_tr_b16 v[192:193], v226 offset:12288
    v_mul_f32 v30, s43, v30
    v_mfma_f32_16x16x32_bf16 v[104:107], v[208:211], a[204:207], v[104:107]
    v_exp_f32 v29, v29
    v_mfma_f32_16x16x32_bf16 v[84:87], v[212:215], a[56:59], v[84:87]
    ds_read_b64_tr_b16 v[194:195], v226 offset:12800
    v_mul_f32 v31, s43, v31
    v_mfma_f32_16x16x32_bf16 v[92:95], v[212:215], a[60:63], v[92:95]
    ds_read_b64_tr_b16 v[196:197], v227 offset:12288
    v_add_f32 v28, 1.0, v28
    v_mfma_f32_16x16x32_bf16 v[100:103], v[212:215], a[200:203], v[100:103]
    ds_read_b64_tr_b16 v[198:199], v227 offset:12800
    v_add_f32 v29, 1.0, v29
    v_mfma_f32_16x16x32_bf16 v[108:111], v[212:215], a[204:207], v[108:111]
    s_waitcnt lgkmcnt(4)
    v_exp_f32 v30, v30
    v_mfma_f32_16x16x32_bf16 v[112:115], v[176:179], a[56:59], v[112:115]
    ds_read_b64_tr_b16 v[208:209], v226 offset:8192
    v_add_f32 v30, 1.0, v30
    v_mfma_f32_16x16x32_bf16 v[120:123], v[176:179], a[60:63], v[120:123]
    v_exp_f32 v31, v31
    v_mfma_f32_16x16x32_bf16 v[128:131], v[176:179], a[200:203], v[128:131]
    ds_read_b64_tr_b16 v[210:211], v226 offset:8704
    v_add_f32 v31, 1.0, v31
    v_mfma_f32_16x16x32_bf16 v[136:139], v[176:179], a[204:207], v[136:139]
    v_rcp_f32 v28, v28
    v_mfma_f32_16x16x32_bf16 v[116:119], v[180:183], a[56:59], v[116:119]
    ds_read_b64_tr_b16 v[212:213], v227 offset:8192
    v_mul_f32 v28, v28, v60
    v_mfma_f32_16x16x32_bf16 v[124:127], v[180:183], a[60:63], v[124:127]
    v_rcp_f32 v29, v29
    v_mfma_f32_16x16x32_bf16 v[132:135], v[180:183], a[200:203], v[132:135]
    ds_read_b64_tr_b16 v[214:215], v227 offset:8704
    v_mul_f32 v29, v29, v61
    v_mfma_f32_16x16x32_bf16 v[140:143], v[180:183], a[204:207], v[140:143]
    s_waitcnt lgkmcnt(4)
    v_rcp_f32 v30, v30
    v_mfma_f32_16x16x32_bf16 v[80:83], v[192:195], a[64:67], v[80:83]
    ds_read_b64_tr_b16 v[176:177], v226 offset:4096
    v_mul_f32 v30, v30, v62
    v_mfma_f32_16x16x32_bf16 v[88:91], v[192:195], a[68:71], v[88:91]
    v_rcp_f32 v31, v31
    v_mfma_f32_16x16x32_bf16 v[96:99], v[192:195], a[208:211], v[96:99]
    ds_read_b64_tr_b16 v[178:179], v226 offset:4608
    v_cvt_pk_bf16_f32 v26, v28, v29
    v_mfma_f32_16x16x32_bf16 v[104:107], v[192:195], a[212:215], v[104:107]
    v_mul_f32 v31, v31, v63
    v_cvt_pk_bf16_f32 v27, v30, v31
    v_mfma_f32_16x16x32_bf16 v[84:87], v[196:199], a[64:67], v[84:87]
    ds_read_b64_tr_b16 v[180:181], v227 offset:4096
    v_mul_f32 v32, s43, v32
    v_mfma_f32_16x16x32_bf16 v[92:95], v[196:199], a[68:71], v[92:95]
    v_exp_f32 v32, v32
    v_mfma_f32_16x16x32_bf16 v[100:103], v[196:199], a[208:211], v[100:103]
    ds_read_b64_tr_b16 v[182:183], v227 offset:4608
    v_mul_f32 v33, s43, v33
    v_mfma_f32_16x16x32_bf16 v[108:111], v[196:199], a[212:215], v[108:111]
    s_waitcnt lgkmcnt(4)
    v_exp_f32 v33, v33
    v_mfma_f32_16x16x32_bf16 v[112:115], v[208:211], a[64:67], v[112:115]
    ds_read_b64_tr_b16 v[192:193], v226 offset:0
    v_mul_f32 v34, s43, v34
    v_mfma_f32_16x16x32_bf16 v[120:123], v[208:211], a[68:71], v[120:123]
    v_exp_f32 v34, v34
    v_mfma_f32_16x16x32_bf16 v[128:131], v[208:211], a[208:211], v[128:131]
    ds_read_b64_tr_b16 v[194:195], v226 offset:512
    v_mul_f32 v35, s43, v35
    v_mfma_f32_16x16x32_bf16 v[136:139], v[208:211], a[212:215], v[136:139]
    ds_read_b64_tr_b16 v[196:197], v227 offset:0
    v_add_f32 v32, 1.0, v32
    v_mfma_f32_16x16x32_bf16 v[116:119], v[212:215], a[64:67], v[116:119]
    ds_read_b64_tr_b16 v[198:199], v227 offset:512
    v_add_f32 v33, 1.0, v33
    v_mfma_f32_16x16x32_bf16 v[124:127], v[212:215], a[68:71], v[124:127]
    v_exp_f32 v35, v35
    v_mfma_f32_16x16x32_bf16 v[132:135], v[212:215], a[208:211], v[132:135]
    ds_write_b128 v239, v[24:27] offset:50176
    v_add_f32 v34, 1.0, v34
    v_mfma_f32_16x16x32_bf16 v[140:143], v[212:215], a[212:215], v[140:143]
    s_waitcnt lgkmcnt(5)
    v_rcp_f32 v32, v32
    v_mfma_f32_16x16x32_bf16 v[80:83], v[176:179], a[72:75], v[80:83]
    ds_read_b64_tr_b16 v[208:209], v224 offset:61440
    v_add_f32 v35, 1.0, v35
    v_mfma_f32_16x16x32_bf16 v[88:91], v[176:179], a[76:79], v[88:91]
    v_rcp_f32 v33, v33
    v_mfma_f32_16x16x32_bf16 v[96:99], v[176:179], a[216:219], v[96:99]
    ds_read_b64_tr_b16 v[210:211], v224 offset:61952
    v_mul_f32 v32, v32, v64
    v_mfma_f32_16x16x32_bf16 v[104:107], v[176:179], a[220:223], v[104:107]
    v_rcp_f32 v34, v34
    v_mfma_f32_16x16x32_bf16 v[84:87], v[180:183], a[72:75], v[84:87]
    ds_read_b64_tr_b16 v[212:213], v225 offset:61440
    v_mul_f32 v33, v33, v65
    v_mfma_f32_16x16x32_bf16 v[92:95], v[180:183], a[76:79], v[92:95]
    v_rcp_f32 v35, v35
    v_mfma_f32_16x16x32_bf16 v[100:103], v[180:183], a[216:219], v[100:103]
    ds_read_b64_tr_b16 v[214:215], v225 offset:61952
    v_mul_f32 v34, v34, v66
    v_mfma_f32_16x16x32_bf16 v[108:111], v[180:183], a[220:223], v[108:111]
    s_waitcnt lgkmcnt(5)
    v_cvt_pk_bf16_f32 v32, v32, v33
    v_mul_f32 v35, v35, v67
    v_mfma_f32_16x16x32_bf16 v[112:115], v[192:195], a[72:75], v[112:115]
    ds_read_b64_tr_b16 v[176:177], v224 offset:57344
    v_cvt_pk_bf16_f32 v33, v34, v35
    v_mfma_f32_16x16x32_bf16 v[120:123], v[192:195], a[76:79], v[120:123]
    v_mul_f32 v36, s43, v36
    v_mul_f32 v37, s43, v37
    v_mfma_f32_16x16x32_bf16 v[128:131], v[192:195], a[216:219], v[128:131]
    ds_read_b64_tr_b16 v[178:179], v224 offset:57856
    v_mul_f32 v38, s43, v38
    v_mfma_f32_16x16x32_bf16 v[136:139], v[192:195], a[220:223], v[136:139]
    v_exp_f32 v36, v36
    v_mfma_f32_16x16x32_bf16 v[116:119], v[196:199], a[72:75], v[116:119]
    ds_read_b64_tr_b16 v[180:181], v225 offset:57344
    v_mul_f32 v39, s43, v39
    v_mfma_f32_16x16x32_bf16 v[124:127], v[196:199], a[76:79], v[124:127]
    v_exp_f32 v37, v37
    v_mfma_f32_16x16x32_bf16 v[132:135], v[196:199], a[216:219], v[132:135]
    ds_read_b64_tr_b16 v[182:183], v225 offset:57856
    v_add_f32 v36, 1.0, v36
    v_mfma_f32_16x16x32_bf16 v[140:143], v[196:199], a[220:223], v[140:143]
    s_waitcnt lgkmcnt(4)
    v_exp_f32 v38, v38
    v_mfma_f32_16x16x32_bf16 v[80:83], v[208:211], a[80:83], v[80:83]
    ds_read_b64_tr_b16 v[192:193], v224 offset:53248
    v_add_f32 v37, 1.0, v37
    v_mfma_f32_16x16x32_bf16 v[88:91], v[208:211], a[84:87], v[88:91]
    v_exp_f32 v39, v39
    v_mfma_f32_16x16x32_bf16 v[96:99], v[208:211], a[224:227], v[96:99]
    ds_read_b64_tr_b16 v[194:195], v224 offset:53760
    v_add_f32 v38, 1.0, v38
    v_mfma_f32_16x16x32_bf16 v[104:107], v[208:211], a[228:231], v[104:107]
    v_rcp_f32 v36, v36
    v_mfma_f32_16x16x32_bf16 v[84:87], v[212:215], a[80:83], v[84:87]
    ds_read_b64_tr_b16 v[196:197], v225 offset:53248
    v_add_f32 v39, 1.0, v39
    v_mfma_f32_16x16x32_bf16 v[92:95], v[212:215], a[84:87], v[92:95]
    v_rcp_f32 v37, v37
    v_mfma_f32_16x16x32_bf16 v[100:103], v[212:215], a[224:227], v[100:103]
    ds_read_b64_tr_b16 v[198:199], v225 offset:53760
    v_mul_f32 v36, v36, v68
    v_mfma_f32_16x16x32_bf16 v[108:111], v[212:215], a[228:231], v[108:111]
    s_waitcnt lgkmcnt(4)
    v_rcp_f32 v38, v38
    v_mfma_f32_16x16x32_bf16 v[112:115], v[176:179], a[80:83], v[112:115]
    ds_read_b64_tr_b16 v[208:209], v224 offset:49152
    v_mul_f32 v37, v37, v69
    v_mfma_f32_16x16x32_bf16 v[120:123], v[176:179], a[84:87], v[120:123]
    v_rcp_f32 v39, v39
    v_mfma_f32_16x16x32_bf16 v[128:131], v[176:179], a[224:227], v[128:131]
    ds_read_b64_tr_b16 v[210:211], v224 offset:49664
    v_mul_f32 v38, v38, v70
    v_mfma_f32_16x16x32_bf16 v[136:139], v[176:179], a[228:231], v[136:139]
    v_cvt_pk_bf16_f32 v34, v36, v37
    v_mul_f32 v39, v39, v71
    v_mfma_f32_16x16x32_bf16 v[116:119], v[180:183], a[80:83], v[116:119]
    ds_read_b64_tr_b16 v[212:213], v225 offset:49152
    v_cvt_pk_bf16_f32 v35, v38, v39
    v_mfma_f32_16x16x32_bf16 v[124:127], v[180:183], a[84:87], v[124:127]
    v_mul_f32 v40, s43, v40
    v_mul_f32 v41, s43, v41
    v_mfma_f32_16x16x32_bf16 v[132:135], v[180:183], a[224:227], v[132:135]
    ds_read_b64_tr_b16 v[214:215], v225 offset:49664
    v_mul_f32 v42, s43, v42
    v_mfma_f32_16x16x32_bf16 v[140:143], v[180:183], a[228:231], v[140:143]
    s_waitcnt lgkmcnt(4)
    v_exp_f32 v40, v40
    v_mfma_f32_16x16x32_bf16 v[80:83], v[192:195], a[88:91], v[80:83]
    s_waitcnt vmcnt(11)
    v_exp_f32 v41, v41
    v_mfma_f32_16x16x32_bf16 v[88:91], v[192:195], a[92:95], v[88:91]
    s_barrier
    v_exp_f32 v42, v42
    v_mfma_f32_16x16x32_bf16 v[96:99], v[192:195], a[232:235], v[96:99]
    ds_read_b64_tr_b16 v[176:177], v224 offset:45056
    v_mul_f32 v43, s43, v43
    v_mfma_f32_16x16x32_bf16 v[104:107], v[192:195], a[236:239], v[104:107]
    ds_read_b64_tr_b16 v[178:179], v224 offset:45568
    v_add_f32 v40, 1.0, v40
    v_mfma_f32_16x16x32_bf16 v[84:87], v[196:199], a[88:91], v[84:87]
    ds_read_b64_tr_b16 v[180:181], v225 offset:45056
    v_add_f32 v41, 1.0, v41
    v_mfma_f32_16x16x32_bf16 v[92:95], v[196:199], a[92:95], v[92:95]
    ds_read_b64_tr_b16 v[182:183], v225 offset:45568
    v_add_f32 v42, 1.0, v42
    v_mfma_f32_16x16x32_bf16 v[100:103], v[196:199], a[232:235], v[100:103]
    ds_write_b128 v240, v[32:35] offset:49152
    v_mfma_f32_16x16x32_bf16 v[108:111], v[196:199], a[236:239], v[108:111]
    s_waitcnt lgkmcnt(5)
    v_exp_f32 v43, v43
    v_mfma_f32_16x16x32_bf16 v[112:115], v[208:211], a[88:91], v[112:115]
    ds_read_b64_tr_b16 v[192:193], v224 offset:40960
    v_add_f32 v43, 1.0, v43
    v_mfma_f32_16x16x32_bf16 v[120:123], v[208:211], a[92:95], v[120:123]
    v_rcp_f32 v40, v40
    v_mfma_f32_16x16x32_bf16 v[128:131], v[208:211], a[232:235], v[128:131]
    ds_read_b64_tr_b16 v[194:195], v224 offset:41472
    v_mul_f32 v40, v40, v72
    v_mfma_f32_16x16x32_bf16 v[136:139], v[208:211], a[236:239], v[136:139]
    v_rcp_f32 v41, v41
    v_mfma_f32_16x16x32_bf16 v[116:119], v[212:215], a[88:91], v[116:119]
    ds_read_b64_tr_b16 v[196:197], v225 offset:40960
    v_mul_f32 v41, v41, v73
    v_mfma_f32_16x16x32_bf16 v[124:127], v[212:215], a[92:95], v[124:127]
    v_rcp_f32 v42, v42
    v_mfma_f32_16x16x32_bf16 v[132:135], v[212:215], a[232:235], v[132:135]
    ds_read_b64_tr_b16 v[198:199], v225 offset:41472
    v_mul_f32 v42, v42, v74
    v_mfma_f32_16x16x32_bf16 v[140:143], v[212:215], a[236:239], v[140:143]
    s_waitcnt lgkmcnt(5)
    v_rcp_f32 v43, v43
    v_mfma_f32_16x16x32_bf16 v[80:83], v[176:179], a[96:99], v[80:83]
    ds_read_b64_tr_b16 v[208:209], v224 offset:36864
    v_cvt_pk_bf16_f32 v40, v40, v41
    v_mfma_f32_16x16x32_bf16 v[88:91], v[176:179], a[100:103], v[88:91]
    v_mul_f32 v43, v43, v75
    v_cvt_pk_bf16_f32 v41, v42, v43
    v_mfma_f32_16x16x32_bf16 v[96:99], v[176:179], a[240:243], v[96:99]
    ds_read_b64_tr_b16 v[210:211], v224 offset:37376
    v_mul_f32 v44, s43, v44
    v_mfma_f32_16x16x32_bf16 v[104:107], v[176:179], a[244:247], v[104:107]
    v_exp_f32 v44, v44
    v_mfma_f32_16x16x32_bf16 v[84:87], v[180:183], a[96:99], v[84:87]
    ds_read_b64_tr_b16 v[212:213], v225 offset:36864
    v_mul_f32 v45, s43, v45
    v_mfma_f32_16x16x32_bf16 v[92:95], v[180:183], a[100:103], v[92:95]
    v_exp_f32 v45, v45
    v_mfma_f32_16x16x32_bf16 v[100:103], v[180:183], a[240:243], v[100:103]
    ds_read_b64_tr_b16 v[214:215], v225 offset:37376
    v_mul_f32 v46, s43, v46
    v_mfma_f32_16x16x32_bf16 v[108:111], v[180:183], a[244:247], v[108:111]
    s_waitcnt lgkmcnt(4)
    v_exp_f32 v46, v46
    v_mfma_f32_16x16x32_bf16 v[112:115], v[192:195], a[96:99], v[112:115]
    ds_read_b64_tr_b16 v[176:177], v224 offset:32768
    v_mul_f32 v47, s43, v47
    v_mfma_f32_16x16x32_bf16 v[120:123], v[192:195], a[100:103], v[120:123]
    v_exp_f32 v47, v47
    v_mfma_f32_16x16x32_bf16 v[128:131], v[192:195], a[240:243], v[128:131]
    ds_read_b64_tr_b16 v[178:179], v224 offset:33280
    v_add_f32 v44, 1.0, v44
    v_mfma_f32_16x16x32_bf16 v[136:139], v[192:195], a[244:247], v[136:139]
    v_rcp_f32 v44, v44
    v_mfma_f32_16x16x32_bf16 v[116:119], v[196:199], a[96:99], v[116:119]
    ds_read_b64_tr_b16 v[180:181], v225 offset:32768
    v_add_f32 v45, 1.0, v45
    v_mfma_f32_16x16x32_bf16 v[124:127], v[196:199], a[100:103], v[124:127]
    v_rcp_f32 v45, v45
    v_mfma_f32_16x16x32_bf16 v[132:135], v[196:199], a[240:243], v[132:135]
    ds_read_b64_tr_b16 v[182:183], v225 offset:33280
    v_add_f32 v46, 1.0, v46
    v_mfma_f32_16x16x32_bf16 v[140:143], v[196:199], a[244:247], v[140:143]
    s_waitcnt lgkmcnt(4)
    v_rcp_f32 v46, v46
    v_mfma_f32_16x16x32_bf16 v[80:83], v[208:211], a[104:107], v[80:83]
    ds_read_b64_tr_b16 v[192:193], v226 offset:61440
    v_add_f32 v47, 1.0, v47
    v_mfma_f32_16x16x32_bf16 v[88:91], v[208:211], a[108:111], v[88:91]
    v_rcp_f32 v47, v47
    v_mfma_f32_16x16x32_bf16 v[96:99], v[208:211], a[248:251], v[96:99]
    ds_read_b64_tr_b16 v[194:195], v226 offset:61952
    v_mul_f32 v44, v44, v76
    v_mfma_f32_16x16x32_bf16 v[104:107], v[208:211], a[252:255], v[104:107]
    v_mul_f32 v45, v45, v77
    v_mul_f32 v46, v46, v78
    v_mfma_f32_16x16x32_bf16 v[84:87], v[212:215], a[104:107], v[84:87]
    ds_read_b64_tr_b16 v[196:197], v227 offset:61440
    v_cvt_pk_bf16_f32 v42, v44, v45
    v_mfma_f32_16x16x32_bf16 v[92:95], v[212:215], a[108:111], v[92:95]
    v_mul_f32 v47, v47, v79
    v_cvt_pk_bf16_f32 v43, v46, v47
    v_mfma_f32_16x16x32_bf16 v[100:103], v[212:215], a[248:251], v[100:103]
    ds_read_b64_tr_b16 v[198:199], v227 offset:61952
    v_mfma_f32_16x16x32_bf16 v[108:111], v[212:215], a[252:255], v[108:111]
    s_waitcnt lgkmcnt(4)
    v_mfma_f32_16x16x32_bf16 v[112:115], v[176:179], a[104:107], v[112:115]
    ds_read_b64_tr_b16 v[208:209], v226 offset:57344
    v_mfma_f32_16x16x32_bf16 v[120:123], v[176:179], a[108:111], v[120:123]
    v_mfma_f32_16x16x32_bf16 v[128:131], v[176:179], a[248:251], v[128:131]
    ds_read_b64_tr_b16 v[210:211], v226 offset:57856
    v_mfma_f32_16x16x32_bf16 v[136:139], v[176:179], a[252:255], v[136:139]
    ds_read_b64_tr_b16 v[212:213], v227 offset:57344
    v_mfma_f32_16x16x32_bf16 v[116:119], v[180:183], a[104:107], v[116:119]
    ds_read_b64_tr_b16 v[214:215], v227 offset:57856
    v_mfma_f32_16x16x32_bf16 v[124:127], v[180:183], a[108:111], v[124:127]
    v_mfma_f32_16x16x32_bf16 v[132:135], v[180:183], a[248:251], v[132:135]
    ds_write_b128 v240, v[40:43] offset:50176
    v_mfma_f32_16x16x32_bf16 v[140:143], v[180:183], a[252:255], v[140:143]
    s_waitcnt lgkmcnt(5)
    v_mfma_f32_16x16x32_bf16 v[80:83], v[192:195], a[112:115], v[80:83]
    ds_read_b64_tr_b16 v[176:177], v226 offset:53248
    v_mfma_f32_16x16x32_bf16 v[88:91], v[192:195], a[116:119], v[88:91]
    v_mfma_f32_16x16x32_bf16 v[96:99], v[192:195], v[144:147], v[96:99]
    ds_read_b64_tr_b16 v[178:179], v226 offset:53760
    v_mfma_f32_16x16x32_bf16 v[104:107], v[192:195], v[148:151], v[104:107]
    v_mfma_f32_16x16x32_bf16 v[84:87], v[196:199], a[112:115], v[84:87]
    ds_read_b64_tr_b16 v[180:181], v227 offset:53248
    v_mfma_f32_16x16x32_bf16 v[92:95], v[196:199], a[116:119], v[92:95]
    v_mfma_f32_16x16x32_bf16 v[100:103], v[196:199], v[144:147], v[100:103]
    ds_read_b64_tr_b16 v[182:183], v227 offset:53760
    v_mfma_f32_16x16x32_bf16 v[108:111], v[196:199], v[148:151], v[108:111]
    s_waitcnt lgkmcnt(5)
    v_mfma_f32_16x16x32_bf16 v[112:115], v[208:211], a[112:115], v[112:115]
    ds_read_b64_tr_b16 v[192:193], v226 offset:49152
    v_mfma_f32_16x16x32_bf16 v[120:123], v[208:211], a[116:119], v[120:123]
    v_mfma_f32_16x16x32_bf16 v[128:131], v[208:211], v[144:147], v[128:131]
    ds_read_b64_tr_b16 v[194:195], v226 offset:49664
    v_mfma_f32_16x16x32_bf16 v[136:139], v[208:211], v[148:151], v[136:139]
    v_mfma_f32_16x16x32_bf16 v[116:119], v[212:215], a[112:115], v[116:119]
    ds_read_b64_tr_b16 v[196:197], v227 offset:49152
    v_mfma_f32_16x16x32_bf16 v[124:127], v[212:215], a[116:119], v[124:127]
    v_mfma_f32_16x16x32_bf16 v[132:135], v[212:215], v[144:147], v[132:135]
    ds_read_b64_tr_b16 v[198:199], v227 offset:49664
    v_mfma_f32_16x16x32_bf16 v[140:143], v[212:215], v[148:151], v[140:143]
    s_waitcnt lgkmcnt(4)
    v_mfma_f32_16x16x32_bf16 v[80:83], v[176:179], a[120:123], v[80:83]
    s_waitcnt vmcnt(3)
    s_barrier
    v_mfma_f32_16x16x32_bf16 v[88:91], v[176:179], a[124:127], v[88:91]
    ds_read_b64_tr_b16 v[208:209], v226 offset:45056
    s_add_u32 m0, s40, 126976
    v_mfma_f32_16x16x32_bf16 v[96:99], v[176:179], v[152:155], v[96:99]
    s_add_u32 s45, s36, 590080
    ds_read_b64_tr_b16 v[210:211], v226 offset:45568
    v_mfma_f32_16x16x32_bf16 v[104:107], v[176:179], v[156:159], v[104:107]
    buffer_load_dwordx4 v233, s[16:19], s45 offen  lds
    v_mfma_f32_16x16x32_bf16 v[84:87], v[180:183], a[120:123], v[84:87]
    ds_read_b64_tr_b16 v[212:213], v227 offset:45056
    s_add_u32 m0, s40, 122880
    v_mfma_f32_16x16x32_bf16 v[92:95], v[180:183], a[124:127], v[92:95]
    s_add_u32 s45, s36, 884992
    ds_read_b64_tr_b16 v[214:215], v227 offset:45568
    v_mfma_f32_16x16x32_bf16 v[100:103], v[180:183], v[152:155], v[100:103]
    buffer_load_dwordx4 v233, s[12:15], s45 offen  lds
    v_mfma_f32_16x16x32_bf16 v[108:111], v[180:183], v[156:159], v[108:111]
    s_waitcnt lgkmcnt(4)
    v_mfma_f32_16x16x32_bf16 v[112:115], v[192:195], a[120:123], v[112:115]
    ds_read_b64_tr_b16 v[176:177], v224 offset:28672
    s_add_u32 m0, s40, 118784
    v_mfma_f32_16x16x32_bf16 v[120:123], v[192:195], a[124:127], v[120:123]
    s_add_u32 s45, s36, 884992
    v_mfma_f32_16x16x32_bf16 v[128:131], v[192:195], v[152:155], v[128:131]
    ds_read_b64_tr_b16 v[178:179], v224 offset:29184
    v_mfma_f32_16x16x32_bf16 v[136:139], v[192:195], v[156:159], v[136:139]
    buffer_load_dwordx4 v233, s[16:19], s45 offen  lds
    v_mfma_f32_16x16x32_bf16 v[116:119], v[196:199], a[120:123], v[116:119]
    ds_read_b64_tr_b16 v[180:181], v225 offset:28672
    s_add_u32 m0, s40, 106496
    v_mfma_f32_16x16x32_bf16 v[124:127], v[196:199], a[124:127], v[124:127]
    s_add_u32 s45, s36, 1179904
    ds_read_b64_tr_b16 v[182:183], v225 offset:29184
    v_mfma_f32_16x16x32_bf16 v[132:135], v[196:199], v[152:155], v[132:135]
    buffer_load_dwordx4 v233, s[12:15], s45 offen  lds
    v_mfma_f32_16x16x32_bf16 v[140:143], v[196:199], v[156:159], v[140:143]
    s_waitcnt lgkmcnt(4)
    v_mfma_f32_16x16x32_bf16 v[80:83], v[208:211], a[128:131], v[80:83]
    ds_read_b64_tr_b16 v[192:193], v224 offset:24576
    s_add_u32 m0, s40, 102400
    v_mfma_f32_16x16x32_bf16 v[88:91], v[208:211], a[132:135], v[88:91]
    s_add_u32 s45, s36, 1179904
    v_mfma_f32_16x16x32_bf16 v[96:99], v[208:211], v[160:163], v[96:99]
    ds_read_b64_tr_b16 v[194:195], v224 offset:25088
    v_mfma_f32_16x16x32_bf16 v[104:107], v[208:211], v[164:167], v[104:107]
    buffer_load_dwordx4 v233, s[16:19], s45 offen  lds
    v_mfma_f32_16x16x32_bf16 v[84:87], v[212:215], a[128:131], v[84:87]
    ds_read_b64_tr_b16 v[196:197], v225 offset:24576
    s_add_u32 m0, s40, 98304
    v_mfma_f32_16x16x32_bf16 v[92:95], v[212:215], a[132:135], v[92:95]
    s_add_u32 s45, s36, 1474816
    ds_read_b64_tr_b16 v[198:199], v225 offset:25088
    v_mfma_f32_16x16x32_bf16 v[100:103], v[212:215], v[160:163], v[100:103]
    buffer_load_dwordx4 v233, s[12:15], s45 offen  lds
    v_mfma_f32_16x16x32_bf16 v[108:111], v[212:215], v[164:167], v[108:111]
    s_waitcnt lgkmcnt(4)
    v_mfma_f32_16x16x32_bf16 v[112:115], v[176:179], a[128:131], v[112:115]
    ds_read_b64_tr_b16 v[208:209], v224 offset:20480
    s_add_u32 m0, s40, 94208
    v_mfma_f32_16x16x32_bf16 v[120:123], v[176:179], a[132:135], v[120:123]
    s_add_u32 s45, s36, 1474816
    v_mfma_f32_16x16x32_bf16 v[128:131], v[176:179], v[160:163], v[128:131]
    ds_read_b64_tr_b16 v[210:211], v224 offset:20992
    v_mfma_f32_16x16x32_bf16 v[136:139], v[176:179], v[164:167], v[136:139]
    buffer_load_dwordx4 v233, s[16:19], s45 offen  lds
    v_mfma_f32_16x16x32_bf16 v[116:119], v[180:183], a[128:131], v[116:119]
    ds_read_b64_tr_b16 v[212:213], v225 offset:20480
    s_add_u32 m0, s40, 90112
    v_mfma_f32_16x16x32_bf16 v[124:127], v[180:183], a[132:135], v[124:127]
    s_add_u32 s45, s36, 1769728
    ds_read_b64_tr_b16 v[214:215], v225 offset:20992
    v_mfma_f32_16x16x32_bf16 v[132:135], v[180:183], v[160:163], v[132:135]
    buffer_load_dwordx4 v233, s[12:15], s45 offen  lds
    v_mfma_f32_16x16x32_bf16 v[140:143], v[180:183], v[164:167], v[140:143]
    s_waitcnt lgkmcnt(4)
    v_mfma_f32_16x16x32_bf16 v[80:83], v[192:195], a[136:139], v[80:83]
    ds_read_b64_tr_b16 v[176:177], v224 offset:16384
    s_add_u32 m0, s40, 86016
    v_mfma_f32_16x16x32_bf16 v[88:91], v[192:195], a[140:143], v[88:91]
    s_add_u32 s45, s36, 1769728
    v_mfma_f32_16x16x32_bf16 v[96:99], v[192:195], v[168:171], v[96:99]
    ds_read_b64_tr_b16 v[178:179], v224 offset:16896
    v_mfma_f32_16x16x32_bf16 v[104:107], v[192:195], v[172:175], v[104:107]
    buffer_load_dwordx4 v233, s[16:19], s45 offen  lds
    v_mfma_f32_16x16x32_bf16 v[84:87], v[196:199], a[136:139], v[84:87]
    ds_read_b64_tr_b16 v[180:181], v225 offset:16384
    s_add_u32 m0, s40, 81920
    v_mfma_f32_16x16x32_bf16 v[92:95], v[196:199], a[140:143], v[92:95]
    s_add_u32 s45, s36, 2064640
    ds_read_b64_tr_b16 v[182:183], v225 offset:16896
    v_mfma_f32_16x16x32_bf16 v[100:103], v[196:199], v[168:171], v[100:103]
    buffer_load_dwordx4 v233, s[12:15], s45 offen  lds
    v_mfma_f32_16x16x32_bf16 v[108:111], v[196:199], v[172:175], v[108:111]
    s_waitcnt lgkmcnt(4)
    v_mfma_f32_16x16x32_bf16 v[112:115], v[208:211], a[136:139], v[112:115]
    ds_read_b64_tr_b16 v[192:193], v224 offset:12288
    s_add_u32 m0, s40, 77824
    v_mfma_f32_16x16x32_bf16 v[120:123], v[208:211], a[140:143], v[120:123]
    s_add_u32 s45, s36, 2064640
    v_mfma_f32_16x16x32_bf16 v[128:131], v[208:211], v[168:171], v[128:131]
    ds_read_b64_tr_b16 v[194:195], v224 offset:12800
    v_mfma_f32_16x16x32_bf16 v[136:139], v[208:211], v[172:175], v[136:139]
    buffer_load_dwordx4 v233, s[16:19], s45 offen  lds
    v_mfma_f32_16x16x32_bf16 v[116:119], v[212:215], a[136:139], v[116:119]
    ds_read_b64_tr_b16 v[196:197], v225 offset:12288
    s_add_u32 m0, s40, 73728
    v_mfma_f32_16x16x32_bf16 v[124:127], v[212:215], a[140:143], v[124:127]
    s_add_u32 s45, s36, 2359552
    ds_read_b64_tr_b16 v[198:199], v225 offset:12800
    v_mfma_f32_16x16x32_bf16 v[132:135], v[212:215], v[168:171], v[132:135]
    buffer_load_dwordx4 v233, s[12:15], s45 offen  lds
    v_mfma_f32_16x16x32_bf16 v[140:143], v[212:215], v[172:175], v[140:143]
    s_waitcnt lgkmcnt(4)
    v_mfma_f32_16x16x32_bf16 v[16:19], v[176:179], a[0:3], 0
    ds_read_b64_tr_b16 v[208:209], v224 offset:8192
    s_add_u32 m0, s40, 69632
    v_mfma_f32_16x16x32_bf16 v[24:27], v[176:179], a[4:7], 0
    s_add_u32 s45, s36, 2359552
    v_mfma_f32_16x16x32_bf16 v[32:35], v[176:179], a[144:147], 0
    ds_read_b64_tr_b16 v[210:211], v224 offset:8704
    v_mfma_f32_16x16x32_bf16 v[40:43], v[176:179], a[148:151], 0
    buffer_load_dwordx4 v233, s[16:19], s45 offen  lds
    v_mfma_f32_16x16x32_bf16 v[20:23], v[180:183], a[0:3], 0
    ds_read_b64_tr_b16 v[212:213], v225 offset:8192
    s_add_u32 m0, s40, 65536
    v_mfma_f32_16x16x32_bf16 v[28:31], v[180:183], a[4:7], 0
    s_add_u32 s45, s36, 2654464
    ds_read_b64_tr_b16 v[214:215], v225 offset:8704
    v_mfma_f32_16x16x32_bf16 v[36:39], v[180:183], a[144:147], 0
    buffer_load_dwordx4 v233, s[12:15], s45 offen  lds
    v_mfma_f32_16x16x32_bf16 v[44:47], v[180:183], a[148:151], 0
    s_waitcnt lgkmcnt(4)
    v_mfma_f32_16x16x32_bf16 v[48:51], v[192:195], a[0:3], 0
    ds_read_b64_tr_b16 v[176:177], v224 offset:4096
    s_add_u32 m0, s40, 61440
    v_mfma_f32_16x16x32_bf16 v[56:59], v[192:195], a[4:7], 0
    s_add_u32 s45, s36, 2654464
    v_mul_f32 v80, s43, v80
    v_mul_f32 v81, s43, v81
    v_mfma_f32_16x16x32_bf16 v[64:67], v[192:195], a[144:147], 0
    ds_read_b64_tr_b16 v[178:179], v224 offset:4608
    v_mul_f32 v82, s43, v82
    v_mfma_f32_16x16x32_bf16 v[72:75], v[192:195], a[148:151], 0
    buffer_load_dwordx4 v233, s[16:19], s45 offen  lds
    v_mfma_f32_16x16x32_bf16 v[52:55], v[196:199], a[0:3], 0
    ds_read_b64_tr_b16 v[180:181], v225 offset:4096
    s_add_u32 m0, s40, 57344
    v_mfma_f32_16x16x32_bf16 v[60:63], v[196:199], a[4:7], 0
    s_add_u32 s45, s36, 2949376
    ds_read_b64_tr_b16 v[182:183], v225 offset:4608
    v_mfma_f32_16x16x32_bf16 v[68:71], v[196:199], a[144:147], 0
    buffer_load_dwordx4 v233, s[12:15], s45 offen  lds
    v_mfma_f32_16x16x32_bf16 v[76:79], v[196:199], a[148:151], 0
    s_waitcnt lgkmcnt(4)
    v_exp_f32 v80, v80
    v_mfma_f32_16x16x32_bf16 v[16:19], v[208:211], a[8:11], v[16:19]
    s_waitcnt vmcnt(9)
    s_barrier
    v_mul_f32 v83, s43, v83
    v_mfma_f32_16x16x32_bf16 v[24:27], v[208:211], a[12:15], v[24:27]
    ds_read_b64_tr_b16 v[192:193], v224 offset:0
    s_add_u32 m0, s40, 114688
    v_mfma_f32_16x16x32_bf16 v[32:35], v[208:211], a[152:155], v[32:35]
    s_add_u32 s45, s36, 2949376
    ds_read_b64_tr_b16 v[194:195], v224 offset:512
    v_mfma_f32_16x16x32_bf16 v[40:43], v[208:211], a[156:159], v[40:43]
    buffer_load_dwordx4 v233, s[16:19], s45 offen  lds
    v_mfma_f32_16x16x32_bf16 v[20:23], v[212:215], a[8:11], v[20:23]
    ds_read_b64_tr_b16 v[196:197], v225 offset:0
    s_add_u32 m0, s40, 110592
    v_mfma_f32_16x16x32_bf16 v[28:31], v[212:215], a[12:15], v[28:31]
    s_add_u32 s45, s36, 3244288
    ds_read_b64_tr_b16 v[198:199], v225 offset:512
    v_mfma_f32_16x16x32_bf16 v[36:39], v[212:215], a[152:155], v[36:39]
    buffer_load_dwordx4 v233, s[12:15], s45 offen  lds
    v_mfma_f32_16x16x32_bf16 v[44:47], v[212:215], a[156:159], v[44:47]
    s_waitcnt lgkmcnt(4)
    v_exp_f32 v81, v81
    v_mfma_f32_16x16x32_bf16 v[48:51], v[176:179], a[8:11], v[48:51]
    ds_read_b64_tr_b16 v[208:209], v226 offset:61440
    s_add_u32 m0, s40, 53248
    v_mfma_f32_16x16x32_bf16 v[56:59], v[176:179], a[12:15], v[56:59]
    s_add_u32 s45, s36, 3244288
    v_exp_f32 v82, v82
    v_mfma_f32_16x16x32_bf16 v[64:67], v[176:179], a[152:155], v[64:67]
    ds_read_b64_tr_b16 v[210:211], v226 offset:61952
    v_add_f32 v80, 1.0, v80
    v_mfma_f32_16x16x32_bf16 v[72:75], v[176:179], a[156:159], v[72:75]
    buffer_load_dwordx4 v233, s[16:19], s45 offen  lds
    v_mfma_f32_16x16x32_bf16 v[52:55], v[180:183], a[8:11], v[52:55]
    ds_read_b64_tr_b16 v[212:213], v227 offset:61440
    s_add_u32 m0, s40, 49152
    v_mfma_f32_16x16x32_bf16 v[60:63], v[180:183], a[12:15], v[60:63]
    s_add_u32 s45, s36, 3539200
    ds_read_b64_tr_b16 v[214:215], v227 offset:61952
    v_mfma_f32_16x16x32_bf16 v[68:71], v[180:183], a[152:155], v[68:71]
    buffer_load_dwordx4 v233, s[12:15], s45 offen  lds
    v_mfma_f32_16x16x32_bf16 v[76:79], v[180:183], a[156:159], v[76:79]
    s_waitcnt lgkmcnt(4)
    v_exp_f32 v83, v83
    v_mfma_f32_16x16x32_bf16 v[16:19], v[192:195], a[16:19], v[16:19]
    ds_read_b64_tr_b16 v[176:177], v226 offset:57344
    s_add_u32 m0, s40, 45056
    v_mfma_f32_16x16x32_bf16 v[24:27], v[192:195], a[20:23], v[24:27]
    s_add_u32 s45, s36, 3539200
    v_rcp_f32 v80, v80
    v_mfma_f32_16x16x32_bf16 v[32:35], v[192:195], a[160:163], v[32:35]
    ds_read_b64_tr_b16 v[178:179], v226 offset:57856
    v_add_f32 v81, 1.0, v81
    v_mfma_f32_16x16x32_bf16 v[40:43], v[192:195], a[164:167], v[40:43]
    buffer_load_dwordx4 v233, s[16:19], s45 offen  lds
    v_mfma_f32_16x16x32_bf16 v[20:23], v[196:199], a[16:19], v[20:23]
    ds_read_b64_tr_b16 v[180:181], v227 offset:57344
    s_add_u32 m0, s40, 40960
    v_mfma_f32_16x16x32_bf16 v[28:31], v[196:199], a[20:23], v[28:31]
    s_add_u32 s45, s36, 3834112
    ds_read_b64_tr_b16 v[182:183], v227 offset:57856
    v_mfma_f32_16x16x32_bf16 v[36:39], v[196:199], a[160:163], v[36:39]
    buffer_load_dwordx4 v233, s[12:15], s45 offen  lds
    v_mfma_f32_16x16x32_bf16 v[44:47], v[196:199], a[164:167], v[44:47]
    s_waitcnt lgkmcnt(4)
    v_rcp_f32 v81, v81
    v_mfma_f32_16x16x32_bf16 v[48:51], v[208:211], a[16:19], v[48:51]
    ds_read_b64_tr_b16 v[192:193], v226 offset:53248
    s_add_u32 m0, s40, 36864
    v_mfma_f32_16x16x32_bf16 v[56:59], v[208:211], a[20:23], v[56:59]
    s_add_u32 s45, s36, 3834112
    v_add_f32 v82, 1.0, v82
    v_add_f32 v83, 1.0, v83
    v_mfma_f32_16x16x32_bf16 v[64:67], v[208:211], a[160:163], v[64:67]
    ds_read_b64_tr_b16 v[194:195], v226 offset:53760
    v_mul_f32 v80, v80, v112
    v_mfma_f32_16x16x32_bf16 v[72:75], v[208:211], a[164:167], v[72:75]
    buffer_load_dwordx4 v233, s[16:19], s45 offen  lds
    v_mfma_f32_16x16x32_bf16 v[52:55], v[212:215], a[16:19], v[52:55]
    ds_read_b64_tr_b16 v[196:197], v227 offset:53248
    s_add_u32 m0, s40, 32768
    v_mfma_f32_16x16x32_bf16 v[60:63], v[212:215], a[20:23], v[60:63]
    s_add_u32 s45, s36, 4129024
    ds_read_b64_tr_b16 v[198:199], v227 offset:53760
    v_mfma_f32_16x16x32_bf16 v[68:71], v[212:215], a[160:163], v[68:71]
    buffer_load_dwordx4 v233, s[12:15], s45 offen  lds
    v_mfma_f32_16x16x32_bf16 v[76:79], v[212:215], a[164:167], v[76:79]
    s_waitcnt lgkmcnt(4)
    v_rcp_f32 v82, v82
    v_mfma_f32_16x16x32_bf16 v[16:19], v[176:179], a[24:27], v[16:19]
    ds_read_b64_tr_b16 v[208:209], v226 offset:40960
    s_add_u32 m0, s40, 28672
    v_mul_f32 v81, v81, v113
    v_mfma_f32_16x16x32_bf16 v[24:27], v[176:179], a[28:31], v[24:27]
    s_add_u32 s45, s36, 4129024
    v_rcp_f32 v83, v83
    v_mfma_f32_16x16x32_bf16 v[32:35], v[176:179], a[168:171], v[32:35]
    ds_read_b64_tr_b16 v[210:211], v226 offset:41472
    v_mul_f32 v82, v82, v114
    v_mfma_f32_16x16x32_bf16 v[40:43], v[176:179], a[172:175], v[40:43]
    buffer_load_dwordx4 v233, s[16:19], s45 offen  lds
    v_mfma_f32_16x16x32_bf16 v[20:23], v[180:183], a[24:27], v[20:23]
    ds_read_b64_tr_b16 v[212:213], v227 offset:40960
    s_add_u32 m0, s40, 24576
    v_cvt_pk_bf16_f32 v80, v80, v81
    v_mfma_f32_16x16x32_bf16 v[28:31], v[180:183], a[28:31], v[28:31]
    s_add_u32 s45, s36, 4423936
    ds_read_b64_tr_b16 v[214:215], v227 offset:41472
    v_mul_f32 v83, v83, v115
    v_mfma_f32_16x16x32_bf16 v[36:39], v[180:183], a[168:171], v[36:39]
    buffer_load_dwordx4 v233, s[12:15], s45 offen  lds
    v_cvt_pk_bf16_f32 v81, v82, v83
    v_mfma_f32_16x16x32_bf16 v[44:47], v[180:183], a[172:175], v[44:47]
    s_waitcnt lgkmcnt(4)
    v_mul_f32 v84, s43, v84
    v_mul_f32 v85, s43, v85
    v_mfma_f32_16x16x32_bf16 v[48:51], v[192:195], a[24:27], v[48:51]
    ds_read_b64_tr_b16 v[176:177], v226 offset:36864
    s_add_u32 m0, s40, 20480
    v_mfma_f32_16x16x32_bf16 v[56:59], v[192:195], a[28:31], v[56:59]
    s_add_u32 s45, s36, 4423936
    v_exp_f32 v84, v84
    v_mfma_f32_16x16x32_bf16 v[64:67], v[192:195], a[168:171], v[64:67]
    ds_read_b64_tr_b16 v[178:179], v226 offset:37376
    v_mul_f32 v86, s43, v86
    v_mfma_f32_16x16x32_bf16 v[72:75], v[192:195], a[172:175], v[72:75]
    buffer_load_dwordx4 v233, s[16:19], s45 offen  lds
    v_mfma_f32_16x16x32_bf16 v[52:55], v[196:199], a[24:27], v[52:55]
    ds_read_b64_tr_b16 v[180:181], v227 offset:36864
    s_add_u32 m0, s40, 16384
    v_mfma_f32_16x16x32_bf16 v[60:63], v[196:199], a[28:31], v[60:63]
    s_add_u32 s45, s36, 4718848
    ds_read_b64_tr_b16 v[182:183], v227 offset:37376
    v_mfma_f32_16x16x32_bf16 v[68:71], v[196:199], a[168:171], v[68:71]
    buffer_load_dwordx4 v233, s[12:15], s45 offen  lds
    v_mfma_f32_16x16x32_bf16 v[76:79], v[196:199], a[172:175], v[76:79]
    s_waitcnt lgkmcnt(4)
    v_exp_f32 v85, v85
    v_mfma_f32_16x16x32_bf16 v[16:19], v[208:211], a[32:35], v[16:19]
    ds_read_b64_tr_b16 v[192:193], v226 offset:32768
    s_add_u32 m0, s40, 12288
    v_mul_f32 v87, s43, v87
    v_mfma_f32_16x16x32_bf16 v[24:27], v[208:211], a[36:39], v[24:27]
    s_add_u32 s45, s36, 4718848
    v_exp_f32 v86, v86
    v_mfma_f32_16x16x32_bf16 v[32:35], v[208:211], a[176:179], v[32:35]
    ds_read_b64_tr_b16 v[194:195], v226 offset:33280
    v_add_f32 v84, 1.0, v84
    v_mfma_f32_16x16x32_bf16 v[40:43], v[208:211], a[180:183], v[40:43]
    buffer_load_dwordx4 v233, s[16:19], s45 offen  lds
    v_mfma_f32_16x16x32_bf16 v[20:23], v[212:215], a[32:35], v[20:23]
    ds_read_b64_tr_b16 v[196:197], v227 offset:32768
    s_add_u32 m0, s40, 8192
    v_add_f32 v85, 1.0, v85
    v_mfma_f32_16x16x32_bf16 v[28:31], v[212:215], a[36:39], v[28:31]
    s_add_u32 s45, s36, 5013760
    ds_read_b64_tr_b16 v[198:199], v227 offset:33280
    v_exp_f32 v87, v87
    v_mfma_f32_16x16x32_bf16 v[36:39], v[212:215], a[176:179], v[36:39]
    buffer_load_dwordx4 v233, s[12:15], s45 offen  lds
    v_mfma_f32_16x16x32_bf16 v[44:47], v[212:215], a[180:183], v[44:47]
    s_waitcnt lgkmcnt(4)
    v_rcp_f32 v84, v84
    v_mfma_f32_16x16x32_bf16 v[48:51], v[176:179], a[32:35], v[48:51]
    ds_read_b64_tr_b16 v[208:209], v226 offset:28672
    v_add_f32 v86, 1.0, v86
    v_mfma_f32_16x16x32_bf16 v[56:59], v[176:179], a[36:39], v[56:59]
    v_rcp_f32 v85, v85
    v_mfma_f32_16x16x32_bf16 v[64:67], v[176:179], a[176:179], v[64:67]
    ds_read_b64_tr_b16 v[210:211], v226 offset:29184
    v_add_f32 v87, 1.0, v87
    v_mfma_f32_16x16x32_bf16 v[72:75], v[176:179], a[180:183], v[72:75]
    v_rcp_f32 v86, v86
    v_mfma_f32_16x16x32_bf16 v[52:55], v[180:183], a[32:35], v[52:55]
    ds_read_b64_tr_b16 v[212:213], v227 offset:28672
    v_mul_f32 v84, v84, v116
    v_mfma_f32_16x16x32_bf16 v[60:63], v[180:183], a[36:39], v[60:63]
    v_rcp_f32 v87, v87
    v_mfma_f32_16x16x32_bf16 v[68:71], v[180:183], a[176:179], v[68:71]
    ds_read_b64_tr_b16 v[214:215], v227 offset:29184
    v_mul_f32 v85, v85, v117
    v_mfma_f32_16x16x32_bf16 v[76:79], v[180:183], a[180:183], v[76:79]
    s_waitcnt lgkmcnt(4)
    v_mul_f32 v86, v86, v118
    v_cvt_pk_bf16_f32 v82, v84, v85
    v_mfma_f32_16x16x32_bf16 v[16:19], v[192:195], a[40:43], v[16:19]
    s_waitcnt vmcnt(15)
    s_barrier
    v_mul_f32 v87, v87, v119
    v_mfma_f32_16x16x32_bf16 v[24:27], v[192:195], a[44:47], v[24:27]
    ds_read_b64_tr_b16 v[176:177], v226 offset:24576
    s_add_u32 m0, s40, 106496
    v_mfma_f32_16x16x32_bf16 v[32:35], v[192:195], a[184:187], v[32:35]
    s_add_u32 s45, s36, 5013760
    ds_read_b64_tr_b16 v[178:179], v226 offset:25088
    v_mfma_f32_16x16x32_bf16 v[40:43], v[192:195], a[188:191], v[40:43]
    buffer_load_dwordx4 v233, s[16:19], s45 offen  lds
    v_mfma_f32_16x16x32_bf16 v[20:23], v[196:199], a[40:43], v[20:23]
    ds_read_b64_tr_b16 v[180:181], v227 offset:24576
    s_add_u32 m0, s40, 102400
    v_mfma_f32_16x16x32_bf16 v[28:31], v[196:199], a[44:47], v[28:31]
    s_add_u32 s45, s36, 384
    ds_read_b64_tr_b16 v[182:183], v227 offset:25088
    v_mfma_f32_16x16x32_bf16 v[36:39], v[196:199], a[184:187], v[36:39]
    buffer_load_dwordx4 v233, s[12:15], s45 offen  lds
    v_mfma_f32_16x16x32_bf16 v[44:47], v[196:199], a[188:191], v[44:47]
    s_waitcnt lgkmcnt(4)
    v_cvt_pk_bf16_f32 v83, v86, v87
    v_mul_f32 v88, s43, v88
    v_mfma_f32_16x16x32_bf16 v[48:51], v[208:211], a[40:43], v[48:51]
    ds_read_b64_tr_b16 v[192:193], v226 offset:20480
    s_add_u32 m0, s40, 98304
    v_mul_f32 v89, s43, v89
    v_mfma_f32_16x16x32_bf16 v[56:59], v[208:211], a[44:47], v[56:59]
    s_add_u32 s45, s36, 384
    ds_read_b64_tr_b16 v[194:195], v226 offset:20992
    v_mul_f32 v90, s43, v90
    v_mfma_f32_16x16x32_bf16 v[64:67], v[208:211], a[184:187], v[64:67]
    buffer_load_dwordx4 v233, s[16:19], s45 offen  lds
    v_mul_f32 v91, s43, v91
    v_mfma_f32_16x16x32_bf16 v[72:75], v[208:211], a[188:191], v[72:75]
    ds_read_b64_tr_b16 v[196:197], v227 offset:20480
    v_mfma_f32_16x16x32_bf16 v[52:55], v[212:215], a[40:43], v[52:55]
    s_add_u32 m0, s40, 4096
    ds_read_b64_tr_b16 v[198:199], v227 offset:20992
    v_exp_f32 v88, v88
    v_mfma_f32_16x16x32_bf16 v[60:63], v[212:215], a[44:47], v[60:63]
    s_add_u32 s45, s36, 295296
    ds_write_b128 v239, v[80:83] offset:32768
    v_exp_f32 v89, v89
    v_mfma_f32_16x16x32_bf16 v[68:71], v[212:215], a[184:187], v[68:71]
    buffer_load_dwordx4 v233, s[12:15], s45 offen  lds
    v_mfma_f32_16x16x32_bf16 v[76:79], v[212:215], a[188:191], v[76:79]
    s_waitcnt lgkmcnt(5)
    v_exp_f32 v90, v90
    v_mfma_f32_16x16x32_bf16 v[16:19], v[176:179], a[48:51], v[16:19]
    ds_read_b64_tr_b16 v[208:209], v226 offset:16384
    v_add_f32 v88, 1.0, v88
    v_mfma_f32_16x16x32_bf16 v[24:27], v[176:179], a[52:55], v[24:27]
    s_add_u32 m0, s40, 0
    v_exp_f32 v91, v91
    v_mfma_f32_16x16x32_bf16 v[32:35], v[176:179], a[192:195], v[32:35]
    ds_read_b64_tr_b16 v[210:211], v226 offset:16896
    v_add_f32 v89, 1.0, v89
    v_mfma_f32_16x16x32_bf16 v[40:43], v[176:179], a[196:199], v[40:43]
    s_add_u32 s45, s36, 295296
    v_rcp_f32 v88, v88
    v_mfma_f32_16x16x32_bf16 v[20:23], v[180:183], a[48:51], v[20:23]
    ds_read_b64_tr_b16 v[212:213], v227 offset:16384
    v_add_f32 v90, 1.0, v90
    v_mfma_f32_16x16x32_bf16 v[28:31], v[180:183], a[52:55], v[28:31]
    buffer_load_dwordx4 v233, s[16:19], s45 offen  lds
    v_mfma_f32_16x16x32_bf16 v[36:39], v[180:183], a[192:195], v[36:39]
    ds_read_b64_tr_b16 v[214:215], v227 offset:16896
    v_add_f32 v91, 1.0, v91
    v_mfma_f32_16x16x32_bf16 v[44:47], v[180:183], a[196:199], v[44:47]
    s_waitcnt lgkmcnt(5)
    v_rcp_f32 v89, v89
    v_mfma_f32_16x16x32_bf16 v[48:51], v[192:195], a[48:51], v[48:51]
    ds_read_b64_tr_b16 v[176:177], v226 offset:12288
    v_mul_f32 v88, v88, v120
    v_mfma_f32_16x16x32_bf16 v[56:59], v[192:195], a[52:55], v[56:59]
    v_rcp_f32 v90, v90
    v_mfma_f32_16x16x32_bf16 v[64:67], v[192:195], a[192:195], v[64:67]
    ds_read_b64_tr_b16 v[178:179], v226 offset:12800
    v_mul_f32 v89, v89, v121
    v_mfma_f32_16x16x32_bf16 v[72:75], v[192:195], a[196:199], v[72:75]
    v_rcp_f32 v91, v91
    v_mfma_f32_16x16x32_bf16 v[52:55], v[196:199], a[48:51], v[52:55]
    ds_read_b64_tr_b16 v[180:181], v227 offset:12288
    v_mul_f32 v90, v90, v122
    v_mfma_f32_16x16x32_bf16 v[60:63], v[196:199], a[52:55], v[60:63]
    v_cvt_pk_bf16_f32 v88, v88, v89
    v_mul_f32 v91, v91, v123
    v_mfma_f32_16x16x32_bf16 v[68:71], v[196:199], a[192:195], v[68:71]
    ds_read_b64_tr_b16 v[182:183], v227 offset:12800
    v_cvt_pk_bf16_f32 v89, v90, v91
    v_mfma_f32_16x16x32_bf16 v[76:79], v[196:199], a[196:199], v[76:79]
    s_waitcnt lgkmcnt(4)
    v_mul_f32 v92, s43, v92
    v_mul_f32 v93, s43, v93
    v_mfma_f32_16x16x32_bf16 v[16:19], v[208:211], a[56:59], v[16:19]
    ds_read_b64_tr_b16 v[192:193], v226 offset:8192
    v_mul_f32 v94, s43, v94
    v_mfma_f32_16x16x32_bf16 v[24:27], v[208:211], a[60:63], v[24:27]
    v_exp_f32 v92, v92
    v_mfma_f32_16x16x32_bf16 v[32:35], v[208:211], a[200:203], v[32:35]
    ds_read_b64_tr_b16 v[194:195], v226 offset:8704
    v_mul_f32 v95, s43, v95
    v_mfma_f32_16x16x32_bf16 v[40:43], v[208:211], a[204:207], v[40:43]
    v_exp_f32 v93, v93
    v_mfma_f32_16x16x32_bf16 v[20:23], v[212:215], a[56:59], v[20:23]
    ds_read_b64_tr_b16 v[196:197], v227 offset:8192
    v_add_f32 v92, 1.0, v92
    v_mfma_f32_16x16x32_bf16 v[28:31], v[212:215], a[60:63], v[28:31]
    v_exp_f32 v94, v94
    v_mfma_f32_16x16x32_bf16 v[36:39], v[212:215], a[200:203], v[36:39]
    ds_read_b64_tr_b16 v[198:199], v227 offset:8704
    v_add_f32 v93, 1.0, v93
    v_mfma_f32_16x16x32_bf16 v[44:47], v[212:215], a[204:207], v[44:47]
    s_waitcnt lgkmcnt(4)
    v_exp_f32 v95, v95
    v_mfma_f32_16x16x32_bf16 v[48:51], v[176:179], a[56:59], v[48:51]
    ds_read_b64_tr_b16 v[208:209], v226 offset:4096
    v_add_f32 v94, 1.0, v94
    v_mfma_f32_16x16x32_bf16 v[56:59], v[176:179], a[60:63], v[56:59]
    v_rcp_f32 v92, v92
    v_mfma_f32_16x16x32_bf16 v[64:67], v[176:179], a[200:203], v[64:67]
    ds_read_b64_tr_b16 v[210:211], v226 offset:4608
    v_add_f32 v95, 1.0, v95
    v_mfma_f32_16x16x32_bf16 v[72:75], v[176:179], a[204:207], v[72:75]
    v_rcp_f32 v93, v93
    v_mfma_f32_16x16x32_bf16 v[52:55], v[180:183], a[56:59], v[52:55]
    ds_read_b64_tr_b16 v[212:213], v227 offset:4096
    v_mul_f32 v92, v92, v124
    v_mfma_f32_16x16x32_bf16 v[60:63], v[180:183], a[60:63], v[60:63]
    v_rcp_f32 v94, v94
    v_mfma_f32_16x16x32_bf16 v[68:71], v[180:183], a[200:203], v[68:71]
    ds_read_b64_tr_b16 v[214:215], v227 offset:4608
    v_mul_f32 v93, v93, v125
    v_mfma_f32_16x16x32_bf16 v[76:79], v[180:183], a[204:207], v[76:79]
    s_waitcnt lgkmcnt(4)
    v_rcp_f32 v95, v95
    v_mfma_f32_16x16x32_bf16 v[16:19], v[192:195], a[64:67], v[16:19]
    ds_read_b64_tr_b16 v[176:177], v226 offset:0
    v_mul_f32 v94, v94, v126
    v_mfma_f32_16x16x32_bf16 v[24:27], v[192:195], a[68:71], v[24:27]
    v_cvt_pk_bf16_f32 v90, v92, v93
    v_mul_f32 v95, v95, v127
    v_mfma_f32_16x16x32_bf16 v[32:35], v[192:195], a[208:211], v[32:35]
    ds_read_b64_tr_b16 v[178:179], v226 offset:512
    v_cvt_pk_bf16_f32 v91, v94, v95
    v_mfma_f32_16x16x32_bf16 v[40:43], v[192:195], a[212:215], v[40:43]
    v_mul_f32 v96, s43, v96
    v_mul_f32 v97, s43, v97
    v_mfma_f32_16x16x32_bf16 v[20:23], v[196:199], a[64:67], v[20:23]
    ds_read_b64_tr_b16 v[180:181], v227 offset:0
    v_mul_f32 v98, s43, v98
    v_mfma_f32_16x16x32_bf16 v[28:31], v[196:199], a[68:71], v[28:31]
    v_exp_f32 v96, v96
    v_mfma_f32_16x16x32_bf16 v[36:39], v[196:199], a[208:211], v[36:39]
    ds_read_b64_tr_b16 v[182:183], v227 offset:512
    v_mul_f32 v99, s43, v99
    v_mfma_f32_16x16x32_bf16 v[44:47], v[196:199], a[212:215], v[44:47]
    s_waitcnt lgkmcnt(4)
    v_exp_f32 v97, v97
    v_mfma_f32_16x16x32_bf16 v[48:51], v[208:211], a[64:67], v[48:51]
    ds_read_b64_tr_b16 v[192:193], v224 offset:61440
    v_add_f32 v96, 1.0, v96
    v_mfma_f32_16x16x32_bf16 v[56:59], v[208:211], a[68:71], v[56:59]
    v_exp_f32 v98, v98
    v_mfma_f32_16x16x32_bf16 v[64:67], v[208:211], a[208:211], v[64:67]
    ds_read_b64_tr_b16 v[194:195], v224 offset:61952
    v_add_f32 v97, 1.0, v97
    v_mfma_f32_16x16x32_bf16 v[72:75], v[208:211], a[212:215], v[72:75]
    ds_read_b64_tr_b16 v[196:197], v225 offset:61440
    v_add_f32 v98, 1.0, v98
    v_mfma_f32_16x16x32_bf16 v[52:55], v[212:215], a[64:67], v[52:55]
    ds_read_b64_tr_b16 v[198:199], v225 offset:61952
    v_mfma_f32_16x16x32_bf16 v[60:63], v[212:215], a[68:71], v[60:63]
    v_exp_f32 v99, v99
    v_mfma_f32_16x16x32_bf16 v[68:71], v[212:215], a[208:211], v[68:71]
    ds_write_b128 v239, v[88:91] offset:33792
    v_add_f32 v99, 1.0, v99
    v_mfma_f32_16x16x32_bf16 v[76:79], v[212:215], a[212:215], v[76:79]
    s_waitcnt lgkmcnt(5)
    v_rcp_f32 v96, v96
    v_mfma_f32_16x16x32_bf16 v[16:19], v[176:179], a[72:75], v[16:19]
    s_waitcnt vmcnt(12)
    s_barrier
    v_mul_f32 v96, v96, v128
    v_mfma_f32_16x16x32_bf16 v[24:27], v[176:179], a[76:79], v[24:27]
    ds_read_b64_tr_b16 v[208:209], v224 offset:57344
    s_add_u32 m0, s40, 94208
    v_mfma_f32_16x16x32_bf16 v[32:35], v[176:179], a[216:219], v[32:35]
    s_add_u32 s45, s36, 590208
    ds_read_b64_tr_b16 v[210:211], v224 offset:57856
    v_mfma_f32_16x16x32_bf16 v[40:43], v[176:179], a[220:223], v[40:43]
    buffer_load_dwordx4 v233, s[12:15], s45 offen  lds
    v_mfma_f32_16x16x32_bf16 v[20:23], v[180:183], a[72:75], v[20:23]
    ds_read_b64_tr_b16 v[212:213], v225 offset:57344
    s_add_u32 m0, s40, 90112
    v_mfma_f32_16x16x32_bf16 v[28:31], v[180:183], a[76:79], v[28:31]
    s_add_u32 s45, s36, 590208
    ds_read_b64_tr_b16 v[214:215], v225 offset:57856
    v_mfma_f32_16x16x32_bf16 v[36:39], v[180:183], a[216:219], v[36:39]
    buffer_load_dwordx4 v233, s[16:19], s45 offen  lds
    v_mfma_f32_16x16x32_bf16 v[44:47], v[180:183], a[220:223], v[44:47]
    s_waitcnt lgkmcnt(5)
    v_rcp_f32 v97, v97
    v_mfma_f32_16x16x32_bf16 v[48:51], v[192:195], a[72:75], v[48:51]
    ds_read_b64_tr_b16 v[176:177], v226 offset:49152
    s_add_u32 m0, s40, 86016
    v_mfma_f32_16x16x32_bf16 v[56:59], v[192:195], a[76:79], v[56:59]
    s_add_u32 s45, s36, 885120
    v_rcp_f32 v98, v98
    v_mfma_f32_16x16x32_bf16 v[64:67], v[192:195], a[216:219], v[64:67]
    ds_read_b64_tr_b16 v[178:179], v226 offset:49664
    v_mul_f32 v97, v97, v129
    v_mfma_f32_16x16x32_bf16 v[72:75], v[192:195], a[220:223], v[72:75]
    buffer_load_dwordx4 v233, s[12:15], s45 offen  lds
    v_mfma_f32_16x16x32_bf16 v[52:55], v[196:199], a[72:75], v[52:55]
    ds_read_b64_tr_b16 v[180:181], v227 offset:49152
    s_add_u32 m0, s40, 81920
    v_mfma_f32_16x16x32_bf16 v[60:63], v[196:199], a[76:79], v[60:63]
    s_add_u32 s45, s36, 885120
    ds_read_b64_tr_b16 v[182:183], v227 offset:49664
    v_mfma_f32_16x16x32_bf16 v[68:71], v[196:199], a[216:219], v[68:71]
    buffer_load_dwordx4 v233, s[16:19], s45 offen  lds
    v_mfma_f32_16x16x32_bf16 v[76:79], v[196:199], a[220:223], v[76:79]
    s_waitcnt lgkmcnt(4)
    v_rcp_f32 v99, v99
    v_mfma_f32_16x16x32_bf16 v[16:19], v[208:211], a[80:83], v[16:19]
    ds_read_b64_tr_b16 v[192:193], v226 offset:45056
    s_add_u32 m0, s40, 77824
    v_mfma_f32_16x16x32_bf16 v[24:27], v[208:211], a[84:87], v[24:27]
    s_add_u32 s45, s36, 1180032
    ds_read_b64_tr_b16 v[194:195], v226 offset:45568
    v_mfma_f32_16x16x32_bf16 v[32:35], v[208:211], a[224:227], v[32:35]
    buffer_load_dwordx4 v233, s[12:15], s45 offen  lds
    v_mfma_f32_16x16x32_bf16 v[40:43], v[208:211], a[228:231], v[40:43]
    s_add_u32 m0, s40, 73728
    ds_read_b64_tr_b16 v[196:197], v227 offset:45056
    v_mfma_f32_16x16x32_bf16 v[20:23], v[212:215], a[80:83], v[20:23]
    s_add_u32 s45, s36, 1180032
    buffer_load_dwordx4 v233, s[16:19], s45 offen  lds
    v_mfma_f32_16x16x32_bf16 v[28:31], v[212:215], a[84:87], v[28:31]
    ds_read_b64_tr_b16 v[198:199], v227 offset:45568
    v_mul_f32 v98, v98, v130
    v_mfma_f32_16x16x32_bf16 v[36:39], v[212:215], a[224:227], v[36:39]
    buffer_load_dword v248, v238, s[20:23], s52 offen
    v_mfma_f32_16x16x32_bf16 v[44:47], v[212:215], a[228:231], v[44:47]
    s_waitcnt lgkmcnt(4)
    v_cvt_pk_bf16_f32 v96, v96, v97
    v_mul_f32 v99, v99, v131
    v_mfma_f32_16x16x32_bf16 v[48:51], v[176:179], a[80:83], v[48:51]
    ds_read_b64_tr_b16 v[208:209], v224 offset:53248
    v_cvt_pk_bf16_f32 v97, v98, v99
    v_mfma_f32_16x16x32_bf16 v[56:59], v[176:179], a[84:87], v[56:59]
    v_mul_f32 v100, s43, v100
    v_mul_f32 v101, s43, v101
    v_mfma_f32_16x16x32_bf16 v[64:67], v[176:179], a[224:227], v[64:67]
    buffer_load_dword v249, v238, s[20:23], s53 offen
    v_mfma_f32_16x16x32_bf16 v[72:75], v[176:179], a[228:231], v[72:75]
    ds_read_b64_tr_b16 v[210:211], v224 offset:53760
    v_mul_f32 v102, s43, v102
    v_mfma_f32_16x16x32_bf16 v[52:55], v[180:183], a[80:83], v[52:55]
    ds_read_b64_tr_b16 v[212:213], v225 offset:53248
    v_mul_f32 v103, s43, v103
    v_mfma_f32_16x16x32_bf16 v[60:63], v[180:183], a[84:87], v[60:63]
    v_exp_f32 v100, v100
    v_mfma_f32_16x16x32_bf16 v[68:71], v[180:183], a[224:227], v[68:71]
    ds_read_b64_tr_b16 v[214:215], v225 offset:53760
    v_add_f32 v100, 1.0, v100
    v_mfma_f32_16x16x32_bf16 v[76:79], v[180:183], a[228:231], v[76:79]
    s_waitcnt lgkmcnt(4)
    v_exp_f32 v101, v101
    v_mfma_f32_16x16x32_bf16 v[16:19], v[192:195], a[88:91], v[16:19]
    ds_read_b64_tr_b16 v[176:177], v224 offset:49152
    v_add_f32 v101, 1.0, v101
    v_mfma_f32_16x16x32_bf16 v[24:27], v[192:195], a[92:95], v[24:27]
    v_exp_f32 v102, v102
    v_mfma_f32_16x16x32_bf16 v[32:35], v[192:195], a[232:235], v[32:35]
    ds_read_b64_tr_b16 v[178:179], v224 offset:49664
    v_add_f32 v102, 1.0, v102
    v_mfma_f32_16x16x32_bf16 v[40:43], v[192:195], a[236:239], v[40:43]
    v_exp_f32 v103, v103
    v_mfma_f32_16x16x32_bf16 v[20:23], v[196:199], a[88:91], v[20:23]
    ds_read_b64_tr_b16 v[180:181], v225 offset:49152
    v_add_f32 v103, 1.0, v103
    v_mfma_f32_16x16x32_bf16 v[28:31], v[196:199], a[92:95], v[28:31]
    v_rcp_f32 v100, v100
    v_mfma_f32_16x16x32_bf16 v[36:39], v[196:199], a[232:235], v[36:39]
    ds_read_b64_tr_b16 v[182:183], v225 offset:49664
    v_mul_f32 v100, v100, v132
    v_mfma_f32_16x16x32_bf16 v[44:47], v[196:199], a[236:239], v[44:47]
    s_waitcnt lgkmcnt(4)
    v_rcp_f32 v101, v101
    v_mfma_f32_16x16x32_bf16 v[48:51], v[208:211], a[88:91], v[48:51]
    ds_read_b64_tr_b16 v[192:193], v224 offset:45056
    v_mul_f32 v101, v101, v133
    v_mfma_f32_16x16x32_bf16 v[56:59], v[208:211], a[92:95], v[56:59]
    v_rcp_f32 v102, v102
    v_mfma_f32_16x16x32_bf16 v[64:67], v[208:211], a[232:235], v[64:67]
    ds_read_b64_tr_b16 v[194:195], v224 offset:45568
    v_mul_f32 v102, v102, v134
    v_mfma_f32_16x16x32_bf16 v[72:75], v[208:211], a[236:239], v[72:75]
    v_rcp_f32 v103, v103
    v_mfma_f32_16x16x32_bf16 v[52:55], v[212:215], a[88:91], v[52:55]
    ds_read_b64_tr_b16 v[196:197], v225 offset:45056
    v_cvt_pk_bf16_f32 v98, v100, v101
    v_mfma_f32_16x16x32_bf16 v[60:63], v[212:215], a[92:95], v[60:63]
    v_mul_f32 v103, v103, v135
    v_cvt_pk_bf16_f32 v99, v102, v103
    v_mfma_f32_16x16x32_bf16 v[68:71], v[212:215], a[232:235], v[68:71]
    ds_read_b64_tr_b16 v[198:199], v225 offset:45568
    v_mul_f32 v104, s43, v104
    v_mfma_f32_16x16x32_bf16 v[76:79], v[212:215], a[236:239], v[76:79]
    s_waitcnt lgkmcnt(4)
    v_exp_f32 v104, v104
    v_mfma_f32_16x16x32_bf16 v[16:19], v[176:179], a[96:99], v[16:19]
    ds_read_b64_tr_b16 v[208:209], v224 offset:40960
    v_mul_f32 v105, s43, v105
    v_mfma_f32_16x16x32_bf16 v[24:27], v[176:179], a[100:103], v[24:27]
    v_exp_f32 v105, v105
    v_mfma_f32_16x16x32_bf16 v[32:35], v[176:179], a[240:243], v[32:35]
    ds_read_b64_tr_b16 v[210:211], v224 offset:41472
    v_mul_f32 v106, s43, v106
    v_mfma_f32_16x16x32_bf16 v[40:43], v[176:179], a[244:247], v[40:43]
    ds_read_b64_tr_b16 v[212:213], v225 offset:40960
    v_mul_f32 v107, s43, v107
    v_mfma_f32_16x16x32_bf16 v[20:23], v[180:183], a[96:99], v[20:23]
    ds_read_b64_tr_b16 v[214:215], v225 offset:41472
    v_add_f32 v104, 1.0, v104
    v_mfma_f32_16x16x32_bf16 v[28:31], v[180:183], a[100:103], v[28:31]
    v_exp_f32 v106, v106
    v_mfma_f32_16x16x32_bf16 v[36:39], v[180:183], a[240:243], v[36:39]
    ds_write_b128 v240, v[96:99] offset:32768
    v_add_f32 v105, 1.0, v105
    v_mfma_f32_16x16x32_bf16 v[44:47], v[180:183], a[244:247], v[44:47]
    s_waitcnt lgkmcnt(5)
    v_exp_f32 v107, v107
    v_mfma_f32_16x16x32_bf16 v[48:51], v[192:195], a[96:99], v[48:51]
    ds_read_b64_tr_b16 v[176:177], v224 offset:36864
    v_add_f32 v106, 1.0, v106
    v_mfma_f32_16x16x32_bf16 v[56:59], v[192:195], a[100:103], v[56:59]
    v_rcp_f32 v104, v104
    v_mfma_f32_16x16x32_bf16 v[64:67], v[192:195], a[240:243], v[64:67]
    ds_read_b64_tr_b16 v[178:179], v224 offset:37376
    v_add_f32 v107, 1.0, v107
    v_mfma_f32_16x16x32_bf16 v[72:75], v[192:195], a[244:247], v[72:75]
    v_rcp_f32 v105, v105
    v_mfma_f32_16x16x32_bf16 v[52:55], v[196:199], a[96:99], v[52:55]
    ds_read_b64_tr_b16 v[180:181], v225 offset:36864
    v_mul_f32 v104, v104, v136
    v_mfma_f32_16x16x32_bf16 v[60:63], v[196:199], a[100:103], v[60:63]
    v_rcp_f32 v106, v106
    v_mfma_f32_16x16x32_bf16 v[68:71], v[196:199], a[240:243], v[68:71]
    ds_read_b64_tr_b16 v[182:183], v225 offset:37376
    v_mul_f32 v105, v105, v137
    v_mfma_f32_16x16x32_bf16 v[76:79], v[196:199], a[244:247], v[76:79]
    s_waitcnt lgkmcnt(5)
    v_rcp_f32 v107, v107
    v_mfma_f32_16x16x32_bf16 v[16:19], v[208:211], a[104:107], v[16:19]
    s_waitcnt vmcnt(12)
    v_mul_f32 v106, v106, v138
    v_cvt_pk_bf16_f32 v104, v104, v105
    v_mfma_f32_16x16x32_bf16 v[24:27], v[208:211], a[108:111], v[24:27]
    s_barrier
    v_mul_f32 v107, v107, v139
    v_cvt_pk_bf16_f32 v105, v106, v107
    v_mfma_f32_16x16x32_bf16 v[32:35], v[208:211], a[248:251], v[32:35]
    ds_read_b64_tr_b16 v[192:193], v224 offset:32768
    v_mul_f32 v108, s43, v108
    v_mfma_f32_16x16x32_bf16 v[40:43], v[208:211], a[252:255], v[40:43]
    v_exp_f32 v108, v108
    v_mfma_f32_16x16x32_bf16 v[20:23], v[212:215], a[104:107], v[20:23]
    ds_read_b64_tr_b16 v[194:195], v224 offset:33280
    v_mul_f32 v109, s43, v109
    v_mfma_f32_16x16x32_bf16 v[28:31], v[212:215], a[108:111], v[28:31]
    ds_read_b64_tr_b16 v[196:197], v225 offset:32768
    v_mul_f32 v110, s43, v110
    v_mfma_f32_16x16x32_bf16 v[36:39], v[212:215], a[248:251], v[36:39]
    ds_read_b64_tr_b16 v[198:199], v225 offset:33280
    v_mul_f32 v111, s43, v111
    v_mfma_f32_16x16x32_bf16 v[44:47], v[212:215], a[252:255], v[44:47]
    s_waitcnt lgkmcnt(4)
    v_exp_f32 v109, v109
    v_mfma_f32_16x16x32_bf16 v[48:51], v[176:179], a[104:107], v[48:51]
    ds_read_b64_tr_b16 v[208:209], v224 offset:28672
    v_add_f32 v108, 1.0, v108
    v_mfma_f32_16x16x32_bf16 v[56:59], v[176:179], a[108:111], v[56:59]
    v_exp_f32 v110, v110
    v_mfma_f32_16x16x32_bf16 v[64:67], v[176:179], a[248:251], v[64:67]
    ds_read_b64_tr_b16 v[210:211], v224 offset:29184
    v_add_f32 v109, 1.0, v109
    v_mfma_f32_16x16x32_bf16 v[72:75], v[176:179], a[252:255], v[72:75]
    v_exp_f32 v111, v111
    v_mfma_f32_16x16x32_bf16 v[52:55], v[180:183], a[104:107], v[52:55]
    ds_read_b64_tr_b16 v[212:213], v225 offset:28672
    v_add_f32 v110, 1.0, v110
    v_mfma_f32_16x16x32_bf16 v[60:63], v[180:183], a[108:111], v[60:63]
    v_rcp_f32 v108, v108
    v_mfma_f32_16x16x32_bf16 v[68:71], v[180:183], a[248:251], v[68:71]
    ds_read_b64_tr_b16 v[214:215], v225 offset:29184
    v_add_f32 v111, 1.0, v111
    v_mfma_f32_16x16x32_bf16 v[76:79], v[180:183], a[252:255], v[76:79]
    s_waitcnt lgkmcnt(4)
    v_rcp_f32 v109, v109
    v_mfma_f32_16x16x32_bf16 v[16:19], v[192:195], a[112:115], v[16:19]
    ds_read_b64_tr_b16 v[176:177], v224 offset:24576
    v_mul_f32 v108, v108, v140
    v_mfma_f32_16x16x32_bf16 v[24:27], v[192:195], a[116:119], v[24:27]
    v_rcp_f32 v110, v110
    v_mfma_f32_16x16x32_bf16 v[32:35], v[192:195], v[144:147], v[32:35]
    ds_read_b64_tr_b16 v[178:179], v224 offset:25088
    v_mul_f32 v109, v109, v141
    v_mfma_f32_16x16x32_bf16 v[40:43], v[192:195], v[148:151], v[40:43]
    v_rcp_f32 v111, v111
    v_mfma_f32_16x16x32_bf16 v[20:23], v[196:199], a[112:115], v[20:23]
    ds_read_b64_tr_b16 v[180:181], v225 offset:24576
    v_mul_f32 v110, v110, v142
    v_mfma_f32_16x16x32_bf16 v[28:31], v[196:199], a[116:119], v[28:31]
    v_cvt_pk_bf16_f32 v106, v108, v109
    v_mul_f32 v111, v111, v143
    v_mfma_f32_16x16x32_bf16 v[36:39], v[196:199], v[144:147], v[36:39]
    ds_read_b64_tr_b16 v[182:183], v225 offset:25088
    v_cvt_pk_bf16_f32 v107, v110, v111
    v_mfma_f32_16x16x32_bf16 v[44:47], v[196:199], v[148:151], v[44:47]
    s_waitcnt lgkmcnt(4)
    v_mfma_f32_16x16x32_bf16 v[48:51], v[208:211], a[112:115], v[48:51]
    ds_read_b64_tr_b16 v[192:193], v224 offset:20480
    v_mfma_f32_16x16x32_bf16 v[56:59], v[208:211], a[116:119], v[56:59]
    v_mfma_f32_16x16x32_bf16 v[64:67], v[208:211], v[144:147], v[64:67]
    ds_read_b64_tr_b16 v[194:195], v224 offset:20992
    v_mfma_f32_16x16x32_bf16 v[72:75], v[208:211], v[148:151], v[72:75]
    ds_read_b64_tr_b16 v[196:197], v225 offset:20480
    v_mfma_f32_16x16x32_bf16 v[52:55], v[212:215], a[112:115], v[52:55]
    ds_read_b64_tr_b16 v[198:199], v225 offset:20992
    v_mfma_f32_16x16x32_bf16 v[60:63], v[212:215], a[116:119], v[60:63]
    v_mfma_f32_16x16x32_bf16 v[68:71], v[212:215], v[144:147], v[68:71]
    ds_write_b128 v240, v[104:107] offset:33792
    v_mfma_f32_16x16x32_bf16 v[76:79], v[212:215], v[148:151], v[76:79]
    s_waitcnt lgkmcnt(5)
    v_mfma_f32_16x16x32_bf16 v[16:19], v[176:179], a[120:123], v[16:19]
    ds_read_b64_tr_b16 v[208:209], v224 offset:16384
    v_mfma_f32_16x16x32_bf16 v[24:27], v[176:179], a[124:127], v[24:27]
    v_mfma_f32_16x16x32_bf16 v[32:35], v[176:179], v[152:155], v[32:35]
    ds_read_b64_tr_b16 v[210:211], v224 offset:16896
    v_mfma_f32_16x16x32_bf16 v[40:43], v[176:179], v[156:159], v[40:43]
    v_mfma_f32_16x16x32_bf16 v[20:23], v[180:183], a[120:123], v[20:23]
    ds_read_b64_tr_b16 v[212:213], v225 offset:16384
    v_mfma_f32_16x16x32_bf16 v[28:31], v[180:183], a[124:127], v[28:31]
    v_mfma_f32_16x16x32_bf16 v[36:39], v[180:183], v[152:155], v[36:39]
    ds_read_b64_tr_b16 v[214:215], v225 offset:16896
    v_mfma_f32_16x16x32_bf16 v[44:47], v[180:183], v[156:159], v[44:47]
    s_waitcnt lgkmcnt(5)
    v_mfma_f32_16x16x32_bf16 v[48:51], v[192:195], a[120:123], v[48:51]
    ds_read_b64_tr_b16 v[176:177], v224 offset:12288
    v_mfma_f32_16x16x32_bf16 v[56:59], v[192:195], a[124:127], v[56:59]
    v_mfma_f32_16x16x32_bf16 v[64:67], v[192:195], v[152:155], v[64:67]
    ds_read_b64_tr_b16 v[178:179], v224 offset:12800
    v_mfma_f32_16x16x32_bf16 v[72:75], v[192:195], v[156:159], v[72:75]
    v_mfma_f32_16x16x32_bf16 v[52:55], v[196:199], a[120:123], v[52:55]
    ds_read_b64_tr_b16 v[180:181], v225 offset:12288
    v_mfma_f32_16x16x32_bf16 v[60:63], v[196:199], a[124:127], v[60:63]
    v_mfma_f32_16x16x32_bf16 v[68:71], v[196:199], v[152:155], v[68:71]
    ds_read_b64_tr_b16 v[182:183], v225 offset:12800
    v_mfma_f32_16x16x32_bf16 v[76:79], v[196:199], v[156:159], v[76:79]
    s_waitcnt lgkmcnt(4)
    v_mfma_f32_16x16x32_bf16 v[16:19], v[208:211], a[128:131], v[16:19]
    ds_read_b64_tr_b16 v[192:193], v224 offset:8192
    v_mfma_f32_16x16x32_bf16 v[24:27], v[208:211], a[132:135], v[24:27]
    v_mfma_f32_16x16x32_bf16 v[32:35], v[208:211], v[160:163], v[32:35]
    ds_read_b64_tr_b16 v[194:195], v224 offset:8704
    v_mfma_f32_16x16x32_bf16 v[40:43], v[208:211], v[164:167], v[40:43]
    v_mfma_f32_16x16x32_bf16 v[20:23], v[212:215], a[128:131], v[20:23]
    ds_read_b64_tr_b16 v[196:197], v225 offset:8192
    v_mfma_f32_16x16x32_bf16 v[28:31], v[212:215], a[132:135], v[28:31]
    v_mfma_f32_16x16x32_bf16 v[36:39], v[212:215], v[160:163], v[36:39]
    ds_read_b64_tr_b16 v[198:199], v225 offset:8704
    v_mfma_f32_16x16x32_bf16 v[44:47], v[212:215], v[164:167], v[44:47]
    s_waitcnt lgkmcnt(4)
    v_mfma_f32_16x16x32_bf16 v[48:51], v[176:179], a[128:131], v[48:51]
    ds_read_b64_tr_b16 v[208:209], v226 offset:40960
    v_mfma_f32_16x16x32_bf16 v[56:59], v[176:179], a[132:135], v[56:59]
    v_mfma_f32_16x16x32_bf16 v[64:67], v[176:179], v[160:163], v[64:67]
    ds_read_b64_tr_b16 v[210:211], v226 offset:41472
    v_mfma_f32_16x16x32_bf16 v[72:75], v[176:179], v[164:167], v[72:75]
    v_mfma_f32_16x16x32_bf16 v[52:55], v[180:183], a[128:131], v[52:55]
    ds_read_b64_tr_b16 v[212:213], v227 offset:40960
    v_mfma_f32_16x16x32_bf16 v[60:63], v[180:183], a[132:135], v[60:63]
    v_mfma_f32_16x16x32_bf16 v[68:71], v[180:183], v[160:163], v[68:71]
    ds_read_b64_tr_b16 v[214:215], v227 offset:41472
    v_mfma_f32_16x16x32_bf16 v[76:79], v[180:183], v[164:167], v[76:79]
    s_waitcnt lgkmcnt(4)
    v_mfma_f32_16x16x32_bf16 v[16:19], v[192:195], a[136:139], v[16:19]
    s_waitcnt vmcnt(4)
    v_mfma_f32_16x16x32_bf16 v[24:27], v[192:195], a[140:143], v[24:27]
    s_barrier
    v_mfma_f32_16x16x32_bf16 v[32:35], v[192:195], v[168:171], v[32:35]
    ds_read_b64_tr_b16 v[176:177], v226 offset:36864
    v_mfma_f32_16x16x32_bf16 v[40:43], v[192:195], v[172:175], v[40:43]
    v_mfma_f32_16x16x32_bf16 v[20:23], v[196:199], a[136:139], v[20:23]
    ds_read_b64_tr_b16 v[178:179], v226 offset:37376
    v_mfma_f32_16x16x32_bf16 v[28:31], v[196:199], a[140:143], v[28:31]
    ds_read_b64_tr_b16 v[180:181], v227 offset:36864
    v_mfma_f32_16x16x32_bf16 v[36:39], v[196:199], v[168:171], v[36:39]
    ds_read_b64_tr_b16 v[182:183], v227 offset:37376
    v_mfma_f32_16x16x32_bf16 v[44:47], v[196:199], v[172:175], v[44:47]
    s_waitcnt lgkmcnt(4)
    v_mfma_f32_16x16x32_bf16 v[48:51], v[208:211], a[136:139], v[48:51]
    ds_read_b64_tr_b16 v[192:193], v226 offset:32768
    v_mfma_f32_16x16x32_bf16 v[56:59], v[208:211], a[140:143], v[56:59]
    v_mfma_f32_16x16x32_bf16 v[64:67], v[208:211], v[168:171], v[64:67]
    ds_read_b64_tr_b16 v[194:195], v226 offset:33280
    v_mfma_f32_16x16x32_bf16 v[72:75], v[208:211], v[172:175], v[72:75]
    v_mfma_f32_16x16x32_bf16 v[52:55], v[212:215], a[136:139], v[52:55]
    ds_read_b64_tr_b16 v[196:197], v227 offset:32768
    v_mfma_f32_16x16x32_bf16 v[60:63], v[212:215], a[140:143], v[60:63]
    v_mfma_f32_16x16x32_bf16 v[68:71], v[212:215], v[168:171], v[68:71]
    ds_read_b64_tr_b16 v[198:199], v227 offset:33280
    v_mfma_f32_16x16x32_bf16 v[76:79], v[212:215], v[172:175], v[76:79]
    s_waitcnt lgkmcnt(4)
    v_mfma_f32_16x16x32_bf16 v[80:83], v[176:179], a[0:3], 0
    ds_read_b64_tr_b16 v[208:209], v224 offset:4096
    s_add_u32 m0, s40, 110592
    v_mfma_f32_16x16x32_bf16 v[88:91], v[176:179], a[4:7], 0
    s_add_u32 s45, s36, 1474944
    v_mfma_f32_16x16x32_bf16 v[96:99], v[176:179], a[144:147], 0
    ds_read_b64_tr_b16 v[210:211], v224 offset:4608
    v_mfma_f32_16x16x32_bf16 v[104:107], v[176:179], a[148:151], 0
    buffer_load_dwordx4 v233, s[12:15], s45 offen  lds
    v_mfma_f32_16x16x32_bf16 v[84:87], v[180:183], a[0:3], 0
    ds_read_b64_tr_b16 v[212:213], v225 offset:4096
    s_add_u32 m0, s40, 69632
    v_mfma_f32_16x16x32_bf16 v[92:95], v[180:183], a[4:7], 0
    s_add_u32 s45, s36, 1474944
    ds_read_b64_tr_b16 v[214:215], v225 offset:4608
    v_mfma_f32_16x16x32_bf16 v[100:103], v[180:183], a[144:147], 0
    buffer_load_dwordx4 v233, s[16:19], s45 offen  lds
    v_mfma_f32_16x16x32_bf16 v[108:111], v[180:183], a[148:151], 0
    s_waitcnt lgkmcnt(4)
    v_mfma_f32_16x16x32_bf16 v[112:115], v[192:195], a[0:3], 0
    ds_read_b64_tr_b16 v[176:177], v224 offset:0
    s_add_u32 m0, s40, 65536
    v_mfma_f32_16x16x32_bf16 v[120:123], v[192:195], a[4:7], 0
    s_add_u32 s45, s36, 1769856
    v_mul_f32 v16, s43, v16
    v_mul_f32 v17, s43, v17
    v_mfma_f32_16x16x32_bf16 v[128:131], v[192:195], a[144:147], 0
    ds_read_b64_tr_b16 v[178:179], v224 offset:512
    v_mul_f32 v18, s43, v18
    v_mfma_f32_16x16x32_bf16 v[136:139], v[192:195], a[148:151], 0
    buffer_load_dwordx4 v233, s[12:15], s45 offen  lds
    v_mfma_f32_16x16x32_bf16 v[116:119], v[196:199], a[0:3], 0
    ds_read_b64_tr_b16 v[180:181], v225 offset:0
    s_add_u32 m0, s40, 61440
    v_mfma_f32_16x16x32_bf16 v[124:127], v[196:199], a[4:7], 0
    s_add_u32 s45, s36, 1769856
    ds_read_b64_tr_b16 v[182:183], v225 offset:512
    v_mfma_f32_16x16x32_bf16 v[132:135], v[196:199], a[144:147], 0
    buffer_load_dwordx4 v233, s[16:19], s45 offen  lds
    v_mfma_f32_16x16x32_bf16 v[140:143], v[196:199], a[148:151], 0
    s_waitcnt lgkmcnt(4)
    v_exp_f32 v16, v16
    v_mfma_f32_16x16x32_bf16 v[80:83], v[208:211], a[8:11], v[80:83]
    ds_read_b64_tr_b16 v[192:193], v226 offset:28672
    s_add_u32 m0, s40, 57344
    v_mfma_f32_16x16x32_bf16 v[88:91], v[208:211], a[12:15], v[88:91]
    s_add_u32 s45, s36, 2064768
    v_exp_f32 v17, v17
    v_mfma_f32_16x16x32_bf16 v[96:99], v[208:211], a[152:155], v[96:99]
    ds_read_b64_tr_b16 v[194:195], v226 offset:29184
    v_mul_f32 v19, s43, v19
    v_mfma_f32_16x16x32_bf16 v[104:107], v[208:211], a[156:159], v[104:107]
    buffer_load_dwordx4 v233, s[12:15], s45 offen  lds
    v_mfma_f32_16x16x32_bf16 v[84:87], v[212:215], a[8:11], v[84:87]
    ds_read_b64_tr_b16 v[196:197], v227 offset:28672
    s_add_u32 m0, s40, 53248
    v_mfma_f32_16x16x32_bf16 v[92:95], v[212:215], a[12:15], v[92:95]
    s_add_u32 s45, s36, 2064768
    ds_read_b64_tr_b16 v[198:199], v227 offset:29184
    v_mfma_f32_16x16x32_bf16 v[100:103], v[212:215], a[152:155], v[100:103]
    buffer_load_dwordx4 v233, s[16:19], s45 offen  lds
    v_mfma_f32_16x16x32_bf16 v[108:111], v[212:215], a[156:159], v[108:111]
    s_waitcnt lgkmcnt(4)
    v_exp_f32 v18, v18
    v_mfma_f32_16x16x32_bf16 v[112:115], v[176:179], a[8:11], v[112:115]
    ds_read_b64_tr_b16 v[208:209], v226 offset:24576
    s_add_u32 m0, s40, 49152
    v_mfma_f32_16x16x32_bf16 v[120:123], v[176:179], a[12:15], v[120:123]
    s_add_u32 s45, s36, 2359680
    v_exp_f32 v19, v19
    v_mfma_f32_16x16x32_bf16 v[128:131], v[176:179], a[152:155], v[128:131]
    ds_read_b64_tr_b16 v[210:211], v226 offset:25088
    v_add_f32 v16, 1.0, v16
    v_mfma_f32_16x16x32_bf16 v[136:139], v[176:179], a[156:159], v[136:139]
    buffer_load_dwordx4 v233, s[12:15], s45 offen  lds
    v_mfma_f32_16x16x32_bf16 v[116:119], v[180:183], a[8:11], v[116:119]
    ds_read_b64_tr_b16 v[212:213], v227 offset:24576
    s_add_u32 m0, s40, 45056
    v_mfma_f32_16x16x32_bf16 v[124:127], v[180:183], a[12:15], v[124:127]
    s_add_u32 s45, s36, 2359680
    ds_read_b64_tr_b16 v[214:215], v227 offset:25088
    v_mfma_f32_16x16x32_bf16 v[132:135], v[180:183], a[152:155], v[132:135]
    buffer_load_dwordx4 v233, s[16:19], s45 offen  lds
    v_mfma_f32_16x16x32_bf16 v[140:143], v[180:183], a[156:159], v[140:143]
    s_waitcnt lgkmcnt(4)
    v_rcp_f32 v16, v16
    v_mfma_f32_16x16x32_bf16 v[80:83], v[192:195], a[16:19], v[80:83]
    ds_read_b64_tr_b16 v[176:177], v226 offset:20480
    s_add_u32 m0, s40, 40960
    v_mfma_f32_16x16x32_bf16 v[88:91], v[192:195], a[20:23], v[88:91]
    s_add_u32 s45, s36, 2654592
    v_add_f32 v17, 1.0, v17
    v_add_f32 v18, 1.0, v18
    v_mfma_f32_16x16x32_bf16 v[96:99], v[192:195], a[160:163], v[96:99]
    ds_read_b64_tr_b16 v[178:179], v226 offset:20992
    v_add_f32 v19, 1.0, v19
    v_mfma_f32_16x16x32_bf16 v[104:107], v[192:195], a[164:167], v[104:107]
    buffer_load_dwordx4 v233, s[12:15], s45 offen  lds
    v_mfma_f32_16x16x32_bf16 v[84:87], v[196:199], a[16:19], v[84:87]
    ds_read_b64_tr_b16 v[180:181], v227 offset:20480
    s_add_u32 m0, s40, 36864
    v_mfma_f32_16x16x32_bf16 v[92:95], v[196:199], a[20:23], v[92:95]
    s_add_u32 s45, s36, 2654592
    ds_read_b64_tr_b16 v[182:183], v227 offset:20992
    v_mfma_f32_16x16x32_bf16 v[100:103], v[196:199], a[160:163], v[100:103]
    buffer_load_dwordx4 v233, s[16:19], s45 offen  lds
    v_mfma_f32_16x16x32_bf16 v[108:111], v[196:199], a[164:167], v[108:111]
    s_waitcnt lgkmcnt(4)
    v_rcp_f32 v17, v17
    v_mfma_f32_16x16x32_bf16 v[112:115], v[208:211], a[16:19], v[112:115]
    ds_read_b64_tr_b16 v[192:193], v226 offset:16384
    s_add_u32 m0, s40, 32768
    v_mfma_f32_16x16x32_bf16 v[120:123], v[208:211], a[20:23], v[120:123]
    s_add_u32 s45, s36, 2949504
    v_rcp_f32 v18, v18
    v_mfma_f32_16x16x32_bf16 v[128:131], v[208:211], a[160:163], v[128:131]
    ds_read_b64_tr_b16 v[194:195], v226 offset:16896
    v_mul_f32 v16, v16, v48
    v_mfma_f32_16x16x32_bf16 v[136:139], v[208:211], a[164:167], v[136:139]
    buffer_load_dwordx4 v233, s[12:15], s45 offen  lds
    v_mfma_f32_16x16x32_bf16 v[116:119], v[212:215], a[16:19], v[116:119]
    ds_read_b64_tr_b16 v[196:197], v227 offset:16384
    s_add_u32 m0, s40, 28672
    v_mfma_f32_16x16x32_bf16 v[124:127], v[212:215], a[20:23], v[124:127]
    s_add_u32 s45, s36, 2949504
    ds_read_b64_tr_b16 v[198:199], v227 offset:16896
    v_mfma_f32_16x16x32_bf16 v[132:135], v[212:215], a[160:163], v[132:135]
    buffer_load_dwordx4 v233, s[16:19], s45 offen  lds
    v_mfma_f32_16x16x32_bf16 v[140:143], v[212:215], a[164:167], v[140:143]
    s_waitcnt lgkmcnt(4)
    v_rcp_f32 v19, v19
    v_mfma_f32_16x16x32_bf16 v[80:83], v[176:179], a[24:27], v[80:83]
    s_waitcnt vmcnt(6)
    s_barrier
    v_mul_f32 v17, v17, v49
    v_mfma_f32_16x16x32_bf16 v[88:91], v[176:179], a[28:31], v[88:91]
    ds_read_b64_tr_b16 v[208:209], v226 offset:12288
    s_add_u32 m0, s40, 106496
    v_mfma_f32_16x16x32_bf16 v[96:99], v[176:179], a[168:171], v[96:99]
    s_add_u32 s45, s36, 3244416
    ds_read_b64_tr_b16 v[210:211], v226 offset:12800
    v_mfma_f32_16x16x32_bf16 v[104:107], v[176:179], a[172:175], v[104:107]
    buffer_load_dwordx4 v233, s[12:15], s45 offen  lds
    v_mfma_f32_16x16x32_bf16 v[84:87], v[180:183], a[24:27], v[84:87]
    ds_read_b64_tr_b16 v[212:213], v227 offset:12288
    s_add_u32 m0, s40, 102400
    v_mfma_f32_16x16x32_bf16 v[92:95], v[180:183], a[28:31], v[92:95]
    s_add_u32 s45, s36, 3244416
    ds_read_b64_tr_b16 v[214:215], v227 offset:12800
    v_mfma_f32_16x16x32_bf16 v[100:103], v[180:183], a[168:171], v[100:103]
    buffer_load_dwordx4 v233, s[16:19], s45 offen  lds
    v_mfma_f32_16x16x32_bf16 v[108:111], v[180:183], a[172:175], v[108:111]
    s_waitcnt lgkmcnt(4)
    v_mul_f32 v18, v18, v50
    v_cvt_pk_bf16_f32 v16, v16, v17
    v_mfma_f32_16x16x32_bf16 v[112:115], v[192:195], a[24:27], v[112:115]
    ds_read_b64_tr_b16 v[176:177], v226 offset:8192
    s_add_u32 m0, s40, 98304
    v_mul_f32 v19, v19, v51
    v_mfma_f32_16x16x32_bf16 v[120:123], v[192:195], a[28:31], v[120:123]
    s_add_u32 s45, s36, 3539328
    v_cvt_pk_bf16_f32 v17, v18, v19
    v_mul_f32 v20, s43, v20
    v_mfma_f32_16x16x32_bf16 v[128:131], v[192:195], a[168:171], v[128:131]
    ds_read_b64_tr_b16 v[178:179], v226 offset:8704
    v_mul_f32 v21, s43, v21
    v_mfma_f32_16x16x32_bf16 v[136:139], v[192:195], a[172:175], v[136:139]
    buffer_load_dwordx4 v233, s[12:15], s45 offen  lds
    v_mfma_f32_16x16x32_bf16 v[116:119], v[196:199], a[24:27], v[116:119]
    ds_read_b64_tr_b16 v[180:181], v227 offset:8192
    s_add_u32 m0, s40, 94208
    v_mul_f32 v22, s43, v22
    v_mfma_f32_16x16x32_bf16 v[124:127], v[196:199], a[28:31], v[124:127]
    s_add_u32 s45, s36, 3539328
    ds_read_b64_tr_b16 v[182:183], v227 offset:8704
    v_mul_f32 v23, s43, v23
    v_mfma_f32_16x16x32_bf16 v[132:135], v[196:199], a[168:171], v[132:135]
    buffer_load_dwordx4 v233, s[16:19], s45 offen  lds
    v_exp_f32 v20, v20
    v_mfma_f32_16x16x32_bf16 v[140:143], v[196:199], a[172:175], v[140:143]
    s_waitcnt lgkmcnt(4)
    v_exp_f32 v21, v21
    v_mfma_f32_16x16x32_bf16 v[80:83], v[208:211], a[32:35], v[80:83]
    ds_read_b64_tr_b16 v[192:193], v226 offset:45056
    s_add_u32 m0, s40, 90112
    v_add_f32 v20, 1.0, v20
    v_mfma_f32_16x16x32_bf16 v[88:91], v[208:211], a[36:39], v[88:91]
    s_add_u32 s45, s36, 3834240
    v_exp_f32 v22, v22
    v_mfma_f32_16x16x32_bf16 v[96:99], v[208:211], a[176:179], v[96:99]
    ds_read_b64_tr_b16 v[194:195], v226 offset:45568
    v_add_f32 v21, 1.0, v21
    v_mfma_f32_16x16x32_bf16 v[104:107], v[208:211], a[180:183], v[104:107]
    buffer_load_dwordx4 v233, s[12:15], s45 offen  lds
    v_mfma_f32_16x16x32_bf16 v[84:87], v[212:215], a[32:35], v[84:87]
    ds_read_b64_tr_b16 v[196:197], v227 offset:45056
    s_add_u32 m0, s40, 86016
    v_exp_f32 v23, v23
    v_mfma_f32_16x16x32_bf16 v[92:95], v[212:215], a[36:39], v[92:95]
    s_add_u32 s45, s36, 3834240
    ds_read_b64_tr_b16 v[198:199], v227 offset:45568
    v_mfma_f32_16x16x32_bf16 v[100:103], v[212:215], a[176:179], v[100:103]
    buffer_load_dwordx4 v233, s[16:19], s45 offen  lds
    v_add_f32 v22, 1.0, v22
    v_mfma_f32_16x16x32_bf16 v[108:111], v[212:215], a[180:183], v[108:111]
    s_waitcnt lgkmcnt(4)
    v_rcp_f32 v20, v20
    v_mfma_f32_16x16x32_bf16 v[112:115], v[176:179], a[32:35], v[112:115]
    ds_read_b64_tr_b16 v[208:209], v226 offset:4096
    s_add_u32 m0, s40, 24576
    v_add_f32 v23, 1.0, v23
    v_mfma_f32_16x16x32_bf16 v[120:123], v[176:179], a[36:39], v[120:123]
    s_add_u32 s45, s36, 4129152
    v_rcp_f32 v21, v21
    v_mfma_f32_16x16x32_bf16 v[128:131], v[176:179], a[176:179], v[128:131]
    ds_read_b64_tr_b16 v[210:211], v226 offset:4608
    v_mul_f32 v20, v20, v52
    v_mfma_f32_16x16x32_bf16 v[136:139], v[176:179], a[180:183], v[136:139]
    buffer_load_dwordx4 v233, s[12:15], s45 offen  lds
    v_mfma_f32_16x16x32_bf16 v[116:119], v[180:183], a[32:35], v[116:119]
    ds_read_b64_tr_b16 v[212:213], v227 offset:4096
    s_add_u32 m0, s40, 20480
    v_rcp_f32 v22, v22
    v_mfma_f32_16x16x32_bf16 v[124:127], v[180:183], a[36:39], v[124:127]
    s_add_u32 s45, s36, 4129152
    ds_read_b64_tr_b16 v[214:215], v227 offset:4608
    v_mfma_f32_16x16x32_bf16 v[132:135], v[180:183], a[176:179], v[132:135]
    buffer_load_dwordx4 v233, s[16:19], s45 offen  lds
    v_mul_f32 v21, v21, v53
    v_mfma_f32_16x16x32_bf16 v[140:143], v[180:183], a[180:183], v[140:143]
    s_waitcnt lgkmcnt(4)
    v_rcp_f32 v23, v23
    v_mfma_f32_16x16x32_bf16 v[80:83], v[192:195], a[40:43], v[80:83]
    ds_read_b64_tr_b16 v[176:177], v226 offset:0
    s_add_u32 m0, s40, 16384
    v_mfma_f32_16x16x32_bf16 v[88:91], v[192:195], a[44:47], v[88:91]
    s_add_u32 s45, s36, 4424064
    v_mul_f32 v22, v22, v54
    v_cvt_pk_bf16_f32 v18, v20, v21
    v_mfma_f32_16x16x32_bf16 v[96:99], v[192:195], a[184:187], v[96:99]
    ds_read_b64_tr_b16 v[178:179], v226 offset:512
    v_mul_f32 v23, v23, v55
    v_mfma_f32_16x16x32_bf16 v[104:107], v[192:195], a[188:191], v[104:107]
    buffer_load_dwordx4 v233, s[12:15], s45 offen  lds
    v_mfma_f32_16x16x32_bf16 v[84:87], v[196:199], a[40:43], v[84:87]
    ds_read_b64_tr_b16 v[180:181], v227 offset:0
    s_add_u32 m0, s40, 12288
    v_mfma_f32_16x16x32_bf16 v[92:95], v[196:199], a[44:47], v[92:95]
    s_add_u32 s45, s36, 4424064
    ds_read_b64_tr_b16 v[182:183], v227 offset:512
    v_mfma_f32_16x16x32_bf16 v[100:103], v[196:199], a[184:187], v[100:103]
    buffer_load_dwordx4 v233, s[16:19], s45 offen  lds
    v_mfma_f32_16x16x32_bf16 v[108:111], v[196:199], a[188:191], v[108:111]
    s_waitcnt lgkmcnt(4)
    v_cvt_pk_bf16_f32 v19, v22, v23
    v_mul_f32 v24, s43, v24
    v_mfma_f32_16x16x32_bf16 v[112:115], v[208:211], a[40:43], v[112:115]
    ds_read_b64_tr_b16 v[192:193], v224 offset:61440
    s_add_u32 m0, s40, 8192
    v_mul_f32 v25, s43, v25
    v_mfma_f32_16x16x32_bf16 v[120:123], v[208:211], a[44:47], v[120:123]
    s_add_u32 s45, s36, 4718976
    ds_read_b64_tr_b16 v[194:195], v224 offset:61952
    v_mul_f32 v26, s43, v26
    v_mfma_f32_16x16x32_bf16 v[128:131], v[208:211], a[184:187], v[128:131]
    buffer_load_dwordx4 v233, s[12:15], s45 offen  lds
    v_mul_f32 v27, s43, v27
    v_mfma_f32_16x16x32_bf16 v[136:139], v[208:211], a[188:191], v[136:139]
    ds_read_b64_tr_b16 v[196:197], v225 offset:61440
    v_mfma_f32_16x16x32_bf16 v[116:119], v[212:215], a[40:43], v[116:119]
    s_add_u32 m0, s40, 4096
    ds_read_b64_tr_b16 v[198:199], v225 offset:61952
    v_exp_f32 v24, v24
    v_mfma_f32_16x16x32_bf16 v[124:127], v[212:215], a[44:47], v[124:127]
    s_add_u32 s45, s36, 4718976
    ds_write_b128 v239, v[16:19] offset:16384
    v_exp_f32 v25, v25
    v_mfma_f32_16x16x32_bf16 v[132:135], v[212:215], a[184:187], v[132:135]
    buffer_load_dwordx4 v233, s[16:19], s45 offen  lds
    v_mfma_f32_16x16x32_bf16 v[140:143], v[212:215], a[188:191], v[140:143]
    s_waitcnt lgkmcnt(5)
    v_exp_f32 v26, v26
    v_mfma_f32_16x16x32_bf16 v[80:83], v[176:179], a[48:51], v[80:83]
    ds_read_b64_tr_b16 v[208:209], v224 offset:57344
    v_add_f32 v24, 1.0, v24
    v_mfma_f32_16x16x32_bf16 v[88:91], v[176:179], a[52:55], v[88:91]
    s_add_u32 m0, s40, 0
    v_exp_f32 v27, v27
    v_mfma_f32_16x16x32_bf16 v[96:99], v[176:179], a[192:195], v[96:99]
    ds_read_b64_tr_b16 v[210:211], v224 offset:57856
    v_add_f32 v25, 1.0, v25
    v_mfma_f32_16x16x32_bf16 v[104:107], v[176:179], a[196:199], v[104:107]
    s_add_u32 s45, s36, 5013888
    v_rcp_f32 v24, v24
    v_mfma_f32_16x16x32_bf16 v[84:87], v[180:183], a[48:51], v[84:87]
    ds_read_b64_tr_b16 v[212:213], v225 offset:57344
    v_add_f32 v26, 1.0, v26
    v_mfma_f32_16x16x32_bf16 v[92:95], v[180:183], a[52:55], v[92:95]
    buffer_load_dwordx4 v233, s[12:15], s45 offen  lds
    v_mfma_f32_16x16x32_bf16 v[100:103], v[180:183], a[192:195], v[100:103]
    ds_read_b64_tr_b16 v[214:215], v225 offset:57856
    v_add_f32 v27, 1.0, v27
    v_mfma_f32_16x16x32_bf16 v[108:111], v[180:183], a[196:199], v[108:111]
    s_waitcnt lgkmcnt(5)
    v_rcp_f32 v25, v25
    v_mfma_f32_16x16x32_bf16 v[112:115], v[192:195], a[48:51], v[112:115]
    ds_read_b64_tr_b16 v[176:177], v224 offset:53248
    v_mul_f32 v24, v24, v56
    v_mfma_f32_16x16x32_bf16 v[120:123], v[192:195], a[52:55], v[120:123]
    v_rcp_f32 v26, v26
    v_mfma_f32_16x16x32_bf16 v[128:131], v[192:195], a[192:195], v[128:131]
    ds_read_b64_tr_b16 v[178:179], v224 offset:53760
    v_mul_f32 v25, v25, v57
    v_mfma_f32_16x16x32_bf16 v[136:139], v[192:195], a[196:199], v[136:139]
    v_rcp_f32 v27, v27
    v_mfma_f32_16x16x32_bf16 v[116:119], v[196:199], a[48:51], v[116:119]
    ds_read_b64_tr_b16 v[180:181], v225 offset:53248
    v_mul_f32 v26, v26, v58
    v_mfma_f32_16x16x32_bf16 v[124:127], v[196:199], a[52:55], v[124:127]
    v_cvt_pk_bf16_f32 v24, v24, v25
    v_mul_f32 v27, v27, v59
    v_mfma_f32_16x16x32_bf16 v[132:135], v[196:199], a[192:195], v[132:135]
    ds_read_b64_tr_b16 v[182:183], v225 offset:53760
    v_cvt_pk_bf16_f32 v25, v26, v27
    v_mfma_f32_16x16x32_bf16 v[140:143], v[196:199], a[196:199], v[140:143]
    s_waitcnt lgkmcnt(4)
    v_mul_f32 v28, s43, v28
    v_mul_f32 v29, s43, v29
    v_mfma_f32_16x16x32_bf16 v[80:83], v[208:211], a[56:59], v[80:83]
    s_waitcnt vmcnt(11)
    s_barrier
    v_mul_f32 v30, s43, v30
    v_mfma_f32_16x16x32_bf16 v[88:91], v[208:211], a[60:63], v[88:91]
    ds_read_b64_tr_b16 v[192:193], v224 offset:49152
    s_add_u32 m0, s40, 81920
    v_mfma_f32_16x16x32_bf16 v[96:99], v[208:211], a[200:203], v[96:99]
    s_add_u32 s45, s36, 5013888
    ds_read_b64_tr_b16 v[194:195], v224 offset:49664
    v_mfma_f32_16x16x32_bf16 v[104:107], v[208:211], a[204:207], v[104:107]
    buffer_load_dwordx4 v233, s[16:19], s45 offen  lds
    v_mfma_f32_16x16x32_bf16 v[84:87], v[212:215], a[56:59], v[84:87]
    ds_read_b64_tr_b16 v[196:197], v225 offset:49152
    s_add_u32 m0, s40, 77824
    v_mfma_f32_16x16x32_bf16 v[92:95], v[212:215], a[60:63], v[92:95]
    s_add_u32 s45, s37, 0
    ds_read_b64_tr_b16 v[198:199], v225 offset:49664
    v_mfma_f32_16x16x32_bf16 v[100:103], v[212:215], a[200:203], v[100:103]
    buffer_load_dwordx4 v234, s[12:15], s45 offen  lds
    v_mfma_f32_16x16x32_bf16 v[108:111], v[212:215], a[204:207], v[108:111]
    s_waitcnt lgkmcnt(4)
    v_exp_f32 v28, v28
    v_mfma_f32_16x16x32_bf16 v[112:115], v[176:179], a[56:59], v[112:115]
    ds_read_b64_tr_b16 v[208:209], v224 offset:45056
    s_add_u32 m0, s40, 73728
    v_mul_f32 v31, s43, v31
    v_mfma_f32_16x16x32_bf16 v[120:123], v[176:179], a[60:63], v[120:123]
    s_add_u32 s45, s37, 0
    v_exp_f32 v29, v29
    v_mfma_f32_16x16x32_bf16 v[128:131], v[176:179], a[200:203], v[128:131]
    ds_read_b64_tr_b16 v[210:211], v224 offset:45568
    v_add_f32 v28, 1.0, v28
    v_mfma_f32_16x16x32_bf16 v[136:139], v[176:179], a[204:207], v[136:139]
    buffer_load_dwordx4 v234, s[16:19], s45 offen  lds
    v_mfma_f32_16x16x32_bf16 v[116:119], v[180:183], a[56:59], v[116:119]
    ds_read_b64_tr_b16 v[212:213], v225 offset:45056
    s_add_u32 m0, s40, 69632
    v_exp_f32 v30, v30
    v_mfma_f32_16x16x32_bf16 v[124:127], v[180:183], a[60:63], v[124:127]
    s_add_u32 s45, s37, 589824
    ds_read_b64_tr_b16 v[214:215], v225 offset:45568
    v_mfma_f32_16x16x32_bf16 v[132:135], v[180:183], a[200:203], v[132:135]
    buffer_load_dwordx4 v234, s[12:15], s45 offen  lds
    v_add_f32 v29, 1.0, v29
    v_mfma_f32_16x16x32_bf16 v[140:143], v[180:183], a[204:207], v[140:143]
    s_waitcnt lgkmcnt(4)
    v_exp_f32 v31, v31
    v_mfma_f32_16x16x32_bf16 v[80:83], v[192:195], a[64:67], v[80:83]
    ds_read_b64_tr_b16 v[176:177], v224 offset:40960
    s_add_u32 m0, s40, 65536
    v_mfma_f32_16x16x32_bf16 v[88:91], v[192:195], a[68:71], v[88:91]
    s_add_u32 s45, s37, 589824
    v_rcp_f32 v28, v28
    v_mfma_f32_16x16x32_bf16 v[96:99], v[192:195], a[208:211], v[96:99]
    ds_read_b64_tr_b16 v[178:179], v224 offset:41472
    v_add_f32 v30, 1.0, v30
    v_mfma_f32_16x16x32_bf16 v[104:107], v[192:195], a[212:215], v[104:107]
    buffer_load_dwordx4 v234, s[16:19], s45 offen  lds
    v_mfma_f32_16x16x32_bf16 v[84:87], v[196:199], a[64:67], v[84:87]
    ds_read_b64_tr_b16 v[180:181], v225 offset:40960
    s_add_u32 m0, s40, 61440
    v_mfma_f32_16x16x32_bf16 v[92:95], v[196:199], a[68:71], v[92:95]
    s_add_u32 s45, s37, 1179648
    ds_read_b64_tr_b16 v[182:183], v225 offset:41472
    v_mfma_f32_16x16x32_bf16 v[100:103], v[196:199], a[208:211], v[100:103]
    buffer_load_dwordx4 v234, s[12:15], s45 offen  lds
    v_mfma_f32_16x16x32_bf16 v[108:111], v[196:199], a[212:215], v[108:111]
    s_waitcnt lgkmcnt(4)
    v_rcp_f32 v29, v29
    v_mfma_f32_16x16x32_bf16 v[112:115], v[208:211], a[64:67], v[112:115]
    ds_read_b64_tr_b16 v[192:193], v224 offset:36864
    v_add_f32 v31, 1.0, v31
    v_mfma_f32_16x16x32_bf16 v[120:123], v[208:211], a[68:71], v[120:123]
    s_add_u32 m0, s40, 57344
    v_rcp_f32 v30, v30
    v_mfma_f32_16x16x32_bf16 v[128:131], v[208:211], a[208:211], v[128:131]
    ds_read_b64_tr_b16 v[194:195], v224 offset:37376
    v_mul_f32 v28, v28, v60
    v_mfma_f32_16x16x32_bf16 v[136:139], v[208:211], a[212:215], v[136:139]
    s_add_u32 s45, s37, 1179648
    v_rcp_f32 v31, v31
    v_mfma_f32_16x16x32_bf16 v[116:119], v[212:215], a[64:67], v[116:119]
    ds_read_b64_tr_b16 v[196:197], v225 offset:36864
    v_mul_f32 v29, v29, v61
    v_mfma_f32_16x16x32_bf16 v[124:127], v[212:215], a[68:71], v[124:127]
    buffer_load_dwordx4 v234, s[16:19], s45 offen  lds
    v_mfma_f32_16x16x32_bf16 v[132:135], v[212:215], a[208:211], v[132:135]
    ds_read_b64_tr_b16 v[198:199], v225 offset:37376
    v_mul_f32 v30, v30, v62
    v_mfma_f32_16x16x32_bf16 v[140:143], v[212:215], a[212:215], v[140:143]
    s_waitcnt lgkmcnt(4)
    v_cvt_pk_bf16_f32 v26, v28, v29
    v_mul_f32 v31, v31, v63
    v_mfma_f32_16x16x32_bf16 v[80:83], v[176:179], a[72:75], v[80:83]
    ds_read_b64_tr_b16 v[208:209], v224 offset:32768
    v_cvt_pk_bf16_f32 v27, v30, v31
    v_mfma_f32_16x16x32_bf16 v[88:91], v[176:179], a[76:79], v[88:91]
    v_mul_f32 v32, s43, v32
    v_mul_f32 v33, s43, v33
    v_mfma_f32_16x16x32_bf16 v[96:99], v[176:179], a[216:219], v[96:99]
    ds_read_b64_tr_b16 v[210:211], v224 offset:33280
    v_mul_f32 v34, s43, v34
    v_mfma_f32_16x16x32_bf16 v[104:107], v[176:179], a[220:223], v[104:107]
    v_exp_f32 v32, v32
    v_mfma_f32_16x16x32_bf16 v[84:87], v[180:183], a[72:75], v[84:87]
    ds_read_b64_tr_b16 v[212:213], v225 offset:32768
    v_mul_f32 v35, s43, v35
    v_mfma_f32_16x16x32_bf16 v[92:95], v[180:183], a[76:79], v[92:95]
    v_exp_f32 v33, v33
    v_mfma_f32_16x16x32_bf16 v[100:103], v[180:183], a[216:219], v[100:103]
    ds_read_b64_tr_b16 v[214:215], v225 offset:33280
    v_add_f32 v32, 1.0, v32
    v_mfma_f32_16x16x32_bf16 v[108:111], v[180:183], a[220:223], v[108:111]
    s_waitcnt lgkmcnt(4)
    v_exp_f32 v34, v34
    v_mfma_f32_16x16x32_bf16 v[112:115], v[192:195], a[72:75], v[112:115]
    ds_read_b64_tr_b16 v[176:177], v224 offset:28672
    v_add_f32 v33, 1.0, v33
    v_mfma_f32_16x16x32_bf16 v[120:123], v[192:195], a[76:79], v[120:123]
    v_exp_f32 v35, v35
    v_mfma_f32_16x16x32_bf16 v[128:131], v[192:195], a[216:219], v[128:131]
    ds_read_b64_tr_b16 v[178:179], v224 offset:29184
    v_add_f32 v34, 1.0, v34
    v_mfma_f32_16x16x32_bf16 v[136:139], v[192:195], a[220:223], v[136:139]
    ds_read_b64_tr_b16 v[180:181], v225 offset:28672
    v_add_f32 v35, 1.0, v35
    v_mfma_f32_16x16x32_bf16 v[116:119], v[196:199], a[72:75], v[116:119]
    ds_read_b64_tr_b16 v[182:183], v225 offset:29184
    v_mfma_f32_16x16x32_bf16 v[124:127], v[196:199], a[76:79], v[124:127]
    v_rcp_f32 v32, v32
    v_mfma_f32_16x16x32_bf16 v[132:135], v[196:199], a[216:219], v[132:135]
    ds_write_b128 v239, v[24:27] offset:17408
    v_mul_f32 v32, v32, v64
    v_mfma_f32_16x16x32_bf16 v[140:143], v[196:199], a[220:223], v[140:143]
    s_waitcnt lgkmcnt(5)
    v_rcp_f32 v33, v33
    v_mfma_f32_16x16x32_bf16 v[80:83], v[208:211], a[80:83], v[80:83]
    ds_read_b64_tr_b16 v[192:193], v226 offset:40960
    v_mul_f32 v33, v33, v65
    v_mfma_f32_16x16x32_bf16 v[88:91], v[208:211], a[84:87], v[88:91]
    v_rcp_f32 v34, v34
    v_mfma_f32_16x16x32_bf16 v[96:99], v[208:211], a[224:227], v[96:99]
    ds_read_b64_tr_b16 v[194:195], v226 offset:41472
    v_mul_f32 v34, v34, v66
    v_mfma_f32_16x16x32_bf16 v[104:107], v[208:211], a[228:231], v[104:107]
    v_rcp_f32 v35, v35
    v_mfma_f32_16x16x32_bf16 v[84:87], v[212:215], a[80:83], v[84:87]
    ds_read_b64_tr_b16 v[196:197], v227 offset:40960
    v_cvt_pk_bf16_f32 v32, v32, v33
    v_mfma_f32_16x16x32_bf16 v[92:95], v[212:215], a[84:87], v[92:95]
    v_mul_f32 v35, v35, v67
    v_cvt_pk_bf16_f32 v33, v34, v35
    v_mfma_f32_16x16x32_bf16 v[100:103], v[212:215], a[224:227], v[100:103]
    ds_read_b64_tr_b16 v[198:199], v227 offset:41472
    v_mul_f32 v36, s43, v36
    v_mfma_f32_16x16x32_bf16 v[108:111], v[212:215], a[228:231], v[108:111]
    s_waitcnt lgkmcnt(5)
    v_exp_f32 v36, v36
    v_mfma_f32_16x16x32_bf16 v[112:115], v[176:179], a[80:83], v[112:115]
    ds_read_b64_tr_b16 v[208:209], v226 offset:36864
    v_mul_f32 v37, s43, v37
    v_mfma_f32_16x16x32_bf16 v[120:123], v[176:179], a[84:87], v[120:123]
    v_exp_f32 v37, v37
    v_mfma_f32_16x16x32_bf16 v[128:131], v[176:179], a[224:227], v[128:131]
    ds_read_b64_tr_b16 v[210:211], v226 offset:37376
    v_mul_f32 v38, s43, v38
    v_mfma_f32_16x16x32_bf16 v[136:139], v[176:179], a[228:231], v[136:139]
    v_exp_f32 v38, v38
    v_mfma_f32_16x16x32_bf16 v[116:119], v[180:183], a[80:83], v[116:119]
    ds_read_b64_tr_b16 v[212:213], v227 offset:36864
    v_mul_f32 v39, s43, v39
    v_mfma_f32_16x16x32_bf16 v[124:127], v[180:183], a[84:87], v[124:127]
    v_exp_f32 v39, v39
    v_mfma_f32_16x16x32_bf16 v[132:135], v[180:183], a[224:227], v[132:135]
    ds_read_b64_tr_b16 v[214:215], v227 offset:37376
    v_add_f32 v36, 1.0, v36
    v_mfma_f32_16x16x32_bf16 v[140:143], v[180:183], a[228:231], v[140:143]
    s_waitcnt lgkmcnt(4)
    v_rcp_f32 v36, v36
    v_mfma_f32_16x16x32_bf16 v[80:83], v[192:195], a[88:91], v[80:83]
    s_waitcnt vmcnt(10)
    s_barrier
    v_add_f32 v37, 1.0, v37
    v_mfma_f32_16x16x32_bf16 v[88:91], v[192:195], a[92:95], v[88:91]
    ds_read_b64_tr_b16 v[176:177], v226 offset:32768
    s_add_u32 m0, s40, 53248
    v_mfma_f32_16x16x32_bf16 v[96:99], v[192:195], a[232:235], v[96:99]
    s_add_u32 s45, s37, 1769472
    ds_read_b64_tr_b16 v[178:179], v226 offset:33280
    v_mfma_f32_16x16x32_bf16 v[104:107], v[192:195], a[236:239], v[104:107]
    buffer_load_dwordx4 v234, s[12:15], s45 offen  lds
    v_mfma_f32_16x16x32_bf16 v[84:87], v[196:199], a[88:91], v[84:87]
    ds_read_b64_tr_b16 v[180:181], v227 offset:32768
    s_add_u32 m0, s40, 49152
    v_mfma_f32_16x16x32_bf16 v[92:95], v[196:199], a[92:95], v[92:95]
    s_add_u32 s45, s37, 1769472
    ds_read_b64_tr_b16 v[182:183], v227 offset:33280
    v_mfma_f32_16x16x32_bf16 v[100:103], v[196:199], a[232:235], v[100:103]
    buffer_load_dwordx4 v234, s[16:19], s45 offen  lds
    v_mfma_f32_16x16x32_bf16 v[108:111], v[196:199], a[236:239], v[108:111]
    s_waitcnt lgkmcnt(4)
    v_rcp_f32 v37, v37
    v_mfma_f32_16x16x32_bf16 v[112:115], v[208:211], a[88:91], v[112:115]
    ds_read_b64_tr_b16 v[192:193], v226 offset:28672
    s_add_u32 m0, s40, 45056
    v_mfma_f32_16x16x32_bf16 v[120:123], v[208:211], a[92:95], v[120:123]
    s_add_u32 s45, s37, 2359296
    v_add_f32 v38, 1.0, v38
    v_add_f32 v39, 1.0, v39
    v_mfma_f32_16x16x32_bf16 v[128:131], v[208:211], a[232:235], v[128:131]
    ds_read_b64_tr_b16 v[194:195], v226 offset:29184
    v_mul_f32 v36, v36, v68
    v_mfma_f32_16x16x32_bf16 v[136:139], v[208:211], a[236:239], v[136:139]
    buffer_load_dwordx4 v234, s[12:15], s45 offen  lds
    v_mfma_f32_16x16x32_bf16 v[116:119], v[212:215], a[88:91], v[116:119]
    ds_read_b64_tr_b16 v[196:197], v227 offset:28672
    s_add_u32 m0, s40, 40960
    v_mfma_f32_16x16x32_bf16 v[124:127], v[212:215], a[92:95], v[124:127]
    s_add_u32 s45, s37, 2359296
    ds_read_b64_tr_b16 v[198:199], v227 offset:29184
    v_mfma_f32_16x16x32_bf16 v[132:135], v[212:215], a[232:235], v[132:135]
    buffer_load_dwordx4 v234, s[16:19], s45 offen  lds
    v_mfma_f32_16x16x32_bf16 v[140:143], v[212:215], a[236:239], v[140:143]
    s_waitcnt lgkmcnt(4)
    v_rcp_f32 v38, v38
    v_mfma_f32_16x16x32_bf16 v[80:83], v[176:179], a[96:99], v[80:83]
    ds_read_b64_tr_b16 v[208:209], v226 offset:24576
    s_add_u32 m0, s40, 36864
    v_mfma_f32_16x16x32_bf16 v[88:91], v[176:179], a[100:103], v[88:91]
    s_add_u32 s45, s37, 2949120
    v_rcp_f32 v39, v39
    v_mfma_f32_16x16x32_bf16 v[96:99], v[176:179], a[240:243], v[96:99]
    ds_read_b64_tr_b16 v[210:211], v226 offset:25088
    v_mul_f32 v37, v37, v69
    v_mfma_f32_16x16x32_bf16 v[104:107], v[176:179], a[244:247], v[104:107]
    buffer_load_dwordx4 v234, s[12:15], s45 offen  lds
    v_mfma_f32_16x16x32_bf16 v[84:87], v[180:183], a[96:99], v[84:87]
    ds_read_b64_tr_b16 v[212:213], v227 offset:24576
    s_add_u32 m0, s40, 32768
    v_mfma_f32_16x16x32_bf16 v[92:95], v[180:183], a[100:103], v[92:95]
    s_add_u32 s45, s37, 2949120
    ds_read_b64_tr_b16 v[214:215], v227 offset:25088
    v_mfma_f32_16x16x32_bf16 v[100:103], v[180:183], a[240:243], v[100:103]
    buffer_load_dwordx4 v234, s[16:19], s45 offen  lds
    v_mfma_f32_16x16x32_bf16 v[108:111], v[180:183], a[244:247], v[108:111]
    s_waitcnt lgkmcnt(4)
    v_mul_f32 v38, v38, v70
    v_cvt_pk_bf16_f32 v34, v36, v37
    v_mfma_f32_16x16x32_bf16 v[112:115], v[192:195], a[96:99], v[112:115]
    ds_read_b64_tr_b16 v[176:177], v226 offset:20480
    v_mul_f32 v39, v39, v71
    v_mfma_f32_16x16x32_bf16 v[120:123], v[192:195], a[100:103], v[120:123]
    s_add_u32 m0, s40, 28672
    v_cvt_pk_bf16_f32 v35, v38, v39
    v_mul_f32 v40, s43, v40
    v_mfma_f32_16x16x32_bf16 v[128:131], v[192:195], a[240:243], v[128:131]
    ds_read_b64_tr_b16 v[178:179], v226 offset:20992
    v_mul_f32 v41, s43, v41
    v_mfma_f32_16x16x32_bf16 v[136:139], v[192:195], a[244:247], v[136:139]
    s_add_u32 s45, s37, 3538944
    v_exp_f32 v40, v40
    v_mfma_f32_16x16x32_bf16 v[116:119], v[196:199], a[96:99], v[116:119]
    ds_read_b64_tr_b16 v[180:181], v227 offset:20480
    v_mul_f32 v42, s43, v42
    v_mfma_f32_16x16x32_bf16 v[124:127], v[196:199], a[100:103], v[124:127]
    buffer_load_dwordx4 v234, s[12:15], s45 offen  lds
    v_mfma_f32_16x16x32_bf16 v[132:135], v[196:199], a[240:243], v[132:135]
    ds_read_b64_tr_b16 v[182:183], v227 offset:20992
    v_mul_f32 v43, s43, v43
    v_mfma_f32_16x16x32_bf16 v[140:143], v[196:199], a[244:247], v[140:143]
    s_waitcnt lgkmcnt(4)
    v_exp_f32 v41, v41
    v_mfma_f32_16x16x32_bf16 v[80:83], v[208:211], a[104:107], v[80:83]
    ds_read_b64_tr_b16 v[192:193], v224 offset:24576
    v_add_f32 v40, 1.0, v40
    v_mfma_f32_16x16x32_bf16 v[88:91], v[208:211], a[108:111], v[88:91]
    v_exp_f32 v42, v42
    v_mfma_f32_16x16x32_bf16 v[96:99], v[208:211], a[248:251], v[96:99]
    ds_read_b64_tr_b16 v[194:195], v224 offset:25088
    v_add_f32 v41, 1.0, v41
    v_mfma_f32_16x16x32_bf16 v[104:107], v[208:211], a[252:255], v[104:107]
    ds_read_b64_tr_b16 v[196:197], v225 offset:24576
    v_add_f32 v42, 1.0, v42
    v_mfma_f32_16x16x32_bf16 v[84:87], v[212:215], a[104:107], v[84:87]
    ds_read_b64_tr_b16 v[198:199], v225 offset:25088
    v_mfma_f32_16x16x32_bf16 v[92:95], v[212:215], a[108:111], v[92:95]
    v_exp_f32 v43, v43
    v_mfma_f32_16x16x32_bf16 v[100:103], v[212:215], a[248:251], v[100:103]
    ds_write_b128 v240, v[32:35] offset:16384
    v_add_f32 v43, 1.0, v43
    v_mfma_f32_16x16x32_bf16 v[108:111], v[212:215], a[252:255], v[108:111]
    s_waitcnt lgkmcnt(5)
    v_rcp_f32 v40, v40
    v_mfma_f32_16x16x32_bf16 v[112:115], v[176:179], a[104:107], v[112:115]
    ds_read_b64_tr_b16 v[208:209], v224 offset:20480
    v_mul_f32 v40, v40, v72
    v_mfma_f32_16x16x32_bf16 v[120:123], v[176:179], a[108:111], v[120:123]
    v_rcp_f32 v41, v41
    v_mfma_f32_16x16x32_bf16 v[128:131], v[176:179], a[248:251], v[128:131]
    ds_read_b64_tr_b16 v[210:211], v224 offset:20992
    v_mul_f32 v41, v41, v73
    v_mfma_f32_16x16x32_bf16 v[136:139], v[176:179], a[252:255], v[136:139]
    v_rcp_f32 v42, v42
    v_mfma_f32_16x16x32_bf16 v[116:119], v[180:183], a[104:107], v[116:119]
    ds_read_b64_tr_b16 v[212:213], v225 offset:20480
    v_mul_f32 v42, v42, v74
    v_mfma_f32_16x16x32_bf16 v[124:127], v[180:183], a[108:111], v[124:127]
    v_rcp_f32 v43, v43
    v_mfma_f32_16x16x32_bf16 v[132:135], v[180:183], a[248:251], v[132:135]
    ds_read_b64_tr_b16 v[214:215], v225 offset:20992
    v_cvt_pk_bf16_f32 v40, v40, v41
    v_mfma_f32_16x16x32_bf16 v[140:143], v[180:183], a[252:255], v[140:143]
    s_waitcnt lgkmcnt(5)
    v_mul_f32 v43, v43, v75
    v_cvt_pk_bf16_f32 v41, v42, v43
    v_mfma_f32_16x16x32_bf16 v[80:83], v[192:195], a[112:115], v[80:83]
    ds_read_b64_tr_b16 v[176:177], v224 offset:16384
    v_mul_f32 v44, s43, v44
    v_mfma_f32_16x16x32_bf16 v[88:91], v[192:195], a[116:119], v[88:91]
    v_exp_f32 v44, v44
    v_mfma_f32_16x16x32_bf16 v[96:99], v[192:195], v[144:147], v[96:99]
    ds_read_b64_tr_b16 v[178:179], v224 offset:16896
    v_mul_f32 v45, s43, v45
    v_mfma_f32_16x16x32_bf16 v[104:107], v[192:195], v[148:151], v[104:107]
    v_exp_f32 v45, v45
    v_mfma_f32_16x16x32_bf16 v[84:87], v[196:199], a[112:115], v[84:87]
    ds_read_b64_tr_b16 v[180:181], v225 offset:16384
    v_mul_f32 v46, s43, v46
    v_mfma_f32_16x16x32_bf16 v[92:95], v[196:199], a[116:119], v[92:95]
    v_exp_f32 v46, v46
    v_mfma_f32_16x16x32_bf16 v[100:103], v[196:199], v[144:147], v[100:103]
    ds_read_b64_tr_b16 v[182:183], v225 offset:16896
    v_mul_f32 v47, s43, v47
    v_mfma_f32_16x16x32_bf16 v[108:111], v[196:199], v[148:151], v[108:111]
    s_waitcnt lgkmcnt(4)
    v_exp_f32 v47, v47
    v_mfma_f32_16x16x32_bf16 v[112:115], v[208:211], a[112:115], v[112:115]
    ds_read_b64_tr_b16 v[192:193], v224 offset:12288
    v_add_f32 v44, 1.0, v44
    v_mfma_f32_16x16x32_bf16 v[120:123], v[208:211], a[116:119], v[120:123]
    v_rcp_f32 v44, v44
    v_mfma_f32_16x16x32_bf16 v[128:131], v[208:211], v[144:147], v[128:131]
    ds_read_b64_tr_b16 v[194:195], v224 offset:12800
    v_add_f32 v45, 1.0, v45
    v_mfma_f32_16x16x32_bf16 v[136:139], v[208:211], v[148:151], v[136:139]
    v_rcp_f32 v45, v45
    v_mfma_f32_16x16x32_bf16 v[116:119], v[212:215], a[112:115], v[116:119]
    ds_read_b64_tr_b16 v[196:197], v225 offset:12288
    v_add_f32 v46, 1.0, v46
    v_mfma_f32_16x16x32_bf16 v[124:127], v[212:215], a[116:119], v[124:127]
    v_rcp_f32 v46, v46
    v_mfma_f32_16x16x32_bf16 v[132:135], v[212:215], v[144:147], v[132:135]
    ds_read_b64_tr_b16 v[198:199], v225 offset:12800
    v_add_f32 v47, 1.0, v47
    v_mfma_f32_16x16x32_bf16 v[140:143], v[212:215], v[148:151], v[140:143]
    s_waitcnt lgkmcnt(4)
    v_rcp_f32 v47, v47
    v_mfma_f32_16x16x32_bf16 v[80:83], v[176:179], a[120:123], v[80:83]
    s_waitcnt vmcnt(9)
    s_barrier
    v_mul_f32 v44, v44, v76
    v_mfma_f32_16x16x32_bf16 v[88:91], v[176:179], a[124:127], v[88:91]
    ds_read_b64_tr_b16 v[208:209], v224 offset:8192
    s_add_u32 m0, s40, 86016
    v_mfma_f32_16x16x32_bf16 v[96:99], v[176:179], v[152:155], v[96:99]
    s_add_u32 s45, s37, 3538944
    ds_read_b64_tr_b16 v[210:211], v224 offset:8704
    v_mfma_f32_16x16x32_bf16 v[104:107], v[176:179], v[156:159], v[104:107]
    buffer_load_dwordx4 v234, s[16:19], s45 offen  lds
    v_mfma_f32_16x16x32_bf16 v[84:87], v[180:183], a[120:123], v[84:87]
    ds_read_b64_tr_b16 v[212:213], v225 offset:8192
    s_add_u32 m0, s40, 24576
    v_mfma_f32_16x16x32_bf16 v[92:95], v[180:183], a[124:127], v[92:95]
    s_add_u32 s45, s37, 4128768
    ds_read_b64_tr_b16 v[214:215], v225 offset:8704
    v_mfma_f32_16x16x32_bf16 v[100:103], v[180:183], v[152:155], v[100:103]
    buffer_load_dwordx4 v234, s[12:15], s45 offen  lds
    v_mfma_f32_16x16x32_bf16 v[108:111], v[180:183], v[156:159], v[108:111]
    s_waitcnt lgkmcnt(4)
    v_mul_f32 v45, v45, v77
    v_mul_f32 v46, v46, v78
    v_mfma_f32_16x16x32_bf16 v[112:115], v[192:195], a[120:123], v[112:115]
    ds_read_b64_tr_b16 v[176:177], v224 offset:4096
    s_add_u32 m0, s40, 20480
    v_mfma_f32_16x16x32_bf16 v[120:123], v[192:195], a[124:127], v[120:123]
    s_add_u32 s45, s37, 4128768
    v_cvt_pk_bf16_f32 v42, v44, v45
    v_mul_f32 v47, v47, v79
    v_mfma_f32_16x16x32_bf16 v[128:131], v[192:195], v[152:155], v[128:131]
    ds_read_b64_tr_b16 v[178:179], v224 offset:4608
    v_cvt_pk_bf16_f32 v43, v46, v47
    v_mfma_f32_16x16x32_bf16 v[136:139], v[192:195], v[156:159], v[136:139]
    buffer_load_dwordx4 v234, s[16:19], s45 offen  lds
    v_mfma_f32_16x16x32_bf16 v[116:119], v[196:199], a[120:123], v[116:119]
    ds_read_b64_tr_b16 v[180:181], v225 offset:4096
    s_add_u32 m0, s40, 16384
    v_mfma_f32_16x16x32_bf16 v[124:127], v[196:199], a[124:127], v[124:127]
    s_add_u32 s45, s37, 4718592
    ds_read_b64_tr_b16 v[182:183], v225 offset:4608
    v_mfma_f32_16x16x32_bf16 v[132:135], v[196:199], v[152:155], v[132:135]
    buffer_load_dwordx4 v234, s[12:15], s45 offen  lds
    v_mfma_f32_16x16x32_bf16 v[140:143], v[196:199], v[156:159], v[140:143]
    s_waitcnt lgkmcnt(4)
    v_mfma_f32_16x16x32_bf16 v[80:83], v[208:211], a[128:131], v[80:83]
    ds_read_b64_tr_b16 v[192:193], v224 offset:0
    v_mfma_f32_16x16x32_bf16 v[88:91], v[208:211], a[132:135], v[88:91]
    v_mfma_f32_16x16x32_bf16 v[96:99], v[208:211], v[160:163], v[96:99]
    ds_read_b64_tr_b16 v[194:195], v224 offset:512
    v_mfma_f32_16x16x32_bf16 v[104:107], v[208:211], v[164:167], v[104:107]
    ds_read_b64_tr_b16 v[196:197], v225 offset:0
    v_mfma_f32_16x16x32_bf16 v[84:87], v[212:215], a[128:131], v[84:87]
    ds_read_b64_tr_b16 v[198:199], v225 offset:512
    v_mfma_f32_16x16x32_bf16 v[92:95], v[212:215], a[132:135], v[92:95]
    v_mfma_f32_16x16x32_bf16 v[100:103], v[212:215], v[160:163], v[100:103]
    ds_write_b128 v240, v[40:43] offset:17408
    v_mfma_f32_16x16x32_bf16 v[108:111], v[212:215], v[164:167], v[108:111]
    s_waitcnt lgkmcnt(5)
    v_mfma_f32_16x16x32_bf16 v[112:115], v[176:179], a[128:131], v[112:115]
    ds_read_b64_tr_b16 v[208:209], v226 offset:16384
    v_mfma_f32_16x16x32_bf16 v[120:123], v[176:179], a[132:135], v[120:123]
    v_mfma_f32_16x16x32_bf16 v[128:131], v[176:179], v[160:163], v[128:131]
    ds_read_b64_tr_b16 v[210:211], v226 offset:16896
    v_mfma_f32_16x16x32_bf16 v[136:139], v[176:179], v[164:167], v[136:139]
    v_mfma_f32_16x16x32_bf16 v[116:119], v[180:183], a[128:131], v[116:119]
    ds_read_b64_tr_b16 v[212:213], v227 offset:16384
    v_mfma_f32_16x16x32_bf16 v[124:127], v[180:183], a[132:135], v[124:127]
    v_mfma_f32_16x16x32_bf16 v[132:135], v[180:183], v[160:163], v[132:135]
    ds_read_b64_tr_b16 v[214:215], v227 offset:16896
    v_mfma_f32_16x16x32_bf16 v[140:143], v[180:183], v[164:167], v[140:143]
    s_waitcnt lgkmcnt(5)
    v_mfma_f32_16x16x32_bf16 v[80:83], v[192:195], a[136:139], v[80:83]
    ds_read_b64_tr_b16 v[176:177], v232 offset:12288
    v_mfma_f32_16x16x32_bf16 v[88:91], v[192:195], a[140:143], v[88:91]
    v_mfma_f32_16x16x32_bf16 v[96:99], v[192:195], v[168:171], v[96:99]
    ds_read_b64_tr_b16 v[178:179], v232 offset:12544
    v_mfma_f32_16x16x32_bf16 v[104:107], v[192:195], v[172:175], v[104:107]
    v_mfma_f32_16x16x32_bf16 v[84:87], v[196:199], a[136:139], v[84:87]
    ds_read_b64_tr_b16 v[180:181], v232 offset:14336
    v_mfma_f32_16x16x32_bf16 v[92:95], v[196:199], a[140:143], v[92:95]
    v_mfma_f32_16x16x32_bf16 v[100:103], v[196:199], v[168:171], v[100:103]
    ds_read_b64_tr_b16 v[182:183], v232 offset:14592
    v_mfma_f32_16x16x32_bf16 v[108:111], v[196:199], v[172:175], v[108:111]
    s_waitcnt lgkmcnt(4)
    v_mfma_f32_16x16x32_bf16 v[112:115], v[208:211], a[136:139], v[112:115]
    ds_read_b64_tr_b16 v[192:193], v232 offset:8192
    v_mfma_f32_16x16x32_bf16 v[120:123], v[208:211], a[140:143], v[120:123]
    v_mfma_f32_16x16x32_bf16 v[128:131], v[208:211], v[168:171], v[128:131]
    ds_read_b64_tr_b16 v[194:195], v232 offset:8448
    v_mfma_f32_16x16x32_bf16 v[136:139], v[208:211], v[172:175], v[136:139]
    v_mfma_f32_16x16x32_bf16 v[116:119], v[212:215], a[136:139], v[116:119]
    ds_read_b64_tr_b16 v[196:197], v232 offset:10240
    v_mfma_f32_16x16x32_bf16 v[124:127], v[212:215], a[140:143], v[124:127]
    v_mfma_f32_16x16x32_bf16 v[132:135], v[212:215], v[168:171], v[132:135]
    ds_read_b64_tr_b16 v[198:199], v232 offset:10496
    v_mfma_f32_16x16x32_bf16 v[140:143], v[212:215], v[172:175], v[140:143]
    s_waitcnt lgkmcnt(4)
    v_mfma_f32_16x16x32_bf16 v[16:19], v[176:179], a[0:3], 0
    ds_read_b64_tr_b16 v[208:209], v232 offset:4096
    v_mfma_f32_16x16x32_bf16 v[20:23], v[176:179], a[4:7], 0
    v_mfma_f32_16x16x32_bf16 v[24:27], v[176:179], a[144:147], 0
    ds_read_b64_tr_b16 v[210:211], v232 offset:4352
    v_mfma_f32_16x16x32_bf16 v[28:31], v[176:179], a[148:151], 0
    v_mfma_f32_16x16x32_bf16 v[16:19], v[180:183], a[8:11], v[16:19]
    ds_read_b64_tr_b16 v[212:213], v232 offset:6144
    v_mfma_f32_16x16x32_bf16 v[20:23], v[180:183], a[12:15], v[20:23]
    v_mfma_f32_16x16x32_bf16 v[24:27], v[180:183], a[152:155], v[24:27]
    ds_read_b64_tr_b16 v[214:215], v232 offset:6400
    v_mfma_f32_16x16x32_bf16 v[28:31], v[180:183], a[156:159], v[28:31]
    s_waitcnt lgkmcnt(4)
    v_mfma_f32_16x16x32_bf16 v[48:51], v[192:195], a[0:3], 0
    ds_read_b64_tr_b16 v[176:177], v232 offset:0
    v_mul_f32 v80, s43, v80
    v_mul_f32 v81, s43, v81
    v_mul_f32 v82, s43, v82
    v_mul_f32 v83, s43, v83
    v_exp_f32 v80, v80
    v_exp_f32 v81, v81
    v_add_f32 v80, 1.0, v80
    v_mfma_f32_16x16x32_bf16 v[52:55], v[192:195], a[4:7], 0
    v_exp_f32 v82, v82
    v_mfma_f32_16x16x32_bf16 v[56:59], v[192:195], a[144:147], 0
    ds_read_b64_tr_b16 v[178:179], v232 offset:256
    v_add_f32 v81, 1.0, v81
    v_mfma_f32_16x16x32_bf16 v[60:63], v[192:195], a[148:151], 0
    v_exp_f32 v83, v83
    v_mfma_f32_16x16x32_bf16 v[48:51], v[196:199], a[8:11], v[48:51]
    ds_read_b64_tr_b16 v[180:181], v232 offset:2048
    v_add_f32 v82, 1.0, v82
    v_mfma_f32_16x16x32_bf16 v[52:55], v[196:199], a[12:15], v[52:55]
    v_rcp_f32 v80, v80
    v_mfma_f32_16x16x32_bf16 v[56:59], v[196:199], a[152:155], v[56:59]
    ds_read_b64_tr_b16 v[182:183], v232 offset:2304
    v_add_f32 v83, 1.0, v83
    v_mfma_f32_16x16x32_bf16 v[60:63], v[196:199], a[156:159], v[60:63]
    s_waitcnt lgkmcnt(4)
    v_rcp_f32 v81, v81
    v_mfma_f32_16x16x32_bf16 v[16:19], v[208:211], a[16:19], v[16:19]
    s_waitcnt vmcnt(5)
    s_barrier
    ds_read_b64_tr_b16 v[192:193], v230 offset:61440
    v_mul_f32 v80, v80, v112
    v_rcp_f32 v82, v82
    v_mul_f32 v81, v81, v113
    v_rcp_f32 v83, v83
    v_mul_f32 v82, v82, v114
    v_cvt_pk_bf16_f32 v80, v80, v81
    v_mul_f32 v83, v83, v115
    v_mfma_f32_16x16x32_bf16 v[20:23], v[208:211], a[20:23], v[20:23]
    s_add_u32 m0, s40, 81920
    ds_read_b64_tr_b16 v[194:195], v230 offset:61696
    v_cvt_pk_bf16_f32 v81, v82, v83
    v_mfma_f32_16x16x32_bf16 v[24:27], v[208:211], a[160:163], v[24:27]
    s_add_u32 s45, s37, 4718592
    ds_read_b64_tr_b16 v[196:197], v230 offset:63488
    v_mul_f32 v84, s43, v84
    v_mfma_f32_16x16x32_bf16 v[28:31], v[208:211], a[164:167], v[28:31]
    buffer_load_dwordx4 v234, s[16:19], s45 offen  lds
    v_mul_f32 v85, s43, v85
    v_mfma_f32_16x16x32_bf16 v[16:19], v[212:215], a[24:27], v[16:19]
    ds_read_b64_tr_b16 v[198:199], v230 offset:63744
    s_add_u32 m0, s40, 77824
    v_mul_f32 v86, s43, v86
    v_mfma_f32_16x16x32_bf16 v[20:23], v[212:215], a[28:31], v[20:23]
    ds_read_b128 a[0:3], v242 offset:49152
    s_add_u32 s45, s38, 0
    v_mul_f32 v87, s43, v87
    v_mfma_f32_16x16x32_bf16 v[24:27], v[212:215], a[168:171], v[24:27]
    ds_read_b128 a[144:147], v243 offset:49152
    buffer_load_dwordx4 v235, s[20:23], s45 offen  lds
    v_exp_f32 v84, v84
    v_mfma_f32_16x16x32_bf16 v[28:31], v[212:215], a[172:175], v[28:31]
    s_waitcnt lgkmcnt(6)
    v_exp_f32 v85, v85
    v_mfma_f32_16x16x32_bf16 v[48:51], v[176:179], a[16:19], v[48:51]
    ds_read_b64_tr_b16 v[208:209], v230 offset:57344
    s_add_u32 m0, s40, 73728
    v_add_f32 v84, 1.0, v84
    v_exp_f32 v86, v86
    v_add_f32 v85, 1.0, v85
    v_exp_f32 v87, v87
    v_add_f32 v86, 1.0, v86
    v_rcp_f32 v84, v84
    v_mfma_f32_16x16x32_bf16 v[52:55], v[176:179], a[20:23], v[52:55]
    ds_read_b64_tr_b16 v[210:211], v230 offset:57600
    v_add_f32 v87, 1.0, v87
    v_mfma_f32_16x16x32_bf16 v[56:59], v[176:179], a[160:163], v[56:59]
    s_add_u32 s45, s38, 36864
    ds_read_b64_tr_b16 v[212:213], v230 offset:59392
    v_rcp_f32 v85, v85
    v_mfma_f32_16x16x32_bf16 v[60:63], v[176:179], a[164:167], v[60:63]
    buffer_load_dwordx4 v235, s[20:23], s45 offen  lds
    ds_read_b64_tr_b16 v[214:215], v230 offset:59648
    v_mfma_f32_16x16x32_bf16 v[48:51], v[180:183], a[24:27], v[48:51]
    s_add_u32 m0, s40, 69632
    ds_read_b128 a[4:7], v242 offset:50176
    v_mul_f32 v84, v84, v116
    v_mfma_f32_16x16x32_bf16 v[52:55], v[180:183], a[28:31], v[52:55]
    s_add_u32 s45, s38, 73728
    ds_read_b128 a[148:151], v243 offset:50176
    v_rcp_f32 v86, v86
    v_mfma_f32_16x16x32_bf16 v[56:59], v[180:183], a[168:171], v[56:59]
    buffer_load_dwordx4 v235, s[20:23], s45 offen  lds
    v_mfma_f32_16x16x32_bf16 v[60:63], v[180:183], a[172:175], v[60:63]
    s_waitcnt lgkmcnt(8)
    v_rcp_f32 v87, v87
    v_mfma_f32_16x16x32_bf16 v[16:19], v[192:195], a[32:35], v[16:19]
    ds_read_b64_tr_b16 v[176:177], v230 offset:53248
    s_add_u32 m0, s40, 12288
    v_mov_b32 v224, v1
    v_xor_b32 v225, 8, v1
    v_add_u32 v226, 65536, v224
    v_add_u32 v227, 65536, v225
    v_add_u32 v228, 131072, v224
    v_add_u32 v229, 131072, v225
    v_mul_f32 v85, v85, v117
    v_mul_f32 v86, v86, v118
    v_cvt_pk_bf16_f32 v82, v84, v85
    v_mfma_f32_16x16x32_bf16 v[20:23], v[192:195], a[36:39], v[20:23]
    ds_read_b64_tr_b16 v[178:179], v230 offset:53504
    v_mul_f32 v87, v87, v119
    v_mfma_f32_16x16x32_bf16 v[24:27], v[192:195], a[176:179], v[24:27]
    s_add_u32 s45, s38, 110592
    ds_read_b64_tr_b16 v[180:181], v230 offset:55296
    v_cvt_pk_bf16_f32 v83, v86, v87
    v_mfma_f32_16x16x32_bf16 v[28:31], v[192:195], a[180:183], v[28:31]
    buffer_load_dwordx4 v235, s[20:23], s45 offen  lds
    ds_read_b64_tr_b16 v[182:183], v230 offset:55552
    v_mul_f32 v88, s43, v88
    v_mfma_f32_16x16x32_bf16 v[16:19], v[196:199], a[40:43], v[16:19]
    s_add_u32 m0, s40, 8192
    ds_read_b128 a[8:11], v242 offset:51200
    v_mul_f32 v89, s43, v89
    v_mfma_f32_16x16x32_bf16 v[20:23], v[196:199], a[44:47], v[20:23]
    s_add_u32 s45, s38, 147456
    ds_read_b128 a[152:155], v243 offset:51200
    v_mul_f32 v90, s43, v90
    v_mfma_f32_16x16x32_bf16 v[24:27], v[196:199], a[184:187], v[24:27]
    buffer_load_dwordx4 v235, s[20:23], s45 offen  lds
    v_mul_f32 v91, s43, v91
    v_mfma_f32_16x16x32_bf16 v[28:31], v[196:199], a[188:191], v[28:31]
    s_waitcnt lgkmcnt(8)
    v_exp_f32 v88, v88
    v_mfma_f32_16x16x32_bf16 v[48:51], v[208:211], a[32:35], v[48:51]
    ds_read_b64_tr_b16 v[192:193], v230 offset:49152
    s_add_u32 m0, s40, 4096
    v_exp_f32 v89, v89
    v_add_f32 v88, 1.0, v88
    v_exp_f32 v90, v90
    v_add_f32 v89, 1.0, v89
    v_exp_f32 v91, v91
    v_add_f32 v90, 1.0, v90
    v_mfma_f32_16x16x32_bf16 v[52:55], v[208:211], a[36:39], v[52:55]
    ds_read_b64_tr_b16 v[194:195], v230 offset:49408
    s_add_u32 s45, s38, 184320
    v_rcp_f32 v88, v88
    v_mfma_f32_16x16x32_bf16 v[56:59], v[208:211], a[176:179], v[56:59]
    ds_read_b64_tr_b16 v[196:197], v230 offset:51200
    buffer_load_dwordx4 v235, s[20:23], s45 offen  lds
    v_mfma_f32_16x16x32_bf16 v[60:63], v[208:211], a[180:183], v[60:63]
    ds_read_b64_tr_b16 v[198:199], v230 offset:51456
    v_add_f32 v91, 1.0, v91
    v_mfma_f32_16x16x32_bf16 v[48:51], v[212:215], a[40:43], v[48:51]
    s_add_u32 m0, s40, 0
    ds_read_b128 a[12:15], v242 offset:52224
    v_rcp_f32 v89, v89
    v_mfma_f32_16x16x32_bf16 v[52:55], v[212:215], a[44:47], v[52:55]
    s_add_u32 s45, s38, 221184
    ds_read_b128 a[156:159], v243 offset:52224
    v_mfma_f32_16x16x32_bf16 v[56:59], v[212:215], a[184:187], v[56:59]
    buffer_load_dwordx4 v235, s[20:23], s45 offen  lds
    ds_write_b128 v239, v[80:83] offset:0
    v_mul_f32 v88, v88, v120
    v_mfma_f32_16x16x32_bf16 v[60:63], v[212:215], a[188:191], v[60:63]
    s_waitcnt lgkmcnt(9)
    v_rcp_f32 v90, v90
    v_mfma_f32_16x16x32_bf16 v[16:19], v[176:179], a[48:51], v[16:19]
    ds_read_b64_tr_b16 v[208:209], v230 offset:45056
    v_mul_f32 v89, v89, v121
    v_rcp_f32 v91, v91
    v_mul_f32 v90, v90, v122
    v_cvt_pk_bf16_f32 v88, v88, v89
    v_mul_f32 v91, v91, v123
    v_cvt_pk_bf16_f32 v89, v90, v91
    v_mul_f32 v92, s43, v92
    v_mul_f32 v93, s43, v93
    v_mfma_f32_16x16x32_bf16 v[20:23], v[176:179], a[52:55], v[20:23]
    ds_read_b64_tr_b16 v[210:211], v230 offset:45312
    v_mul_f32 v94, s43, v94
    v_mfma_f32_16x16x32_bf16 v[24:27], v[176:179], a[192:195], v[24:27]
    ds_read_b64_tr_b16 v[212:213], v230 offset:47104
    v_mul_f32 v95, s43, v95
    v_mfma_f32_16x16x32_bf16 v[28:31], v[176:179], a[196:199], v[28:31]
    v_exp_f32 v92, v92
    v_mfma_f32_16x16x32_bf16 v[16:19], v[180:183], a[56:59], v[16:19]
    ds_read_b64_tr_b16 v[214:215], v230 offset:47360
    v_add_f32 v92, 1.0, v92
    v_mfma_f32_16x16x32_bf16 v[20:23], v[180:183], a[60:63], v[20:23]
    ds_read_b128 a[16:19], v242 offset:32768
    v_mfma_f32_16x16x32_bf16 v[24:27], v[180:183], a[200:203], v[24:27]
    ds_read_b128 a[160:163], v243 offset:32768
    v_mfma_f32_16x16x32_bf16 v[28:31], v[180:183], a[204:207], v[28:31]
    s_waitcnt lgkmcnt(9)
    v_exp_f32 v93, v93
    v_mfma_f32_16x16x32_bf16 v[48:51], v[192:195], a[48:51], v[48:51]
    ds_read_b64_tr_b16 v[176:177], v230 offset:40960
    v_add_f32 v93, 1.0, v93
    v_exp_f32 v94, v94
    v_exp_f32 v95, v95
    v_add_f32 v94, 1.0, v94
    v_rcp_f32 v92, v92
    v_add_f32 v95, 1.0, v95
    v_mfma_f32_16x16x32_bf16 v[52:55], v[192:195], a[52:55], v[52:55]
    ds_read_b64_tr_b16 v[178:179], v230 offset:41216
    v_mul_f32 v92, v92, v124
    v_mfma_f32_16x16x32_bf16 v[56:59], v[192:195], a[192:195], v[56:59]
    ds_read_b64_tr_b16 v[180:181], v230 offset:43008
    v_mul_f32 v96, s43, v96
    v_mfma_f32_16x16x32_bf16 v[60:63], v[192:195], a[196:199], v[60:63]
    v_rcp_f32 v93, v93
    v_mfma_f32_16x16x32_bf16 v[48:51], v[196:199], a[56:59], v[48:51]
    ds_read_b64_tr_b16 v[182:183], v230 offset:43264
    v_mul_f32 v93, v93, v125
    v_mfma_f32_16x16x32_bf16 v[52:55], v[196:199], a[60:63], v[52:55]
    ds_read_b128 a[20:23], v242 offset:33792
    v_cvt_pk_bf16_f32 v90, v92, v93
    v_mfma_f32_16x16x32_bf16 v[56:59], v[196:199], a[200:203], v[56:59]
    ds_read_b128 a[164:167], v243 offset:33792
    v_mul_f32 v97, s43, v97
    v_mfma_f32_16x16x32_bf16 v[60:63], v[196:199], a[204:207], v[60:63]
    s_waitcnt lgkmcnt(8)
    v_rcp_f32 v94, v94
    v_mfma_f32_16x16x32_bf16 v[16:19], v[208:211], a[64:67], v[16:19]
    ds_read_b64_tr_b16 v[192:193], v230 offset:36864
    v_mul_f32 v94, v94, v126
    v_rcp_f32 v95, v95
    v_mfma_f32_16x16x32_bf16 v[20:23], v[208:211], a[68:71], v[20:23]
    ds_read_b64_tr_b16 v[194:195], v230 offset:37120
    v_mul_f32 v95, v95, v127
    v_cvt_pk_bf16_f32 v91, v94, v95
    v_mul_f32 v98, s43, v98
    v_mul_f32 v99, s43, v99
    v_exp_f32 v96, v96
    v_exp_f32 v97, v97
    v_mfma_f32_16x16x32_bf16 v[24:27], v[208:211], a[208:211], v[24:27]
    ds_read_b64_tr_b16 v[196:197], v230 offset:38912
    v_add_f32 v96, 1.0, v96
    v_mfma_f32_16x16x32_bf16 v[28:31], v[208:211], a[212:215], v[28:31]
    v_exp_f32 v98, v98
    v_mfma_f32_16x16x32_bf16 v[16:19], v[212:215], a[72:75], v[16:19]
    ds_read_b64_tr_b16 v[198:199], v230 offset:39168
    v_add_f32 v97, 1.0, v97
    v_mfma_f32_16x16x32_bf16 v[20:23], v[212:215], a[76:79], v[20:23]
    ds_read_b128 a[24:27], v242 offset:34816
    v_add_f32 v98, 1.0, v98
    v_mfma_f32_16x16x32_bf16 v[24:27], v[212:215], a[216:219], v[24:27]
    ds_read_b128 a[168:171], v243 offset:34816
    v_mfma_f32_16x16x32_bf16 v[28:31], v[212:215], a[220:223], v[28:31]
    s_waitcnt lgkmcnt(8)
    v_exp_f32 v99, v99
    v_mfma_f32_16x16x32_bf16 v[48:51], v[176:179], a[64:67], v[48:51]
    ds_read_b64_tr_b16 v[208:209], v230 offset:32768
    v_add_f32 v99, 1.0, v99
    v_rcp_f32 v96, v96
    v_rcp_f32 v97, v97
    v_mul_f32 v96, v96, v128
    v_rcp_f32 v98, v98
    v_mfma_f32_16x16x32_bf16 v[52:55], v[176:179], a[68:71], v[52:55]
    ds_read_b64_tr_b16 v[210:211], v230 offset:33024
    v_mul_f32 v97, v97, v129
    v_mfma_f32_16x16x32_bf16 v[56:59], v[176:179], a[208:211], v[56:59]
    ds_read_b64_tr_b16 v[212:213], v230 offset:34816
    v_mul_f32 v98, v98, v130
    v_mfma_f32_16x16x32_bf16 v[60:63], v[176:179], a[212:215], v[60:63]
    ds_read_b64_tr_b16 v[214:215], v230 offset:35072
    v_cvt_pk_bf16_f32 v96, v96, v97
    v_mfma_f32_16x16x32_bf16 v[48:51], v[180:183], a[72:75], v[48:51]
    ds_read_b128 a[28:31], v242 offset:35840
    v_mul_f32 v100, s43, v100
    v_mfma_f32_16x16x32_bf16 v[52:55], v[180:183], a[76:79], v[52:55]
    ds_read_b128 a[172:175], v243 offset:35840
    v_mul_f32 v101, s43, v101
    v_mfma_f32_16x16x32_bf16 v[56:59], v[180:183], a[216:219], v[56:59]
    ds_write_b128 v239, v[88:91] offset:1024
    v_mul_f32 v102, s43, v102
    v_mfma_f32_16x16x32_bf16 v[60:63], v[180:183], a[220:223], v[60:63]
    s_waitcnt lgkmcnt(9)
    v_rcp_f32 v99, v99
    v_mfma_f32_16x16x32_bf16 v[16:19], v[192:195], a[80:83], v[16:19]
    s_waitcnt vmcnt(5)
    s_barrier
    ds_read_b64_tr_b16 v[176:177], v230 offset:28672
    v_mul_f32 v99, v99, v131
    v_cvt_pk_bf16_f32 v97, v98, v99
    v_mul_f32 v103, s43, v103
    v_exp_f32 v100, v100
    v_exp_f32 v101, v101
    v_add_f32 v100, 1.0, v100
    v_mfma_f32_16x16x32_bf16 v[20:23], v[192:195], a[84:87], v[20:23]
    s_add_u32 m0, s40, 159744
    ds_read_b64_tr_b16 v[178:179], v230 offset:28928
    v_exp_f32 v102, v102
    v_mfma_f32_16x16x32_bf16 v[24:27], v[192:195], a[224:227], v[24:27]
    s_add_u32 s45, s38, 258048
    ds_read_b64_tr_b16 v[180:181], v230 offset:30720
    v_mfma_f32_16x16x32_bf16 v[28:31], v[192:195], a[228:231], v[28:31]
    buffer_load_dwordx4 v235, s[20:23], s45 offen  lds
    v_add_f32 v101, 1.0, v101
    v_mfma_f32_16x16x32_bf16 v[16:19], v[196:199], a[88:91], v[16:19]
    ds_read_b64_tr_b16 v[182:183], v230 offset:30976
    s_add_u32 m0, s40, 155648
    v_exp_f32 v103, v103
    v_mfma_f32_16x16x32_bf16 v[20:23], v[196:199], a[92:95], v[20:23]
    ds_read_b128 a[32:35], v242 offset:16384
    s_add_u32 s45, s39, 0
    v_mfma_f32_16x16x32_bf16 v[24:27], v[196:199], a[232:235], v[24:27]
    ds_read_b128 a[176:179], v243 offset:16384
    buffer_load_dwordx4 v235, s[20:23], s45 offen  lds
    v_add_f32 v102, 1.0, v102
    v_mfma_f32_16x16x32_bf16 v[28:31], v[196:199], a[236:239], v[28:31]
    s_waitcnt lgkmcnt(9)
    v_rcp_f32 v100, v100
    v_mfma_f32_16x16x32_bf16 v[48:51], v[208:211], a[80:83], v[48:51]
    ds_read_b64_tr_b16 v[192:193], v232 offset:20480
    s_add_u32 m0, s40, 151552
    v_add_f32 v103, 1.0, v103
    v_rcp_f32 v101, v101
    v_mul_f32 v100, v100, v132
    v_rcp_f32 v102, v102
    v_mul_f32 v101, v101, v133
    v_rcp_f32 v103, v103
    v_mfma_f32_16x16x32_bf16 v[52:55], v[208:211], a[84:87], v[52:55]
    ds_read_b64_tr_b16 v[194:195], v232 offset:20736
    v_mul_f32 v102, v102, v134
    v_mfma_f32_16x16x32_bf16 v[56:59], v[208:211], a[224:227], v[56:59]
    s_add_u32 s45, s38, 128
    ds_read_b64_tr_b16 v[196:197], v232 offset:22528
    v_mfma_f32_16x16x32_bf16 v[60:63], v[208:211], a[228:231], v[60:63]
    buffer_load_dwordx4 v235, s[20:23], s45 offen  lds
    ds_read_b64_tr_b16 v[198:199], v232 offset:22784
    v_cvt_pk_bf16_f32 v98, v100, v101
    v_mfma_f32_16x16x32_bf16 v[48:51], v[212:215], a[88:91], v[48:51]
    s_add_u32 m0, s40, 147456
    ds_read_b128 a[36:39], v242 offset:17408
    v_mul_f32 v103, v103, v135
    v_mfma_f32_16x16x32_bf16 v[52:55], v[212:215], a[92:95], v[52:55]
    s_add_u32 s45, s38, 36992
    ds_read_b128 a[180:183], v243 offset:17408
    v_cvt_pk_bf16_f32 v99, v102, v103
    v_mfma_f32_16x16x32_bf16 v[56:59], v[212:215], a[232:235], v[56:59]
    buffer_load_dwordx4 v235, s[20:23], s45 offen  lds
    v_mul_f32 v104, s43, v104
    v_mfma_f32_16x16x32_bf16 v[60:63], v[212:215], a[236:239], v[60:63]
    s_waitcnt lgkmcnt(8)
    v_exp_f32 v104, v104
    v_mfma_f32_16x16x32_bf16 v[16:19], v[176:179], a[96:99], v[16:19]
    ds_read_b64_tr_b16 v[208:209], v230 offset:24576
    s_add_u32 m0, s40, 65536
    v_mul_f32 v105, s43, v105
    v_mul_f32 v106, s43, v106
    v_mul_f32 v107, s43, v107
    v_exp_f32 v105, v105
    v_add_f32 v104, 1.0, v104
    v_exp_f32 v106, v106
    v_mfma_f32_16x16x32_bf16 v[20:23], v[176:179], a[100:103], v[20:23]
    ds_read_b64_tr_b16 v[210:211], v230 offset:24832
    s_add_u32 s45, s38, 73856
    v_add_f32 v105, 1.0, v105
    v_mfma_f32_16x16x32_bf16 v[24:27], v[176:179], a[240:243], v[24:27]
    ds_read_b64_tr_b16 v[212:213], v230 offset:26624
    buffer_load_dwordx4 v235, s[20:23], s45 offen  lds
    v_exp_f32 v107, v107
    v_mfma_f32_16x16x32_bf16 v[28:31], v[176:179], a[244:247], v[28:31]
    ds_read_b64_tr_b16 v[214:215], v230 offset:26880
    v_add_f32 v106, 1.0, v106
    v_mfma_f32_16x16x32_bf16 v[16:19], v[180:183], a[104:107], v[16:19]
    s_add_u32 m0, s40, 61440
    ds_read_b128 a[40:43], v242 offset:18432
    v_mfma_f32_16x16x32_bf16 v[20:23], v[180:183], a[108:111], v[20:23]
    s_add_u32 s45, s38, 110720
    ds_read_b128 a[184:187], v243 offset:18432
    v_rcp_f32 v104, v104
    v_mfma_f32_16x16x32_bf16 v[24:27], v[180:183], a[248:251], v[24:27]
    buffer_load_dwordx4 v235, s[20:23], s45 offen  lds
    ds_write_b128 v240, v[96:99] offset:0
    v_mfma_f32_16x16x32_bf16 v[28:31], v[180:183], a[252:255], v[28:31]
    s_waitcnt lgkmcnt(9)
    v_rcp_f32 v105, v105
    v_mfma_f32_16x16x32_bf16 v[48:51], v[192:195], a[96:99], v[48:51]
    ds_read_b64_tr_b16 v[176:177], v230 offset:20480
    s_add_u32 m0, s40, 57344
    v_add_f32 v107, 1.0, v107
    v_mul_f32 v104, v104, v136
    v_rcp_f32 v106, v106
    v_mul_f32 v105, v105, v137
    v_rcp_f32 v107, v107
    v_mfma_f32_16x16x32_bf16 v[52:55], v[192:195], a[100:103], v[52:55]
    ds_read_b64_tr_b16 v[178:179], v230 offset:20736
    v_mul_f32 v106, v106, v138
    v_mfma_f32_16x16x32_bf16 v[56:59], v[192:195], a[240:243], v[56:59]
    s_add_u32 s45, s38, 147584
    ds_read_b64_tr_b16 v[180:181], v230 offset:22528
    v_cvt_pk_bf16_f32 v104, v104, v105
    v_mfma_f32_16x16x32_bf16 v[60:63], v[192:195], a[244:247], v[60:63]
    buffer_load_dwordx4 v235, s[20:23], s45 offen  lds
    ds_read_b64_tr_b16 v[182:183], v230 offset:22784
    v_mul_f32 v107, v107, v139
    v_mfma_f32_16x16x32_bf16 v[48:51], v[196:199], a[104:107], v[48:51]
    s_add_u32 m0, s40, 53248
    ds_read_b128 a[44:47], v242 offset:19456
    v_cvt_pk_bf16_f32 v105, v106, v107
    v_mfma_f32_16x16x32_bf16 v[52:55], v[196:199], a[108:111], v[52:55]
    s_add_u32 s45, s38, 184448
    ds_read_b128 a[188:191], v243 offset:19456
    v_mul_f32 v108, s43, v108
    v_mfma_f32_16x16x32_bf16 v[56:59], v[196:199], a[248:251], v[56:59]
    buffer_load_dwordx4 v235, s[20:23], s45 offen  lds
    v_mul_f32 v109, s43, v109
    v_mfma_f32_16x16x32_bf16 v[60:63], v[196:199], a[252:255], v[60:63]
    s_waitcnt lgkmcnt(9)
    v_exp_f32 v108, v108
    v_mfma_f32_16x16x32_bf16 v[16:19], v[208:211], a[112:115], v[16:19]
    ds_read_b64_tr_b16 v[192:193], v230 offset:16384
    s_add_u32 m0, s40, 49152
    v_mul_f32 v110, s43, v110
    v_mul_f32 v111, s43, v111
    v_exp_f32 v109, v109
    v_add_f32 v108, 1.0, v108
    v_exp_f32 v110, v110
    v_mfma_f32_16x16x32_bf16 v[20:23], v[208:211], a[116:119], v[20:23]
    s_add_u32 s45, s38, 221312
    v_exp_f32 v111, v111
    v_mfma_f32_16x16x32_bf16 v[24:27], v[208:211], v[144:147], v[24:27]
    ds_read_b64_tr_b16 v[194:195], v230 offset:16640
    v_add_f32 v109, 1.0, v109
    v_mfma_f32_16x16x32_bf16 v[28:31], v[208:211], v[148:151], v[28:31]
    buffer_load_dwordx4 v235, s[20:23], s45 offen  lds
    v_mfma_f32_16x16x32_bf16 v[16:19], v[212:215], a[120:123], v[16:19]
    ds_read_b64_tr_b16 v[196:197], v230 offset:18432
    s_add_u32 m0, s40, 45056
    v_mfma_f32_16x16x32_bf16 v[20:23], v[212:215], a[124:127], v[20:23]
    s_add_u32 s45, s38, 258176
    ds_read_b64_tr_b16 v[198:199], v230 offset:18688
    v_add_f32 v110, 1.0, v110
    v_mfma_f32_16x16x32_bf16 v[24:27], v[212:215], v[152:155], v[24:27]
    buffer_load_dwordx4 v235, s[20:23], s45 offen  lds
    v_rcp_f32 v108, v108
    v_mfma_f32_16x16x32_bf16 v[28:31], v[212:215], v[156:159], v[28:31]
    s_waitcnt lgkmcnt(6)
    v_rcp_f32 v109, v109
    v_mfma_f32_16x16x32_bf16 v[48:51], v[176:179], a[112:115], v[48:51]
    ds_read_b64_tr_b16 v[208:209], v232 offset:16384
    s_add_u32 m0, s40, 40960
    v_add_f32 v111, 1.0, v111
    v_mul_f32 v108, v108, v140
    v_rcp_f32 v110, v110
    v_mfma_f32_16x16x32_bf16 v[52:55], v[176:179], a[116:119], v[52:55]
    s_add_u32 s45, s39, 128
    v_rcp_f32 v111, v111
    v_mfma_f32_16x16x32_bf16 v[56:59], v[176:179], v[144:147], v[56:59]
    ds_read_b64_tr_b16 v[210:211], v232 offset:16640
    v_mul_f32 v109, v109, v141
    v_mfma_f32_16x16x32_bf16 v[60:63], v[176:179], v[148:151], v[60:63]
    buffer_load_dwordx4 v235, s[20:23], s45 offen  lds
    v_mfma_f32_16x16x32_bf16 v[48:51], v[180:183], a[120:123], v[48:51]
    ds_read_b64_tr_b16 v[212:213], v232 offset:18432
    s_add_u32 m0, s40, 36864
    v_mul_f32 v110, v110, v142
    v_mfma_f32_16x16x32_bf16 v[52:55], v[180:183], a[124:127], v[52:55]
    s_add_u32 s45, s38, 256
    ds_read_b64_tr_b16 v[214:215], v232 offset:18688
    v_cvt_pk_bf16_f32 v106, v108, v109
    v_mfma_f32_16x16x32_bf16 v[56:59], v[180:183], v[152:155], v[56:59]
    buffer_load_dwordx4 v235, s[20:23], s45 offen  lds
    v_mul_f32 v111, v111, v143
    v_mfma_f32_16x16x32_bf16 v[60:63], v[180:183], v[156:159], v[60:63]
    s_waitcnt lgkmcnt(4)
    v_cvt_pk_bf16_f32 v107, v110, v111
    v_mfma_f32_16x16x32_bf16 v[16:19], v[192:195], a[128:131], v[16:19]
    ds_read_b64_tr_b16 v[176:177], v226 offset:12288
    v_mfma_f32_16x16x32_bf16 v[20:23], v[192:195], a[132:135], v[20:23]
    v_mfma_f32_16x16x32_bf16 v[24:27], v[192:195], v[160:163], v[24:27]
    ds_read_b64_tr_b16 v[178:179], v226 offset:14336
    v_mfma_f32_16x16x32_bf16 v[28:31], v[192:195], v[164:167], v[28:31]
    ds_read_b64_tr_b16 v[180:181], v227 offset:12288
    v_mfma_f32_16x16x32_bf16 v[16:19], v[196:199], a[136:139], v[16:19]
    ds_read_b64_tr_b16 v[182:183], v227 offset:14336
    v_mfma_f32_16x16x32_bf16 v[20:23], v[196:199], a[140:143], v[20:23]
    v_mfma_f32_16x16x32_bf16 v[24:27], v[196:199], v[168:171], v[24:27]
    ds_write_b128 v240, v[104:107] offset:1024
    v_mfma_f32_16x16x32_bf16 v[28:31], v[196:199], v[172:175], v[28:31]
    s_waitcnt lgkmcnt(5)
    v_mfma_f32_16x16x32_bf16 v[48:51], v[208:211], a[128:131], v[48:51]
    s_waitcnt vmcnt(10)
    s_waitcnt lgkmcnt(0)
    s_barrier
    v_mfma_f32_16x16x32_bf16 v[52:55], v[208:211], a[132:135], v[52:55]
    ds_read_b64_tr_b16 v[192:193], v226 offset:8192
    s_add_u32 m0, s40, 143360
    v_mfma_f32_16x16x32_bf16 v[56:59], v[208:211], v[160:163], v[56:59]
    ds_read_b64_tr_b16 v[194:195], v226 offset:10240
    s_add_u32 s45, s38, 37120
    v_mfma_f32_16x16x32_bf16 v[60:63], v[208:211], v[164:167], v[60:63]
    ds_read_b64_tr_b16 v[196:197], v227 offset:8192
    buffer_load_dwordx4 v235, s[20:23], s45 offen  lds
    ds_read_b64_tr_b16 v[198:199], v227 offset:10240
    v_mfma_f32_16x16x32_bf16 v[48:51], v[212:215], a[136:139], v[48:51]
    ds_read_b128 a[48:51], v242 offset:0
    s_add_u32 m0, s40, 139264
    v_mfma_f32_16x16x32_bf16 v[52:55], v[212:215], a[140:143], v[52:55]
    ds_read_b128 a[192:195], v243 offset:0
    s_add_u32 s45, s38, 73984
    ds_read_b128 a[52:55], v242 offset:1024
    v_mfma_f32_16x16x32_bf16 v[56:59], v[212:215], v[168:171], v[56:59]
    buffer_load_dwordx4 v235, s[20:23], s45 offen  lds
    ds_read_b128 a[196:199], v243 offset:1024
    v_mfma_f32_16x16x32_bf16 v[60:63], v[212:215], v[172:175], v[60:63]
    v_mfma_f32_16x16x32_bf16 v[80:83], v[176:179], a[0:3], 0
    ds_read_b64_tr_b16 v[208:209], v226 offset:4096
    s_add_u32 m0, s40, 135168
    v_mfma_f32_16x16x32_bf16 v[88:91], v[176:179], a[4:7], 0
    ds_read_b64_tr_b16 v[210:211], v226 offset:6144
    s_add_u32 s45, s38, 110848
    v_mfma_f32_16x16x32_bf16 v[96:99], v[176:179], a[144:147], 0
    ds_read_b64_tr_b16 v[212:213], v227 offset:4096
    buffer_load_dwordx4 v235, s[20:23], s45 offen  lds
    v_mfma_f32_16x16x32_bf16 v[104:107], v[176:179], a[148:151], 0
    ds_read_b64_tr_b16 v[214:215], v227 offset:6144
    ds_read_b128 a[56:59], v242 offset:2048
    v_mfma_f32_16x16x32_bf16 v[84:87], v[180:183], a[0:3], 0
    s_add_u32 m0, s40, 131072
    ds_read_b128 a[200:203], v243 offset:2048
    v_mfma_f32_16x16x32_bf16 v[92:95], v[180:183], a[4:7], 0
    s_add_u32 s45, s38, 147712
    ds_read_b128 a[60:63], v242 offset:3072
    v_mfma_f32_16x16x32_bf16 v[100:103], v[180:183], a[144:147], 0
    buffer_load_dwordx4 v235, s[20:23], s45 offen  lds
    ds_read_b128 a[204:207], v243 offset:3072
    v_mfma_f32_16x16x32_bf16 v[108:111], v[180:183], a[148:151], 0
    s_waitcnt lgkmcnt(12)
    v_mfma_f32_16x16x32_bf16 v[80:83], v[192:195], a[8:11], v[80:83]
    ds_read_b64_tr_b16 v[176:177], v224 offset:12288
    s_add_u32 m0, s40, 126976
    v_mul_f32 v16, s43, v16
    v_mul_f32 v17, s43, v17
    v_mul_f32 v18, s43, v18
    v_mul_f32 v19, s43, v19
    v_exp_f32 v16, v16
    v_exp_f32 v17, v17
    v_add_f32 v16, 1.0, v16
    v_exp_f32 v18, v18
    v_add_f32 v17, 1.0, v17
    v_exp_f32 v19, v19
    v_add_f32 v18, 1.0, v18
    v_rcp_f32 v16, v16
    v_add_f32 v19, 1.0, v19
    v_rcp_f32 v17, v17
    v_mul_f32 v16, v16, v48
    v_rcp_f32 v18, v18
    v_mfma_f32_16x16x32_bf16 v[88:91], v[192:195], a[12:15], v[88:91]
    s_add_u32 s45, s38, 184576
    v_rcp_f32 v19, v19
    v_mfma_f32_16x16x32_bf16 v[96:99], v[192:195], a[152:155], v[96:99]
    ds_read_b64_tr_b16 v[178:179], v224 offset:14336
    v_mul_f32 v17, v17, v49
    v_mfma_f32_16x16x32_bf16 v[104:107], v[192:195], a[156:159], v[104:107]
    buffer_load_dwordx4 v235, s[20:23], s45 offen  lds
    v_mfma_f32_16x16x32_bf16 v[84:87], v[196:199], a[8:11], v[84:87]
    ds_read_b64_tr_b16 v[180:181], v225 offset:12288
    s_add_u32 m0, s40, 122880
    v_mul_f32 v18, v18, v50
    v_mfma_f32_16x16x32_bf16 v[92:95], v[196:199], a[12:15], v[92:95]
    s_add_u32 s45, s38, 221440
    ds_read_b64_tr_b16 v[182:183], v225 offset:14336
    v_cvt_pk_bf16_f32 v16, v16, v17
    v_mfma_f32_16x16x32_bf16 v[100:103], v[196:199], a[152:155], v[100:103]
    buffer_load_dwordx4 v235, s[20:23], s45 offen  lds
    v_mul_f32 v19, v19, v51
    v_mfma_f32_16x16x32_bf16 v[108:111], v[196:199], a[156:159], v[108:111]
    s_waitcnt lgkmcnt(8)
    v_cvt_pk_bf16_f32 v17, v18, v19
    v_mul_f32 v20, s43, v20
    v_mfma_f32_16x16x32_bf16 v[80:83], v[208:211], a[16:19], v[80:83]
    ds_read_b64_tr_b16 v[192:193], v224 offset:8192
    s_add_u32 m0, s40, 118784
    v_mul_f32 v21, s43, v21
    v_mul_f32 v22, s43, v22
    v_mul_f32 v23, s43, v23
    v_exp_f32 v20, v20
    v_exp_f32 v21, v21
    v_add_f32 v20, 1.0, v20
    v_exp_f32 v22, v22
    v_add_f32 v21, 1.0, v21
    v_exp_f32 v23, v23
    v_add_f32 v22, 1.0, v22
    v_rcp_f32 v20, v20
    v_add_f32 v23, 1.0, v23
    v_rcp_f32 v21, v21
    v_mul_f32 v20, v20, v52
    v_rcp_f32 v22, v22
    v_mul_f32 v21, v21, v53
    v_mfma_f32_16x16x32_bf16 v[88:91], v[208:211], a[20:23], v[88:91]
    s_add_u32 s45, s38, 258304
    ds_read_b64_tr_b16 v[194:195], v224 offset:10240
    v_rcp_f32 v23, v23
    v_mfma_f32_16x16x32_bf16 v[96:99], v[208:211], a[160:163], v[96:99]
    buffer_load_dwordx4 v235, s[20:23], s45 offen  lds
    v_mfma_f32_16x16x32_bf16 v[104:107], v[208:211], a[164:167], v[104:107]
    ds_read_b64_tr_b16 v[196:197], v225 offset:8192
    v_mul_f32 v22, v22, v54
    v_mfma_f32_16x16x32_bf16 v[84:87], v[212:215], a[16:19], v[84:87]
    s_add_u32 m0, s40, 114688
    ds_read_b64_tr_b16 v[198:199], v225 offset:10240
    v_cvt_pk_bf16_f32 v20, v20, v21
    v_mfma_f32_16x16x32_bf16 v[92:95], v[212:215], a[20:23], v[92:95]
    s_add_u32 s45, s39, 256
    ds_write_b64 v231, v[16:17] offset:0
    v_mul_f32 v23, v23, v55
    v_mfma_f32_16x16x32_bf16 v[100:103], v[212:215], a[160:163], v[100:103]
    buffer_load_dwordx4 v235, s[20:23], s45 offen  lds
    v_cvt_pk_bf16_f32 v21, v22, v23
    v_mfma_f32_16x16x32_bf16 v[108:111], v[212:215], a[164:167], v[108:111]
    s_waitcnt lgkmcnt(5)
    v_mul_f32 v24, s43, v24
    v_mul_f32 v25, s43, v25
    v_mfma_f32_16x16x32_bf16 v[80:83], v[176:179], a[24:27], v[80:83]
    ds_read_b64_tr_b16 v[208:209], v224 offset:4096
    s_add_u32 m0, s40, 86016
    v_mul_f32 v26, s43, v26
    v_mul_f32 v27, s43, v27
    v_exp_f32 v24, v24
    v_exp_f32 v25, v25
    v_add_f32 v24, 1.0, v24
    v_exp_f32 v26, v26
    v_add_f32 v25, 1.0, v25
    v_exp_f32 v27, v27
    v_add_f32 v26, 1.0, v26
    v_rcp_f32 v24, v24
    v_add_f32 v27, 1.0, v27
    v_rcp_f32 v25, v25
    v_mul_f32 v24, v24, v56
    v_rcp_f32 v26, v26
    v_mul_f32 v25, v25, v57
    v_mfma_f32_16x16x32_bf16 v[88:91], v[176:179], a[28:31], v[88:91]
    s_add_u32 s45, s38, 384
    ds_read_b64_tr_b16 v[210:211], v224 offset:6144
    v_rcp_f32 v27, v27
    v_mfma_f32_16x16x32_bf16 v[96:99], v[176:179], a[168:171], v[96:99]
    buffer_load_dwordx4 v235, s[20:23], s45 offen  lds
    v_mfma_f32_16x16x32_bf16 v[104:107], v[176:179], a[172:175], v[104:107]
    ds_read_b64_tr_b16 v[212:213], v225 offset:4096
    v_mul_f32 v26, v26, v58
    v_mfma_f32_16x16x32_bf16 v[84:87], v[180:183], a[24:27], v[84:87]
    s_add_u32 m0, s40, 81920
    ds_read_b64_tr_b16 v[214:215], v225 offset:6144
    v_cvt_pk_bf16_f32 v24, v24, v25
    v_mfma_f32_16x16x32_bf16 v[92:95], v[180:183], a[28:31], v[92:95]
    s_add_u32 s45, s38, 37248
    ds_write_b64 v231, v[20:21] offset:1024
    v_mul_f32 v27, v27, v59
    v_mfma_f32_16x16x32_bf16 v[100:103], v[180:183], a[168:171], v[100:103]
    buffer_load_dwordx4 v235, s[20:23], s45 offen  lds
    v_cvt_pk_bf16_f32 v25, v26, v27
    v_mfma_f32_16x16x32_bf16 v[108:111], v[180:183], a[172:175], v[108:111]
    s_waitcnt lgkmcnt(6)
    v_mul_f32 v28, s43, v28
    v_mul_f32 v29, s43, v29
    v_mfma_f32_16x16x32_bf16 v[80:83], v[192:195], a[32:35], v[80:83]
    ds_read_b64_tr_b16 v[176:177], v224 offset:0
    s_add_u32 m0, s40, 32768
    v_mul_f32 v30, s43, v30
    v_mul_f32 v31, s43, v31
    v_exp_f32 v28, v28
    v_exp_f32 v29, v29
    v_add_f32 v28, 1.0, v28
    v_exp_f32 v30, v30
    v_add_f32 v29, 1.0, v29
    v_exp_f32 v31, v31
    v_add_f32 v30, 1.0, v30
    v_rcp_f32 v28, v28
    v_add_f32 v31, 1.0, v31
    v_rcp_f32 v29, v29
    v_mul_f32 v28, v28, v60
    v_rcp_f32 v30, v30
    v_mfma_f32_16x16x32_bf16 v[88:91], v[192:195], a[36:39], v[88:91]
    s_add_u32 s45, s38, 74112
    ds_read_b64_tr_b16 v[178:179], v224 offset:2048
    v_mul_f32 v29, v29, v61
    v_mfma_f32_16x16x32_bf16 v[96:99], v[192:195], a[176:179], v[96:99]
    buffer_load_dwordx4 v235, s[20:23], s45 offen  lds
    v_rcp_f32 v31, v31
    v_mfma_f32_16x16x32_bf16 v[104:107], v[192:195], a[180:183], v[104:107]
    ds_read_b64_tr_b16 v[180:181], v225 offset:0
    v_mul_f32 v30, v30, v62
    v_mfma_f32_16x16x32_bf16 v[84:87], v[196:199], a[32:35], v[84:87]
    s_add_u32 m0, s40, 28672
    ds_read_b64_tr_b16 v[182:183], v225 offset:2048
    v_mfma_f32_16x16x32_bf16 v[92:95], v[196:199], a[36:39], v[92:95]
    s_add_u32 s45, s38, 110976
    ds_write_b64 v241, v[24:25] offset:0
    v_cvt_pk_bf16_f32 v28, v28, v29
    v_mfma_f32_16x16x32_bf16 v[100:103], v[196:199], a[176:179], v[100:103]
    buffer_load_dwordx4 v235, s[20:23], s45 offen  lds
    v_mul_f32 v31, v31, v63
    v_mfma_f32_16x16x32_bf16 v[108:111], v[196:199], a[180:183], v[108:111]
    s_waitcnt lgkmcnt(6)
    v_cvt_pk_bf16_f32 v29, v30, v31
    v_mfma_f32_16x16x32_bf16 v[80:83], v[208:211], a[40:43], v[80:83]
    ds_read_b64_tr_b16 v[192:193], v228 offset:28672
    s_add_u32 m0, s40, 24576
    v_mfma_f32_16x16x32_bf16 v[88:91], v[208:211], a[44:47], v[88:91]
    s_add_u32 s45, s38, 147840
    ds_read_b64_tr_b16 v[194:195], v228 offset:30720
    v_mfma_f32_16x16x32_bf16 v[96:99], v[208:211], a[184:187], v[96:99]
    buffer_load_dwordx4 v235, s[20:23], s45 offen  lds
    v_mfma_f32_16x16x32_bf16 v[104:107], v[208:211], a[188:191], v[104:107]
    ds_read_b64_tr_b16 v[196:197], v229 offset:28672
    v_mfma_f32_16x16x32_bf16 v[84:87], v[212:215], a[40:43], v[84:87]
    s_add_u32 m0, s40, 20480
    ds_read_b64_tr_b16 v[198:199], v229 offset:30720
    v_mfma_f32_16x16x32_bf16 v[92:95], v[212:215], a[44:47], v[92:95]
    s_add_u32 s45, s38, 184704
    ds_write_b64 v241, v[28:29] offset:1024
    v_mfma_f32_16x16x32_bf16 v[100:103], v[212:215], a[184:187], v[100:103]
    buffer_load_dwordx4 v235, s[20:23], s45 offen  lds
    v_mfma_f32_16x16x32_bf16 v[108:111], v[212:215], a[188:191], v[108:111]
    s_waitcnt lgkmcnt(6)
    v_mfma_f32_16x16x32_bf16 v[80:83], v[176:179], a[48:51], v[80:83]
    s_waitcnt vmcnt(17)
    s_waitcnt lgkmcnt(0)
    s_barrier
    v_mfma_f32_16x16x32_bf16 v[88:91], v[176:179], a[52:55], v[88:91]
    ds_read_b64_tr_b16 v[208:209], v228 offset:24576
    s_add_u32 m0, s40, 110592
    v_mfma_f32_16x16x32_bf16 v[96:99], v[176:179], a[192:195], v[96:99]
    ds_read_b64_tr_b16 v[210:211], v228 offset:26624
    s_add_u32 s45, s38, 221568
    v_mfma_f32_16x16x32_bf16 v[104:107], v[176:179], a[196:199], v[104:107]
    ds_read_b64_tr_b16 v[212:213], v229 offset:24576
    buffer_load_dwordx4 v235, s[20:23], s45 offen  lds
    ds_read_b64_tr_b16 v[214:215], v229 offset:26624
    v_mfma_f32_16x16x32_bf16 v[84:87], v[180:183], a[48:51], v[84:87]
    ds_read_b128 a[64:67], v244 offset:0
    s_add_u32 m0, s40, 106496
    v_mfma_f32_16x16x32_bf16 v[92:95], v[180:183], a[52:55], v[92:95]
    ds_read_b128 a[208:211], v245 offset:0
    s_add_u32 s45, s38, 258432
    ds_read_b128 a[68:71], v244 offset:1024
    v_mfma_f32_16x16x32_bf16 v[100:103], v[180:183], a[192:195], v[100:103]
    buffer_load_dwordx4 v235, s[20:23], s45 offen  lds
    ds_read_b128 a[212:215], v245 offset:1024
    v_mfma_f32_16x16x32_bf16 v[108:111], v[180:183], a[196:199], v[108:111]
    v_mfma_f32_16x16x32_bf16 v[80:83], v[192:195], a[56:59], v[80:83]
    ds_read_b64_tr_b16 v[176:177], v228 offset:20480
    v_mfma_f32_16x16x32_bf16 v[88:91], v[192:195], a[60:63], v[88:91]
    s_add_u32 m0, s40, 102400
    v_mfma_f32_16x16x32_bf16 v[96:99], v[192:195], a[200:203], v[96:99]
    ds_read_b64_tr_b16 v[178:179], v228 offset:22528
    v_mfma_f32_16x16x32_bf16 v[104:107], v[192:195], a[204:207], v[104:107]
    s_add_u32 s45, s39, 384
    v_mfma_f32_16x16x32_bf16 v[84:87], v[196:199], a[56:59], v[84:87]
    ds_read_b64_tr_b16 v[180:181], v229 offset:20480
    v_mfma_f32_16x16x32_bf16 v[92:95], v[196:199], a[60:63], v[92:95]
    buffer_load_dwordx4 v235, s[20:23], s45 offen  lds
    v_mfma_f32_16x16x32_bf16 v[100:103], v[196:199], a[200:203], v[100:103]
    ds_read_b64_tr_b16 v[182:183], v229 offset:22528
    v_mfma_f32_16x16x32_bf16 v[108:111], v[196:199], a[204:207], v[108:111]
    s_waitcnt lgkmcnt(8)
    s_waitcnt lgkmcnt(4)
    v_mfma_f32_16x16x32_bf16 v[80:83], v[208:211], a[64:67], v[80:83]
    ds_read_b64_tr_b16 v[192:193], v228 offset:16384
    v_mfma_f32_16x16x32_bf16 v[88:91], v[208:211], a[68:71], v[88:91]
    s_add_u32 m0, s40, 98304
    v_mfma_f32_16x16x32_bf16 v[96:99], v[208:211], a[208:211], v[96:99]
    ds_read_b64_tr_b16 v[194:195], v228 offset:18432
    v_mfma_f32_16x16x32_bf16 v[104:107], v[208:211], a[212:215], v[104:107]
    s_add_u32 s45, s38, 512
    v_mfma_f32_16x16x32_bf16 v[84:87], v[212:215], a[64:67], v[84:87]
    ds_read_b64_tr_b16 v[196:197], v229 offset:16384
    v_mfma_f32_16x16x32_bf16 v[92:95], v[212:215], a[68:71], v[92:95]
    buffer_load_dwordx4 v235, s[20:23], s45 offen  lds
    v_mfma_f32_16x16x32_bf16 v[100:103], v[212:215], a[208:211], v[100:103]
    ds_read_b64_tr_b16 v[198:199], v229 offset:18432
    v_mfma_f32_16x16x32_bf16 v[108:111], v[212:215], a[212:215], v[108:111]
    s_waitcnt lgkmcnt(4)
    v_mfma_f32_16x16x32_bf16 v[112:115], v[176:179], a[0:3], 0
    ds_read_b64_tr_b16 v[208:209], v226 offset:0
    v_mfma_f32_16x16x32_bf16 v[120:123], v[176:179], a[4:7], 0
    s_add_u32 m0, s40, 77824
    v_mfma_f32_16x16x32_bf16 v[128:131], v[176:179], a[144:147], 0
    ds_read_b64_tr_b16 v[210:211], v226 offset:2048
    v_mfma_f32_16x16x32_bf16 v[136:139], v[176:179], a[148:151], 0
    s_add_u32 s45, s38, 37376
    v_mfma_f32_16x16x32_bf16 v[116:119], v[180:183], a[0:3], 0
    ds_read_b64_tr_b16 v[212:213], v227 offset:0
    v_mfma_f32_16x16x32_bf16 v[124:127], v[180:183], a[4:7], 0
    buffer_load_dwordx4 v235, s[20:23], s45 offen  lds
    v_mfma_f32_16x16x32_bf16 v[132:135], v[180:183], a[144:147], 0
    ds_read_b64_tr_b16 v[214:215], v227 offset:2048
    v_mfma_f32_16x16x32_bf16 v[140:143], v[180:183], a[148:151], 0
    s_waitcnt lgkmcnt(4)
    v_mfma_f32_16x16x32_bf16 v[112:115], v[192:195], a[8:11], v[112:115]
    ds_read_b64_tr_b16 v[176:177], v224 offset:61440
    v_cvt_pk_bf16_f32 v16, v80, v81
    v_mfma_f32_16x16x32_bf16 v[120:123], v[192:195], a[12:15], v[120:123]
    s_add_u32 m0, s40, 73728
    v_cvt_pk_bf16_f32 v17, v82, v83
    v_cvt_pk_bf16_f32 v18, v84, v85
    v_mfma_f32_16x16x32_bf16 v[128:131], v[192:195], a[152:155], v[128:131]
    s_add_u32 s45, s38, 74240
    ds_read_b64_tr_b16 v[178:179], v224 offset:63488
    v_mfma_f32_16x16x32_bf16 v[136:139], v[192:195], a[156:159], v[136:139]
    buffer_load_dwordx4 v235, s[20:23], s45 offen  lds
    v_mfma_f32_16x16x32_bf16 v[116:119], v[196:199], a[8:11], v[116:119]
    ds_read_b64_tr_b16 v[180:181], v225 offset:61440
    v_cvt_pk_bf16_f32 v19, v86, v87
    v_mfma_f32_16x16x32_bf16 v[124:127], v[196:199], a[12:15], v[124:127]
    s_add_u32 s46, s58, 0
    ds_read_b64_tr_b16 v[182:183], v225 offset:63488
    v_mfma_f32_16x16x32_bf16 v[132:135], v[196:199], a[152:155], v[132:135]
    s_add_u32 s47, s59, 0
    v_cvt_pk_bf16_f32 v20, v88, v89
    v_cvt_pk_bf16_f32 v21, v90, v91
    v_mfma_f32_16x16x32_bf16 v[140:143], v[196:199], a[156:159], v[140:143]
    s_waitcnt lgkmcnt(4)
    v_cvt_pk_bf16_f32 v22, v92, v93
    v_cvt_pk_bf16_f32 v23, v94, v95
    v_mfma_f32_16x16x32_bf16 v[112:115], v[208:211], a[16:19], v[112:115]
    ds_read_b64_tr_b16 v[192:193], v224 offset:57344
    s_add_u32 m0, s40, 69632
    v_mfma_f32_16x16x32_bf16 v[120:123], v[208:211], a[20:23], v[120:123]
    s_add_u32 s45, s38, 111104
    ds_read_b64_tr_b16 v[194:195], v224 offset:59392
    v_mfma_f32_16x16x32_bf16 v[128:131], v[208:211], a[160:163], v[128:131]
    buffer_load_dwordx4 v235, s[20:23], s45 offen  lds
    v_mfma_f32_16x16x32_bf16 v[136:139], v[208:211], a[164:167], v[136:139]
    ds_read_b64_tr_b16 v[196:197], v225 offset:57344
    v_cvt_pk_bf16_f32 v24, v96, v97
    v_mfma_f32_16x16x32_bf16 v[116:119], v[212:215], a[16:19], v[116:119]
    buffer_store_dwordx4 v[16:19], v236, s[48:51], s46 offen offset:0 sc1
    v_mfma_f32_16x16x32_bf16 v[124:127], v[212:215], a[20:23], v[124:127]
    ds_read_b64_tr_b16 v[198:199], v225 offset:59392
    v_cvt_pk_bf16_f32 v25, v98, v99
    v_mfma_f32_16x16x32_bf16 v[132:135], v[212:215], a[160:163], v[132:135]
    buffer_store_dwordx4 v[20:23], v236, s[48:51], s46 offen offset:256 sc1
    v_mfma_f32_16x16x32_bf16 v[140:143], v[212:215], a[164:167], v[140:143]
    s_waitcnt lgkmcnt(4)
    v_cvt_pk_bf16_f32 v26, v100, v101
    v_cvt_pk_bf16_f32 v27, v102, v103
    v_mfma_f32_16x16x32_bf16 v[112:115], v[176:179], a[24:27], v[112:115]
    ds_read_b64_tr_b16 v[208:209], v224 offset:53248
    v_cvt_pk_bf16_f32 v28, v104, v105
    v_mfma_f32_16x16x32_bf16 v[120:123], v[176:179], a[28:31], v[120:123]
    s_add_u32 m0, s40, 16384
    v_cvt_pk_bf16_f32 v29, v106, v107
    v_cvt_pk_bf16_f32 v30, v108, v109
    v_mfma_f32_16x16x32_bf16 v[128:131], v[176:179], a[168:171], v[128:131]
    ds_read_b64_tr_b16 v[210:211], v224 offset:55296
    v_cvt_pk_bf16_f32 v31, v110, v111
    v_mfma_f32_16x16x32_bf16 v[136:139], v[176:179], a[172:175], v[136:139]
    s_add_u32 s45, s38, 147968
    ds_read_b64_tr_b16 v[212:213], v225 offset:53248
    v_mfma_f32_16x16x32_bf16 v[116:119], v[180:183], a[24:27], v[116:119]
    buffer_load_dwordx4 v235, s[20:23], s45 offen  lds
    v_mfma_f32_16x16x32_bf16 v[124:127], v[180:183], a[28:31], v[124:127]
    ds_read_b64_tr_b16 v[214:215], v225 offset:55296
    v_mfma_f32_16x16x32_bf16 v[132:135], v[180:183], a[168:171], v[132:135]
    buffer_store_dwordx4 v[24:27], v236, s[48:51], s47 offen offset:0 sc1
    v_mfma_f32_16x16x32_bf16 v[140:143], v[180:183], a[172:175], v[140:143]
    s_waitcnt lgkmcnt(4)
    v_mfma_f32_16x16x32_bf16 v[112:115], v[192:195], a[32:35], v[112:115]
    ds_read_b64_tr_b16 v[176:177], v224 offset:49152
    v_mfma_f32_16x16x32_bf16 v[120:123], v[192:195], a[36:39], v[120:123]
    s_add_u32 m0, s40, 12288
    v_mfma_f32_16x16x32_bf16 v[128:131], v[192:195], a[176:179], v[128:131]
    ds_read_b64_tr_b16 v[178:179], v224 offset:51200
    v_mfma_f32_16x16x32_bf16 v[136:139], v[192:195], a[180:183], v[136:139]
    s_add_u32 s45, s38, 184832
    ds_read_b64_tr_b16 v[180:181], v225 offset:49152
    v_mfma_f32_16x16x32_bf16 v[116:119], v[196:199], a[32:35], v[116:119]
    buffer_load_dwordx4 v235, s[20:23], s45 offen  lds
    v_mfma_f32_16x16x32_bf16 v[124:127], v[196:199], a[36:39], v[124:127]
    ds_read_b64_tr_b16 v[182:183], v225 offset:51200
    v_mfma_f32_16x16x32_bf16 v[132:135], v[196:199], a[176:179], v[132:135]
    buffer_store_dwordx4 v[28:31], v236, s[48:51], s47 offen offset:256 sc1
    v_mfma_f32_16x16x32_bf16 v[140:143], v[196:199], a[180:183], v[140:143]
    s_waitcnt lgkmcnt(4)
    v_mfma_f32_16x16x32_bf16 v[112:115], v[208:211], a[40:43], v[112:115]
    s_waitcnt vmcnt(22)
    v_mfma_f32_16x16x32_bf16 v[120:123], v[208:211], a[44:47], v[120:123]
    s_barrier
    ds_read_b64_tr_b16 v[192:193], v224 offset:45056
    v_mfma_f32_16x16x32_bf16 v[128:131], v[208:211], a[184:187], v[128:131]
    s_add_u32 m0, s40, 159744
    v_mfma_f32_16x16x32_bf16 v[136:139], v[208:211], a[188:191], v[136:139]
    ds_read_b64_tr_b16 v[194:195], v224 offset:47104
    v_mfma_f32_16x16x32_bf16 v[116:119], v[212:215], a[40:43], v[116:119]
    s_add_u32 s45, s38, 221696
    ds_read_b64_tr_b16 v[196:197], v225 offset:45056
    v_mfma_f32_16x16x32_bf16 v[124:127], v[212:215], a[44:47], v[124:127]
    buffer_load_dwordx4 v235, s[20:23], s45 offen  lds
    v_mfma_f32_16x16x32_bf16 v[132:135], v[212:215], a[184:187], v[132:135]
    ds_read_b64_tr_b16 v[198:199], v225 offset:47104
    v_mfma_f32_16x16x32_bf16 v[140:143], v[212:215], a[188:191], v[140:143]
    s_waitcnt lgkmcnt(4)
    v_mfma_f32_16x16x32_bf16 v[112:115], v[176:179], a[48:51], v[112:115]
    ds_read_b64_tr_b16 v[208:209], v224 offset:40960
    v_mfma_f32_16x16x32_bf16 v[120:123], v[176:179], a[52:55], v[120:123]
    s_add_u32 m0, s40, 155648
    v_mfma_f32_16x16x32_bf16 v[128:131], v[176:179], a[192:195], v[128:131]
    ds_read_b64_tr_b16 v[210:211], v224 offset:43008
    v_mfma_f32_16x16x32_bf16 v[136:139], v[176:179], a[196:199], v[136:139]
    s_add_u32 s45, s38, 258560
    v_mfma_f32_16x16x32_bf16 v[116:119], v[180:183], a[48:51], v[116:119]
    ds_read_b64_tr_b16 v[212:213], v225 offset:40960
    v_mfma_f32_16x16x32_bf16 v[124:127], v[180:183], a[52:55], v[124:127]
    buffer_load_dwordx4 v235, s[20:23], s45 offen  lds
    v_mfma_f32_16x16x32_bf16 v[132:135], v[180:183], a[192:195], v[132:135]
    ds_read_b64_tr_b16 v[214:215], v225 offset:43008
    v_mfma_f32_16x16x32_bf16 v[140:143], v[180:183], a[196:199], v[140:143]
    s_waitcnt lgkmcnt(4)
    v_mfma_f32_16x16x32_bf16 v[112:115], v[192:195], a[56:59], v[112:115]
    ds_read_b64_tr_b16 v[176:177], v224 offset:36864
    v_mfma_f32_16x16x32_bf16 v[120:123], v[192:195], a[60:63], v[120:123]
    s_add_u32 m0, s40, 151552
    v_mfma_f32_16x16x32_bf16 v[128:131], v[192:195], a[200:203], v[128:131]
    ds_read_b64_tr_b16 v[178:179], v224 offset:38912
    v_mfma_f32_16x16x32_bf16 v[136:139], v[192:195], a[204:207], v[136:139]
    s_add_u32 s45, s39, 512
    v_mfma_f32_16x16x32_bf16 v[116:119], v[196:199], a[56:59], v[116:119]
    ds_read_b64_tr_b16 v[180:181], v225 offset:36864
    v_mfma_f32_16x16x32_bf16 v[124:127], v[196:199], a[60:63], v[124:127]
    buffer_load_dwordx4 v235, s[20:23], s45 offen  lds
    v_mfma_f32_16x16x32_bf16 v[132:135], v[196:199], a[200:203], v[132:135]
    ds_read_b64_tr_b16 v[182:183], v225 offset:38912
    v_mfma_f32_16x16x32_bf16 v[140:143], v[196:199], a[204:207], v[140:143]
    s_waitcnt lgkmcnt(4)
    v_mfma_f32_16x16x32_bf16 v[112:115], v[208:211], a[64:67], v[112:115]
    ds_read_b64_tr_b16 v[192:193], v228 offset:12288
    v_mfma_f32_16x16x32_bf16 v[120:123], v[208:211], a[68:71], v[120:123]
    s_add_u32 m0, s40, 147456
    v_mfma_f32_16x16x32_bf16 v[128:131], v[208:211], a[208:211], v[128:131]
    ds_read_b64_tr_b16 v[194:195], v228 offset:14336
    v_mfma_f32_16x16x32_bf16 v[136:139], v[208:211], a[212:215], v[136:139]
    s_add_u32 s45, s38, 640
    v_mfma_f32_16x16x32_bf16 v[116:119], v[212:215], a[64:67], v[116:119]
    ds_read_b64_tr_b16 v[196:197], v229 offset:12288
    v_mfma_f32_16x16x32_bf16 v[124:127], v[212:215], a[68:71], v[124:127]
    buffer_load_dwordx4 v235, s[20:23], s45 offen  lds
    v_mfma_f32_16x16x32_bf16 v[132:135], v[212:215], a[208:211], v[132:135]
    ds_read_b64_tr_b16 v[198:199], v229 offset:14336
    v_mfma_f32_16x16x32_bf16 v[140:143], v[212:215], a[212:215], v[140:143]
    s_waitcnt lgkmcnt(4)
    v_mfma_f32_16x16x32_bf16 v[80:83], v[176:179], a[0:3], 0
    ds_read_b64_tr_b16 v[208:209], v228 offset:8192
    v_mfma_f32_16x16x32_bf16 v[88:91], v[176:179], a[4:7], 0
    s_add_u32 m0, s40, 94208
    v_mfma_f32_16x16x32_bf16 v[96:99], v[176:179], a[144:147], 0
    ds_read_b64_tr_b16 v[210:211], v228 offset:10240
    v_mfma_f32_16x16x32_bf16 v[104:107], v[176:179], a[148:151], 0
    s_add_u32 s45, s38, 37504
    v_mfma_f32_16x16x32_bf16 v[84:87], v[180:183], a[0:3], 0
    ds_read_b64_tr_b16 v[212:213], v229 offset:8192
    v_mfma_f32_16x16x32_bf16 v[92:95], v[180:183], a[4:7], 0
    buffer_load_dwordx4 v235, s[20:23], s45 offen  lds
    v_mfma_f32_16x16x32_bf16 v[100:103], v[180:183], a[144:147], 0
    ds_read_b64_tr_b16 v[214:215], v229 offset:10240
    v_mfma_f32_16x16x32_bf16 v[108:111], v[180:183], a[148:151], 0
    s_waitcnt lgkmcnt(4)
    v_mfma_f32_16x16x32_bf16 v[80:83], v[192:195], a[8:11], v[80:83]
    ds_read_b64_tr_b16 v[176:177], v228 offset:4096
    v_cvt_pk_bf16_f32 v32, v112, v113
    v_mfma_f32_16x16x32_bf16 v[88:91], v[192:195], a[12:15], v[88:91]
    s_add_u32 m0, s40, 90112
    v_cvt_pk_bf16_f32 v33, v114, v115
    v_cvt_pk_bf16_f32 v34, v116, v117
    v_mfma_f32_16x16x32_bf16 v[96:99], v[192:195], a[152:155], v[96:99]
    s_add_u32 s45, s38, 74368
    ds_read_b64_tr_b16 v[178:179], v228 offset:6144
    v_mfma_f32_16x16x32_bf16 v[104:107], v[192:195], a[156:159], v[104:107]
    buffer_load_dwordx4 v235, s[20:23], s45 offen  lds
    v_mfma_f32_16x16x32_bf16 v[84:87], v[196:199], a[8:11], v[84:87]
    ds_read_b64_tr_b16 v[180:181], v229 offset:4096
    v_cvt_pk_bf16_f32 v35, v118, v119
    v_mfma_f32_16x16x32_bf16 v[92:95], v[196:199], a[12:15], v[92:95]
    s_add_u32 s46, s58, 4096
    ds_read_b64_tr_b16 v[182:183], v229 offset:6144
    v_mfma_f32_16x16x32_bf16 v[100:103], v[196:199], a[152:155], v[100:103]
    s_add_u32 s47, s59, 4096
    v_cvt_pk_bf16_f32 v36, v120, v121
    v_cvt_pk_bf16_f32 v37, v122, v123
    v_mfma_f32_16x16x32_bf16 v[108:111], v[196:199], a[156:159], v[108:111]
    s_waitcnt lgkmcnt(4)
    v_cvt_pk_bf16_f32 v38, v124, v125
    v_cvt_pk_bf16_f32 v39, v126, v127
    v_mfma_f32_16x16x32_bf16 v[80:83], v[208:211], a[16:19], v[80:83]
    ds_read_b64_tr_b16 v[192:193], v228 offset:0
    s_add_u32 m0, s40, 65536
    v_mfma_f32_16x16x32_bf16 v[88:91], v[208:211], a[20:23], v[88:91]
    s_add_u32 s45, s38, 111232
    ds_read_b64_tr_b16 v[194:195], v228 offset:2048
    v_mfma_f32_16x16x32_bf16 v[96:99], v[208:211], a[160:163], v[96:99]
    buffer_load_dwordx4 v235, s[20:23], s45 offen  lds
    v_mfma_f32_16x16x32_bf16 v[104:107], v[208:211], a[164:167], v[104:107]
    ds_read_b64_tr_b16 v[196:197], v229 offset:0
    v_cvt_pk_bf16_f32 v40, v128, v129
    v_mfma_f32_16x16x32_bf16 v[84:87], v[212:215], a[16:19], v[84:87]
    buffer_store_dwordx4 v[32:35], v236, s[48:51], s46 offen offset:0 sc1
    v_mfma_f32_16x16x32_bf16 v[92:95], v[212:215], a[20:23], v[92:95]
    ds_read_b64_tr_b16 v[198:199], v229 offset:2048
    v_cvt_pk_bf16_f32 v41, v130, v131
    v_mfma_f32_16x16x32_bf16 v[100:103], v[212:215], a[160:163], v[100:103]
    buffer_store_dwordx4 v[36:39], v236, s[48:51], s46 offen offset:256 sc1
    v_mfma_f32_16x16x32_bf16 v[108:111], v[212:215], a[164:167], v[108:111]
    s_waitcnt lgkmcnt(4)
    v_cvt_pk_bf16_f32 v42, v132, v133
    v_cvt_pk_bf16_f32 v43, v134, v135
    v_mfma_f32_16x16x32_bf16 v[80:83], v[176:179], a[24:27], v[80:83]
    ds_read_b64_tr_b16 v[208:209], v226 offset:61440
    v_cvt_pk_bf16_f32 v44, v136, v137
    v_mfma_f32_16x16x32_bf16 v[88:91], v[176:179], a[28:31], v[88:91]
    s_add_u32 m0, s40, 61440
    v_cvt_pk_bf16_f32 v45, v138, v139
    v_cvt_pk_bf16_f32 v46, v140, v141
    v_mfma_f32_16x16x32_bf16 v[96:99], v[176:179], a[168:171], v[96:99]
    ds_read_b64_tr_b16 v[210:211], v226 offset:63488
    v_cvt_pk_bf16_f32 v47, v142, v143
    v_mfma_f32_16x16x32_bf16 v[104:107], v[176:179], a[172:175], v[104:107]
    s_add_u32 s45, s38, 148096
    ds_read_b64_tr_b16 v[212:213], v227 offset:61440
    v_mfma_f32_16x16x32_bf16 v[84:87], v[180:183], a[24:27], v[84:87]
    buffer_load_dwordx4 v235, s[20:23], s45 offen  lds
    v_mfma_f32_16x16x32_bf16 v[92:95], v[180:183], a[28:31], v[92:95]
    ds_read_b64_tr_b16 v[214:215], v227 offset:63488
    v_mfma_f32_16x16x32_bf16 v[100:103], v[180:183], a[168:171], v[100:103]
    buffer_store_dwordx4 v[40:43], v236, s[48:51], s47 offen offset:0 sc1
    v_mfma_f32_16x16x32_bf16 v[108:111], v[180:183], a[172:175], v[108:111]
    s_waitcnt lgkmcnt(4)
    v_mfma_f32_16x16x32_bf16 v[80:83], v[192:195], a[32:35], v[80:83]
    s_waitcnt vmcnt(25)
    v_mfma_f32_16x16x32_bf16 v[88:91], v[192:195], a[36:39], v[88:91]
    s_barrier
    ds_read_b64_tr_b16 v[176:177], v226 offset:57344
    v_mfma_f32_16x16x32_bf16 v[96:99], v[192:195], a[176:179], v[96:99]
    s_add_u32 m0, s40, 143360
    ds_read_b64_tr_b16 v[178:179], v226 offset:59392
    v_mfma_f32_16x16x32_bf16 v[104:107], v[192:195], a[180:183], v[104:107]
    s_add_u32 s45, s38, 184960
    ds_read_b64_tr_b16 v[180:181], v227 offset:57344
    v_mfma_f32_16x16x32_bf16 v[84:87], v[196:199], a[32:35], v[84:87]
    buffer_load_dwordx4 v235, s[20:23], s45 offen  lds
    v_mfma_f32_16x16x32_bf16 v[92:95], v[196:199], a[36:39], v[92:95]
    ds_read_b64_tr_b16 v[182:183], v227 offset:59392
    v_mfma_f32_16x16x32_bf16 v[100:103], v[196:199], a[176:179], v[100:103]
    buffer_store_dwordx4 v[44:47], v236, s[48:51], s47 offen offset:256 sc1
    v_mfma_f32_16x16x32_bf16 v[108:111], v[196:199], a[180:183], v[108:111]
    s_waitcnt lgkmcnt(4)
    v_mfma_f32_16x16x32_bf16 v[80:83], v[208:211], a[40:43], v[80:83]
    ds_read_b64_tr_b16 v[192:193], v226 offset:53248
    v_mfma_f32_16x16x32_bf16 v[88:91], v[208:211], a[44:47], v[88:91]
    s_add_u32 m0, s40, 139264
    v_mfma_f32_16x16x32_bf16 v[96:99], v[208:211], a[184:187], v[96:99]
    ds_read_b64_tr_b16 v[194:195], v226 offset:55296
    v_mfma_f32_16x16x32_bf16 v[104:107], v[208:211], a[188:191], v[104:107]
    s_add_u32 s45, s38, 221824
    v_mfma_f32_16x16x32_bf16 v[84:87], v[212:215], a[40:43], v[84:87]
    ds_read_b64_tr_b16 v[196:197], v227 offset:53248
    v_mfma_f32_16x16x32_bf16 v[92:95], v[212:215], a[44:47], v[92:95]
    buffer_load_dwordx4 v235, s[20:23], s45 offen  lds
    v_mfma_f32_16x16x32_bf16 v[100:103], v[212:215], a[184:187], v[100:103]
    ds_read_b64_tr_b16 v[198:199], v227 offset:55296
    v_mfma_f32_16x16x32_bf16 v[108:111], v[212:215], a[188:191], v[108:111]
    s_waitcnt lgkmcnt(4)
    v_mfma_f32_16x16x32_bf16 v[80:83], v[176:179], a[48:51], v[80:83]
    ds_read_b64_tr_b16 v[208:209], v226 offset:49152
    v_mfma_f32_16x16x32_bf16 v[88:91], v[176:179], a[52:55], v[88:91]
    s_add_u32 m0, s40, 135168
    v_mfma_f32_16x16x32_bf16 v[96:99], v[176:179], a[192:195], v[96:99]
    ds_read_b64_tr_b16 v[210:211], v226 offset:51200
    v_mfma_f32_16x16x32_bf16 v[104:107], v[176:179], a[196:199], v[104:107]
    s_add_u32 s45, s38, 258688
    v_mfma_f32_16x16x32_bf16 v[84:87], v[180:183], a[48:51], v[84:87]
    ds_read_b64_tr_b16 v[212:213], v227 offset:49152
    v_mfma_f32_16x16x32_bf16 v[92:95], v[180:183], a[52:55], v[92:95]
    buffer_load_dwordx4 v235, s[20:23], s45 offen  lds
    v_mfma_f32_16x16x32_bf16 v[100:103], v[180:183], a[192:195], v[100:103]
    ds_read_b64_tr_b16 v[214:215], v227 offset:51200
    v_mfma_f32_16x16x32_bf16 v[108:111], v[180:183], a[196:199], v[108:111]
    s_waitcnt lgkmcnt(4)
    v_mfma_f32_16x16x32_bf16 v[80:83], v[192:195], a[56:59], v[80:83]
    ds_read_b64_tr_b16 v[176:177], v226 offset:20480
    v_mfma_f32_16x16x32_bf16 v[88:91], v[192:195], a[60:63], v[88:91]
    s_add_u32 m0, s40, 131072
    v_mfma_f32_16x16x32_bf16 v[96:99], v[192:195], a[200:203], v[96:99]
    ds_read_b64_tr_b16 v[178:179], v226 offset:22528
    v_mfma_f32_16x16x32_bf16 v[104:107], v[192:195], a[204:207], v[104:107]
    s_add_u32 s45, s39, 640
    v_mfma_f32_16x16x32_bf16 v[84:87], v[196:199], a[56:59], v[84:87]
    ds_read_b64_tr_b16 v[180:181], v227 offset:20480
    v_mfma_f32_16x16x32_bf16 v[92:95], v[196:199], a[60:63], v[92:95]
    buffer_load_dwordx4 v235, s[20:23], s45 offen  lds
    v_mfma_f32_16x16x32_bf16 v[100:103], v[196:199], a[200:203], v[100:103]
    ds_read_b64_tr_b16 v[182:183], v227 offset:22528
    v_mfma_f32_16x16x32_bf16 v[108:111], v[196:199], a[204:207], v[108:111]
    s_waitcnt lgkmcnt(4)
    v_mfma_f32_16x16x32_bf16 v[80:83], v[208:211], a[64:67], v[80:83]
    ds_read_b64_tr_b16 v[192:193], v226 offset:16384
    v_mfma_f32_16x16x32_bf16 v[88:91], v[208:211], a[68:71], v[88:91]
    s_add_u32 m0, s40, 57344
    v_mfma_f32_16x16x32_bf16 v[96:99], v[208:211], a[208:211], v[96:99]
    ds_read_b64_tr_b16 v[194:195], v226 offset:18432
    v_mfma_f32_16x16x32_bf16 v[104:107], v[208:211], a[212:215], v[104:107]
    s_add_u32 s45, s38, 768
    v_mfma_f32_16x16x32_bf16 v[84:87], v[212:215], a[64:67], v[84:87]
    ds_read_b64_tr_b16 v[196:197], v227 offset:16384
    v_mfma_f32_16x16x32_bf16 v[92:95], v[212:215], a[68:71], v[92:95]
    buffer_load_dwordx4 v235, s[20:23], s45 offen  lds
    v_mfma_f32_16x16x32_bf16 v[100:103], v[212:215], a[208:211], v[100:103]
    ds_read_b64_tr_b16 v[198:199], v227 offset:18432
    v_mfma_f32_16x16x32_bf16 v[108:111], v[212:215], a[212:215], v[108:111]
    s_waitcnt lgkmcnt(4)
    v_mfma_f32_16x16x32_bf16 v[112:115], v[176:179], a[0:3], 0
    ds_read_b64_tr_b16 v[208:209], v224 offset:32768
    v_mfma_f32_16x16x32_bf16 v[120:123], v[176:179], a[4:7], 0
    s_add_u32 m0, s40, 53248
    v_mfma_f32_16x16x32_bf16 v[128:131], v[176:179], a[144:147], 0
    ds_read_b64_tr_b16 v[210:211], v224 offset:34816
    v_mfma_f32_16x16x32_bf16 v[136:139], v[176:179], a[148:151], 0
    s_add_u32 s45, s38, 37632
    v_mfma_f32_16x16x32_bf16 v[116:119], v[180:183], a[0:3], 0
    ds_read_b64_tr_b16 v[212:213], v225 offset:32768
    v_mfma_f32_16x16x32_bf16 v[124:127], v[180:183], a[4:7], 0
    buffer_load_dwordx4 v235, s[20:23], s45 offen  lds
    v_mfma_f32_16x16x32_bf16 v[132:135], v[180:183], a[144:147], 0
    ds_read_b64_tr_b16 v[214:215], v225 offset:34816
    v_mfma_f32_16x16x32_bf16 v[140:143], v[180:183], a[148:151], 0
    s_waitcnt lgkmcnt(4)
    v_mfma_f32_16x16x32_bf16 v[112:115], v[192:195], a[8:11], v[112:115]
    ds_read_b64_tr_b16 v[176:177], v224 offset:28672
    v_cvt_pk_bf16_f32 v16, v80, v81
    v_mfma_f32_16x16x32_bf16 v[120:123], v[192:195], a[12:15], v[120:123]
    s_add_u32 m0, s40, 49152
    v_cvt_pk_bf16_f32 v17, v82, v83
    v_cvt_pk_bf16_f32 v18, v84, v85
    v_mfma_f32_16x16x32_bf16 v[128:131], v[192:195], a[152:155], v[128:131]
    s_add_u32 s45, s38, 74496
    ds_read_b64_tr_b16 v[178:179], v224 offset:30720
    v_mfma_f32_16x16x32_bf16 v[136:139], v[192:195], a[156:159], v[136:139]
    buffer_load_dwordx4 v235, s[20:23], s45 offen  lds
    v_mfma_f32_16x16x32_bf16 v[116:119], v[196:199], a[8:11], v[116:119]
    ds_read_b64_tr_b16 v[180:181], v225 offset:28672
    v_cvt_pk_bf16_f32 v19, v86, v87
    v_mfma_f32_16x16x32_bf16 v[124:127], v[196:199], a[12:15], v[124:127]
    s_add_u32 s46, s58, 8192
    ds_read_b64_tr_b16 v[182:183], v225 offset:30720
    v_mfma_f32_16x16x32_bf16 v[132:135], v[196:199], a[152:155], v[132:135]
    s_add_u32 s47, s59, 8192
    v_cvt_pk_bf16_f32 v20, v88, v89
    v_cvt_pk_bf16_f32 v21, v90, v91
    v_mfma_f32_16x16x32_bf16 v[140:143], v[196:199], a[156:159], v[140:143]
    s_waitcnt lgkmcnt(4)
    v_cvt_pk_bf16_f32 v22, v92, v93
    v_cvt_pk_bf16_f32 v23, v94, v95
    v_mfma_f32_16x16x32_bf16 v[112:115], v[208:211], a[16:19], v[112:115]
    ds_read_b64_tr_b16 v[192:193], v224 offset:24576
    s_add_u32 m0, s40, 45056
    v_mfma_f32_16x16x32_bf16 v[120:123], v[208:211], a[20:23], v[120:123]
    s_add_u32 s45, s38, 111360
    ds_read_b64_tr_b16 v[194:195], v224 offset:26624
    v_mfma_f32_16x16x32_bf16 v[128:131], v[208:211], a[160:163], v[128:131]
    buffer_load_dwordx4 v235, s[20:23], s45 offen  lds
    v_mfma_f32_16x16x32_bf16 v[136:139], v[208:211], a[164:167], v[136:139]
    ds_read_b64_tr_b16 v[196:197], v225 offset:24576
    v_cvt_pk_bf16_f32 v24, v96, v97
    v_mfma_f32_16x16x32_bf16 v[116:119], v[212:215], a[16:19], v[116:119]
    buffer_store_dwordx4 v[16:19], v236, s[48:51], s46 offen offset:0 sc1
    v_mfma_f32_16x16x32_bf16 v[124:127], v[212:215], a[20:23], v[124:127]
    ds_read_b64_tr_b16 v[198:199], v225 offset:26624
    v_cvt_pk_bf16_f32 v25, v98, v99
    v_mfma_f32_16x16x32_bf16 v[132:135], v[212:215], a[160:163], v[132:135]
    buffer_store_dwordx4 v[20:23], v236, s[48:51], s46 offen offset:256 sc1
    v_mfma_f32_16x16x32_bf16 v[140:143], v[212:215], a[164:167], v[140:143]
    s_waitcnt lgkmcnt(4)
    v_cvt_pk_bf16_f32 v26, v100, v101
    v_cvt_pk_bf16_f32 v27, v102, v103
    v_mfma_f32_16x16x32_bf16 v[112:115], v[176:179], a[24:27], v[112:115]
    s_waitcnt vmcnt(28)
    v_cvt_pk_bf16_f32 v28, v104, v105
    v_cvt_pk_bf16_f32 v29, v106, v107
    v_mfma_f32_16x16x32_bf16 v[120:123], v[176:179], a[28:31], v[120:123]
    s_barrier
    ds_read_b64_tr_b16 v[208:209], v224 offset:20480
    v_mfma_f32_16x16x32_bf16 v[128:131], v[176:179], a[168:171], v[128:131]
    s_add_u32 m0, s40, 126976
    ds_read_b64_tr_b16 v[210:211], v224 offset:22528
    v_mfma_f32_16x16x32_bf16 v[136:139], v[176:179], a[172:175], v[136:139]
    s_add_u32 s45, s38, 148224
    ds_read_b64_tr_b16 v[212:213], v225 offset:20480
    v_mfma_f32_16x16x32_bf16 v[116:119], v[180:183], a[24:27], v[116:119]
    buffer_load_dwordx4 v235, s[20:23], s45 offen  lds
    v_mfma_f32_16x16x32_bf16 v[124:127], v[180:183], a[28:31], v[124:127]
    ds_read_b64_tr_b16 v[214:215], v225 offset:22528
    v_cvt_pk_bf16_f32 v30, v108, v109
    v_mfma_f32_16x16x32_bf16 v[132:135], v[180:183], a[168:171], v[132:135]
    buffer_store_dwordx4 v[24:27], v236, s[48:51], s47 offen offset:0 sc1
    v_mfma_f32_16x16x32_bf16 v[140:143], v[180:183], a[172:175], v[140:143]
    s_waitcnt lgkmcnt(4)
    v_cvt_pk_bf16_f32 v31, v110, v111
    v_mfma_f32_16x16x32_bf16 v[112:115], v[192:195], a[32:35], v[112:115]
    ds_read_b64_tr_b16 v[176:177], v226 offset:45056
    v_mfma_f32_16x16x32_bf16 v[120:123], v[192:195], a[36:39], v[120:123]
    s_add_u32 m0, s40, 122880
    v_mfma_f32_16x16x32_bf16 v[128:131], v[192:195], a[176:179], v[128:131]
    ds_read_b64_tr_b16 v[178:179], v226 offset:47104
    v_mfma_f32_16x16x32_bf16 v[136:139], v[192:195], a[180:183], v[136:139]
    s_add_u32 s45, s38, 185088
    ds_read_b64_tr_b16 v[180:181], v227 offset:45056
    v_mfma_f32_16x16x32_bf16 v[116:119], v[196:199], a[32:35], v[116:119]
    buffer_load_dwordx4 v235, s[20:23], s45 offen  lds
    v_mfma_f32_16x16x32_bf16 v[124:127], v[196:199], a[36:39], v[124:127]
    ds_read_b64_tr_b16 v[182:183], v227 offset:47104
    v_mfma_f32_16x16x32_bf16 v[132:135], v[196:199], a[176:179], v[132:135]
    buffer_store_dwordx4 v[28:31], v236, s[48:51], s47 offen offset:256 sc1
    v_mfma_f32_16x16x32_bf16 v[140:143], v[196:199], a[180:183], v[140:143]
    s_waitcnt lgkmcnt(4)
    v_mfma_f32_16x16x32_bf16 v[112:115], v[208:211], a[40:43], v[112:115]
    ds_read_b64_tr_b16 v[192:193], v226 offset:40960
    v_mfma_f32_16x16x32_bf16 v[120:123], v[208:211], a[44:47], v[120:123]
    s_add_u32 m0, s40, 118784
    v_mfma_f32_16x16x32_bf16 v[128:131], v[208:211], a[184:187], v[128:131]
    ds_read_b64_tr_b16 v[194:195], v226 offset:43008
    v_mfma_f32_16x16x32_bf16 v[136:139], v[208:211], a[188:191], v[136:139]
    s_add_u32 s45, s38, 221952
    v_mfma_f32_16x16x32_bf16 v[116:119], v[212:215], a[40:43], v[116:119]
    ds_read_b64_tr_b16 v[196:197], v227 offset:40960
    v_mfma_f32_16x16x32_bf16 v[124:127], v[212:215], a[44:47], v[124:127]
    buffer_load_dwordx4 v235, s[20:23], s45 offen  lds
    v_mfma_f32_16x16x32_bf16 v[132:135], v[212:215], a[184:187], v[132:135]
    ds_read_b64_tr_b16 v[198:199], v227 offset:43008
    v_mfma_f32_16x16x32_bf16 v[140:143], v[212:215], a[188:191], v[140:143]
    s_waitcnt lgkmcnt(4)
    v_mfma_f32_16x16x32_bf16 v[112:115], v[176:179], a[48:51], v[112:115]
    ds_read_b64_tr_b16 v[208:209], v226 offset:36864
    v_mfma_f32_16x16x32_bf16 v[120:123], v[176:179], a[52:55], v[120:123]
    s_add_u32 m0, s40, 114688
    v_mfma_f32_16x16x32_bf16 v[128:131], v[176:179], a[192:195], v[128:131]
    ds_read_b64_tr_b16 v[210:211], v226 offset:38912
    v_mfma_f32_16x16x32_bf16 v[136:139], v[176:179], a[196:199], v[136:139]
    s_add_u32 s45, s38, 258816
    v_mfma_f32_16x16x32_bf16 v[116:119], v[180:183], a[48:51], v[116:119]
    ds_read_b64_tr_b16 v[212:213], v227 offset:36864
    v_mfma_f32_16x16x32_bf16 v[124:127], v[180:183], a[52:55], v[124:127]
    buffer_load_dwordx4 v235, s[20:23], s45 offen  lds
    v_mfma_f32_16x16x32_bf16 v[132:135], v[180:183], a[192:195], v[132:135]
    ds_read_b64_tr_b16 v[214:215], v227 offset:38912
    v_mfma_f32_16x16x32_bf16 v[140:143], v[180:183], a[196:199], v[140:143]
    s_waitcnt lgkmcnt(4)
    v_mfma_f32_16x16x32_bf16 v[112:115], v[192:195], a[56:59], v[112:115]
    ds_read_b64_tr_b16 v[176:177], v226 offset:32768
    v_mfma_f32_16x16x32_bf16 v[120:123], v[192:195], a[60:63], v[120:123]
    s_add_u32 m0, s40, 86016
    v_mfma_f32_16x16x32_bf16 v[128:131], v[192:195], a[200:203], v[128:131]
    ds_read_b64_tr_b16 v[178:179], v226 offset:34816
    v_mfma_f32_16x16x32_bf16 v[136:139], v[192:195], a[204:207], v[136:139]
    s_add_u32 s45, s39, 768
    v_mfma_f32_16x16x32_bf16 v[116:119], v[196:199], a[56:59], v[116:119]
    ds_read_b64_tr_b16 v[180:181], v227 offset:32768
    v_mfma_f32_16x16x32_bf16 v[124:127], v[196:199], a[60:63], v[124:127]
    buffer_load_dwordx4 v235, s[20:23], s45 offen  lds
    v_mfma_f32_16x16x32_bf16 v[132:135], v[196:199], a[200:203], v[132:135]
    ds_read_b64_tr_b16 v[182:183], v227 offset:34816
    v_mfma_f32_16x16x32_bf16 v[140:143], v[196:199], a[204:207], v[140:143]
    s_waitcnt lgkmcnt(4)
    v_mfma_f32_16x16x32_bf16 v[112:115], v[208:211], a[64:67], v[112:115]
    ds_read_b64_tr_b16 v[192:193], v226 offset:12288
    v_mfma_f32_16x16x32_bf16 v[120:123], v[208:211], a[68:71], v[120:123]
    s_add_u32 m0, s40, 81920
    v_mfma_f32_16x16x32_bf16 v[128:131], v[208:211], a[208:211], v[128:131]
    ds_read_b64_tr_b16 v[194:195], v226 offset:14336
    v_mfma_f32_16x16x32_bf16 v[136:139], v[208:211], a[212:215], v[136:139]
    s_add_u32 s45, s38, 896
    v_mfma_f32_16x16x32_bf16 v[116:119], v[212:215], a[64:67], v[116:119]
    ds_read_b64_tr_b16 v[196:197], v227 offset:12288
    v_mfma_f32_16x16x32_bf16 v[124:127], v[212:215], a[68:71], v[124:127]
    buffer_load_dwordx4 v235, s[20:23], s45 offen  lds
    v_mfma_f32_16x16x32_bf16 v[132:135], v[212:215], a[208:211], v[132:135]
    ds_read_b64_tr_b16 v[198:199], v227 offset:14336
    v_mfma_f32_16x16x32_bf16 v[140:143], v[212:215], a[212:215], v[140:143]
    s_waitcnt lgkmcnt(4)
    v_mfma_f32_16x16x32_bf16 v[80:83], v[176:179], a[0:3], 0
    ds_read_b64_tr_b16 v[208:209], v226 offset:8192
    v_mfma_f32_16x16x32_bf16 v[88:91], v[176:179], a[4:7], 0
    s_add_u32 m0, s40, 40960
    v_mfma_f32_16x16x32_bf16 v[96:99], v[176:179], a[144:147], 0
    ds_read_b64_tr_b16 v[210:211], v226 offset:10240
    v_mfma_f32_16x16x32_bf16 v[104:107], v[176:179], a[148:151], 0
    s_add_u32 s45, s38, 37760
    v_mfma_f32_16x16x32_bf16 v[84:87], v[180:183], a[0:3], 0
    ds_read_b64_tr_b16 v[212:213], v227 offset:8192
    v_mfma_f32_16x16x32_bf16 v[92:95], v[180:183], a[4:7], 0
    buffer_load_dwordx4 v235, s[20:23], s45 offen  lds
    v_mfma_f32_16x16x32_bf16 v[100:103], v[180:183], a[144:147], 0
    ds_read_b64_tr_b16 v[214:215], v227 offset:10240
    v_mfma_f32_16x16x32_bf16 v[108:111], v[180:183], a[148:151], 0
    s_waitcnt lgkmcnt(4)
    v_mfma_f32_16x16x32_bf16 v[80:83], v[192:195], a[8:11], v[80:83]
    ds_read_b64_tr_b16 v[176:177], v226 offset:4096
    v_cvt_pk_bf16_f32 v32, v112, v113
    v_mfma_f32_16x16x32_bf16 v[88:91], v[192:195], a[12:15], v[88:91]
    s_add_u32 m0, s40, 36864
    v_cvt_pk_bf16_f32 v33, v114, v115
    v_cvt_pk_bf16_f32 v34, v116, v117
    v_mfma_f32_16x16x32_bf16 v[96:99], v[192:195], a[152:155], v[96:99]
    s_add_u32 s45, s38, 74624
    ds_read_b64_tr_b16 v[178:179], v226 offset:6144
    v_mfma_f32_16x16x32_bf16 v[104:107], v[192:195], a[156:159], v[104:107]
    buffer_load_dwordx4 v235, s[20:23], s45 offen  lds
    v_mfma_f32_16x16x32_bf16 v[84:87], v[196:199], a[8:11], v[84:87]
    ds_read_b64_tr_b16 v[180:181], v227 offset:4096
    v_cvt_pk_bf16_f32 v35, v118, v119
    v_mfma_f32_16x16x32_bf16 v[92:95], v[196:199], a[12:15], v[92:95]
    s_add_u32 s46, s58, 12288
    ds_read_b64_tr_b16 v[182:183], v227 offset:6144
    v_mfma_f32_16x16x32_bf16 v[100:103], v[196:199], a[152:155], v[100:103]
    s_add_u32 s47, s59, 12288
    v_cvt_pk_bf16_f32 v36, v120, v121
    v_cvt_pk_bf16_f32 v37, v122, v123
    v_mfma_f32_16x16x32_bf16 v[108:111], v[196:199], a[156:159], v[108:111]
    s_waitcnt lgkmcnt(4)
    v_cvt_pk_bf16_f32 v38, v124, v125
    v_cvt_pk_bf16_f32 v39, v126, v127
    v_mfma_f32_16x16x32_bf16 v[80:83], v[208:211], a[16:19], v[80:83]
    s_waitcnt vmcnt(26)
    s_barrier
    v_cvt_pk_bf16_f32 v40, v128, v129
    v_mfma_f32_16x16x32_bf16 v[88:91], v[208:211], a[20:23], v[88:91]
    ds_read_b64_tr_b16 v[192:193], v224 offset:16384
    s_add_u32 m0, s40, 110592
    v_mfma_f32_16x16x32_bf16 v[96:99], v[208:211], a[160:163], v[96:99]
    s_add_u32 s45, s38, 111488
    ds_read_b64_tr_b16 v[194:195], v224 offset:18432
    v_mfma_f32_16x16x32_bf16 v[104:107], v[208:211], a[164:167], v[104:107]
    buffer_load_dwordx4 v235, s[20:23], s45 offen  lds
    v_mfma_f32_16x16x32_bf16 v[84:87], v[212:215], a[16:19], v[84:87]
    ds_read_b64_tr_b16 v[196:197], v225 offset:16384
    v_cvt_pk_bf16_f32 v41, v130, v131
    v_mfma_f32_16x16x32_bf16 v[92:95], v[212:215], a[20:23], v[92:95]
    buffer_store_dwordx4 v[32:35], v236, s[48:51], s46 offen offset:0 sc1
    v_mfma_f32_16x16x32_bf16 v[100:103], v[212:215], a[160:163], v[100:103]
    ds_read_b64_tr_b16 v[198:199], v225 offset:18432
    buffer_store_dwordx4 v[36:39], v236, s[48:51], s46 offen offset:256 sc1
    v_mfma_f32_16x16x32_bf16 v[108:111], v[212:215], a[164:167], v[108:111]
    s_waitcnt lgkmcnt(4)
    v_cvt_pk_bf16_f32 v42, v132, v133
    v_cvt_pk_bf16_f32 v43, v134, v135
    v_mfma_f32_16x16x32_bf16 v[80:83], v[176:179], a[24:27], v[80:83]
    ds_read_b64_tr_b16 v[208:209], v224 offset:12288
    v_cvt_pk_bf16_f32 v44, v136, v137
    v_mfma_f32_16x16x32_bf16 v[88:91], v[176:179], a[28:31], v[88:91]
    s_add_u32 m0, s40, 106496
    v_cvt_pk_bf16_f32 v45, v138, v139
    v_cvt_pk_bf16_f32 v46, v140, v141
    v_mfma_f32_16x16x32_bf16 v[96:99], v[176:179], a[168:171], v[96:99]
    ds_read_b64_tr_b16 v[210:211], v224 offset:14336
    v_cvt_pk_bf16_f32 v47, v142, v143
    v_mfma_f32_16x16x32_bf16 v[104:107], v[176:179], a[172:175], v[104:107]
    s_add_u32 s45, s38, 148352
    ds_read_b64_tr_b16 v[212:213], v225 offset:12288
    v_mfma_f32_16x16x32_bf16 v[84:87], v[180:183], a[24:27], v[84:87]
    buffer_load_dwordx4 v235, s[20:23], s45 offen  lds
    v_mfma_f32_16x16x32_bf16 v[92:95], v[180:183], a[28:31], v[92:95]
    ds_read_b64_tr_b16 v[214:215], v225 offset:14336
    v_mfma_f32_16x16x32_bf16 v[100:103], v[180:183], a[168:171], v[100:103]
    buffer_store_dwordx4 v[40:43], v236, s[48:51], s47 offen offset:0 sc1
    v_mfma_f32_16x16x32_bf16 v[108:111], v[180:183], a[172:175], v[108:111]
    s_waitcnt lgkmcnt(4)
    v_mfma_f32_16x16x32_bf16 v[80:83], v[192:195], a[32:35], v[80:83]
    ds_read_b64_tr_b16 v[176:177], v228 offset:28672
    v_mfma_f32_16x16x32_bf16 v[88:91], v[192:195], a[36:39], v[88:91]
    s_add_u32 m0, s40, 102400
    v_mfma_f32_16x16x32_bf16 v[96:99], v[192:195], a[176:179], v[96:99]
    ds_read_b64_tr_b16 v[178:179], v228 offset:30720
    v_mfma_f32_16x16x32_bf16 v[104:107], v[192:195], a[180:183], v[104:107]
    s_add_u32 s45, s38, 185216
    ds_read_b64_tr_b16 v[180:181], v229 offset:28672
    v_mfma_f32_16x16x32_bf16 v[84:87], v[196:199], a[32:35], v[84:87]
    buffer_load_dwordx4 v235, s[20:23], s45 offen  lds
    v_mfma_f32_16x16x32_bf16 v[92:95], v[196:199], a[36:39], v[92:95]
    ds_read_b64_tr_b16 v[182:183], v229 offset:30720
    v_mfma_f32_16x16x32_bf16 v[100:103], v[196:199], a[176:179], v[100:103]
    buffer_store_dwordx4 v[44:47], v236, s[48:51], s47 offen offset:256 sc1
    v_mfma_f32_16x16x32_bf16 v[108:111], v[196:199], a[180:183], v[108:111]
    s_waitcnt lgkmcnt(4)
    v_mfma_f32_16x16x32_bf16 v[80:83], v[208:211], a[40:43], v[80:83]
    ds_read_b64_tr_b16 v[192:193], v228 offset:24576
    v_mfma_f32_16x16x32_bf16 v[88:91], v[208:211], a[44:47], v[88:91]
    s_add_u32 m0, s40, 98304
    v_mfma_f32_16x16x32_bf16 v[96:99], v[208:211], a[184:187], v[96:99]
    ds_read_b64_tr_b16 v[194:195], v228 offset:26624
    v_mfma_f32_16x16x32_bf16 v[104:107], v[208:211], a[188:191], v[104:107]
    s_add_u32 s45, s38, 222080
    v_mfma_f32_16x16x32_bf16 v[84:87], v[212:215], a[40:43], v[84:87]
    ds_read_b64_tr_b16 v[196:197], v229 offset:24576
    v_mfma_f32_16x16x32_bf16 v[92:95], v[212:215], a[44:47], v[92:95]
    buffer_load_dwordx4 v235, s[20:23], s45 offen  lds
    v_mfma_f32_16x16x32_bf16 v[100:103], v[212:215], a[184:187], v[100:103]
    ds_read_b64_tr_b16 v[198:199], v229 offset:26624
    v_mfma_f32_16x16x32_bf16 v[108:111], v[212:215], a[188:191], v[108:111]
    s_waitcnt lgkmcnt(4)
    v_mfma_f32_16x16x32_bf16 v[80:83], v[176:179], a[48:51], v[80:83]
    ds_read_b64_tr_b16 v[208:209], v228 offset:20480
    v_mfma_f32_16x16x32_bf16 v[88:91], v[176:179], a[52:55], v[88:91]
    s_add_u32 m0, s40, 77824
    v_mfma_f32_16x16x32_bf16 v[96:99], v[176:179], a[192:195], v[96:99]
    ds_read_b64_tr_b16 v[210:211], v228 offset:22528
    v_mfma_f32_16x16x32_bf16 v[104:107], v[176:179], a[196:199], v[104:107]
    s_add_u32 s45, s38, 258944
    v_mfma_f32_16x16x32_bf16 v[84:87], v[180:183], a[48:51], v[84:87]
    ds_read_b64_tr_b16 v[212:213], v229 offset:20480
    v_mfma_f32_16x16x32_bf16 v[92:95], v[180:183], a[52:55], v[92:95]
    buffer_load_dwordx4 v235, s[20:23], s45 offen  lds
    v_mfma_f32_16x16x32_bf16 v[100:103], v[180:183], a[192:195], v[100:103]
    ds_read_b64_tr_b16 v[214:215], v229 offset:22528
    v_mfma_f32_16x16x32_bf16 v[108:111], v[180:183], a[196:199], v[108:111]
    s_waitcnt lgkmcnt(4)
    v_mfma_f32_16x16x32_bf16 v[80:83], v[192:195], a[56:59], v[80:83]
    ds_read_b64_tr_b16 v[176:177], v228 offset:16384
    v_mfma_f32_16x16x32_bf16 v[88:91], v[192:195], a[60:63], v[88:91]
    s_add_u32 m0, s40, 73728
    v_mfma_f32_16x16x32_bf16 v[96:99], v[192:195], a[200:203], v[96:99]
    ds_read_b64_tr_b16 v[178:179], v228 offset:18432
    v_mfma_f32_16x16x32_bf16 v[104:107], v[192:195], a[204:207], v[104:107]
    s_add_u32 s45, s39, 896
    v_mfma_f32_16x16x32_bf16 v[84:87], v[196:199], a[56:59], v[84:87]
    ds_read_b64_tr_b16 v[180:181], v229 offset:16384
    v_mfma_f32_16x16x32_bf16 v[92:95], v[196:199], a[60:63], v[92:95]
    buffer_load_dwordx4 v235, s[20:23], s45 offen  lds
    v_mfma_f32_16x16x32_bf16 v[100:103], v[196:199], a[200:203], v[100:103]
    ds_read_b64_tr_b16 v[182:183], v229 offset:18432
    v_mfma_f32_16x16x32_bf16 v[108:111], v[196:199], a[204:207], v[108:111]
    s_waitcnt lgkmcnt(4)
    v_mfma_f32_16x16x32_bf16 v[80:83], v[208:211], a[64:67], v[80:83]
    ds_read_b64_tr_b16 v[192:193], v226 offset:28672
    v_mfma_f32_16x16x32_bf16 v[88:91], v[208:211], a[68:71], v[88:91]
    s_add_u32 m0, s40, 32768
    v_mfma_f32_16x16x32_bf16 v[96:99], v[208:211], a[208:211], v[96:99]
    ds_read_b64_tr_b16 v[194:195], v226 offset:30720
    v_mfma_f32_16x16x32_bf16 v[104:107], v[208:211], a[212:215], v[104:107]
    s_add_u32 s45, s38, 1024
    v_mfma_f32_16x16x32_bf16 v[84:87], v[212:215], a[64:67], v[84:87]
    ds_read_b64_tr_b16 v[196:197], v227 offset:28672
    v_mfma_f32_16x16x32_bf16 v[92:95], v[212:215], a[68:71], v[92:95]
    buffer_load_dwordx4 v235, s[20:23], s45 offen  lds
    v_mfma_f32_16x16x32_bf16 v[100:103], v[212:215], a[208:211], v[100:103]
    ds_read_b64_tr_b16 v[198:199], v227 offset:30720
    v_mfma_f32_16x16x32_bf16 v[108:111], v[212:215], a[212:215], v[108:111]
    s_waitcnt lgkmcnt(4)
    v_mfma_f32_16x16x32_bf16 v[112:115], v[176:179], a[0:3], 0
    ds_read_b64_tr_b16 v[208:209], v226 offset:24576
    v_mfma_f32_16x16x32_bf16 v[120:123], v[176:179], a[4:7], 0
    s_add_u32 m0, s40, 28672
    v_mfma_f32_16x16x32_bf16 v[128:131], v[176:179], a[144:147], 0
    ds_read_b64_tr_b16 v[210:211], v226 offset:26624
    v_mfma_f32_16x16x32_bf16 v[136:139], v[176:179], a[148:151], 0
    s_add_u32 s45, s38, 37888
    v_mfma_f32_16x16x32_bf16 v[116:119], v[180:183], a[0:3], 0
    ds_read_b64_tr_b16 v[212:213], v227 offset:24576
    v_mfma_f32_16x16x32_bf16 v[124:127], v[180:183], a[4:7], 0
    buffer_load_dwordx4 v235, s[20:23], s45 offen  lds
    v_mfma_f32_16x16x32_bf16 v[132:135], v[180:183], a[144:147], 0
    ds_read_b64_tr_b16 v[214:215], v227 offset:26624
    v_mfma_f32_16x16x32_bf16 v[140:143], v[180:183], a[148:151], 0
    s_waitcnt lgkmcnt(4)
    v_mfma_f32_16x16x32_bf16 v[112:115], v[192:195], a[8:11], v[112:115]
    s_waitcnt vmcnt(26)
    v_cvt_pk_bf16_f32 v16, v80, v81
    v_cvt_pk_bf16_f32 v17, v82, v83
    v_mfma_f32_16x16x32_bf16 v[120:123], v[192:195], a[12:15], v[120:123]
    s_barrier
    ds_read_b64_tr_b16 v[176:177], v226 offset:0
    v_mfma_f32_16x16x32_bf16 v[128:131], v[192:195], a[152:155], v[128:131]
    s_add_u32 m0, s40, 159744
    v_cvt_pk_bf16_f32 v18, v84, v85
    v_cvt_pk_bf16_f32 v19, v86, v87
    v_mfma_f32_16x16x32_bf16 v[136:139], v[192:195], a[156:159], v[136:139]
    s_add_u32 s45, s38, 74752
    ds_read_b64_tr_b16 v[178:179], v226 offset:2048
    v_mfma_f32_16x16x32_bf16 v[116:119], v[196:199], a[8:11], v[116:119]
    buffer_load_dwordx4 v235, s[20:23], s45 offen  lds
    v_mfma_f32_16x16x32_bf16 v[124:127], v[196:199], a[12:15], v[124:127]
    ds_read_b64_tr_b16 v[180:181], v227 offset:0
    s_add_u32 s46, s58, 16384
    v_mfma_f32_16x16x32_bf16 v[132:135], v[196:199], a[152:155], v[132:135]
    ds_read_b64_tr_b16 v[182:183], v227 offset:2048
    s_add_u32 s47, s59, 16384
    v_mfma_f32_16x16x32_bf16 v[140:143], v[196:199], a[156:159], v[140:143]
    s_waitcnt lgkmcnt(4)
    v_cvt_pk_bf16_f32 v20, v88, v89
    v_cvt_pk_bf16_f32 v21, v90, v91
    v_mfma_f32_16x16x32_bf16 v[112:115], v[208:211], a[16:19], v[112:115]
    s_waitcnt vmcnt(6)
    s_barrier
    v_cvt_pk_bf16_f32 v22, v92, v93
    v_mfma_f32_16x16x32_bf16 v[120:123], v[208:211], a[20:23], v[120:123]
    s_cmp_lg_u32 s28, 0
    s_cbranch_scc1 K3_SA1
    s_mov_b64 exec, 1
    buffer_atomic_add v254, v250, s[60:63], s68 offen offset:0 sc1
    s_mov_b64 exec, -1
K3_SA1:
    ds_read_b64_tr_b16 v[192:193], v224 offset:61440
    v_mfma_f32_16x16x32_bf16 v[128:131], v[208:211], a[160:163], v[128:131]
    s_add_u32 m0, s40, 155648
    ds_read_b64_tr_b16 v[194:195], v224 offset:63488
    v_mfma_f32_16x16x32_bf16 v[136:139], v[208:211], a[164:167], v[136:139]
    s_add_u32 s45, s38, 111616
    ds_read_b64_tr_b16 v[196:197], v225 offset:61440
    v_mfma_f32_16x16x32_bf16 v[116:119], v[212:215], a[16:19], v[116:119]
    buffer_load_dwordx4 v235, s[20:23], s45 offen  lds
    v_mfma_f32_16x16x32_bf16 v[124:127], v[212:215], a[20:23], v[124:127]
    ds_read_b64_tr_b16 v[198:199], v225 offset:63488
    v_cvt_pk_bf16_f32 v23, v94, v95
    v_mfma_f32_16x16x32_bf16 v[132:135], v[212:215], a[160:163], v[132:135]
    buffer_store_dwordx4 v[16:19], v236, s[48:51], s46 offen offset:0 sc1
    v_mfma_f32_16x16x32_bf16 v[140:143], v[212:215], a[164:167], v[140:143]
    s_waitcnt lgkmcnt(4)
    v_cvt_pk_bf16_f32 v24, v96, v97
    v_cvt_pk_bf16_f32 v25, v98, v99
    v_mfma_f32_16x16x32_bf16 v[112:115], v[176:179], a[24:27], v[112:115]
    ds_read_b64_tr_b16 v[208:209], v228 offset:12288
    v_cvt_pk_bf16_f32 v26, v100, v101
    v_mfma_f32_16x16x32_bf16 v[120:123], v[176:179], a[28:31], v[120:123]
    s_add_u32 m0, s40, 151552
    v_cvt_pk_bf16_f32 v27, v102, v103
    v_cvt_pk_bf16_f32 v28, v104, v105
    v_mfma_f32_16x16x32_bf16 v[128:131], v[176:179], a[168:171], v[128:131]
    ds_read_b64_tr_b16 v[210:211], v228 offset:14336
    v_cvt_pk_bf16_f32 v29, v106, v107
    v_mfma_f32_16x16x32_bf16 v[136:139], v[176:179], a[172:175], v[136:139]
    s_add_u32 s45, s38, 148480
    ds_read_b64_tr_b16 v[212:213], v229 offset:12288
    v_mfma_f32_16x16x32_bf16 v[116:119], v[180:183], a[24:27], v[116:119]
    buffer_load_dwordx4 v235, s[20:23], s45 offen  lds
    v_mfma_f32_16x16x32_bf16 v[124:127], v[180:183], a[28:31], v[124:127]
    ds_read_b64_tr_b16 v[214:215], v229 offset:14336
    v_cvt_pk_bf16_f32 v30, v108, v109
    v_mfma_f32_16x16x32_bf16 v[132:135], v[180:183], a[168:171], v[132:135]
    buffer_store_dwordx4 v[20:23], v236, s[48:51], s46 offen offset:256 sc1
    v_mfma_f32_16x16x32_bf16 v[140:143], v[180:183], a[172:175], v[140:143]
    s_waitcnt lgkmcnt(4)
    v_cvt_pk_bf16_f32 v31, v110, v111
    v_mfma_f32_16x16x32_bf16 v[112:115], v[192:195], a[32:35], v[112:115]
    ds_read_b64_tr_b16 v[176:177], v228 offset:8192
    s_add_u32 m0, s40, 147456
    v_mfma_f32_16x16x32_bf16 v[120:123], v[192:195], a[36:39], v[120:123]
    s_add_u32 s45, s38, 185344
    ds_read_b64_tr_b16 v[178:179], v228 offset:10240
    v_mfma_f32_16x16x32_bf16 v[128:131], v[192:195], a[176:179], v[128:131]
    buffer_load_dwordx4 v235, s[20:23], s45 offen  lds
    v_mfma_f32_16x16x32_bf16 v[136:139], v[192:195], a[180:183], v[136:139]
    ds_read_b64_tr_b16 v[180:181], v229 offset:8192
    v_mfma_f32_16x16x32_bf16 v[116:119], v[196:199], a[32:35], v[116:119]
    buffer_store_dwordx4 v[24:27], v236, s[48:51], s47 offen offset:0 sc1
    v_mfma_f32_16x16x32_bf16 v[124:127], v[196:199], a[36:39], v[124:127]
    ds_read_b64_tr_b16 v[182:183], v229 offset:10240
    v_mfma_f32_16x16x32_bf16 v[132:135], v[196:199], a[176:179], v[132:135]
    buffer_store_dwordx4 v[28:31], v236, s[48:51], s47 offen offset:256 sc1
    v_mfma_f32_16x16x32_bf16 v[140:143], v[196:199], a[180:183], v[140:143]
    s_waitcnt lgkmcnt(4)
    v_mfma_f32_16x16x32_bf16 v[112:115], v[208:211], a[40:43], v[112:115]
    ds_read_b64_tr_b16 v[192:193], v228 offset:4096
    v_mfma_f32_16x16x32_bf16 v[120:123], v[208:211], a[44:47], v[120:123]
    s_add_u32 m0, s40, 94208
    v_mfma_f32_16x16x32_bf16 v[128:131], v[208:211], a[184:187], v[128:131]
    ds_read_b64_tr_b16 v[194:195], v228 offset:6144
    v_mfma_f32_16x16x32_bf16 v[136:139], v[208:211], a[188:191], v[136:139]
    s_add_u32 s45, s38, 222208
    v_mfma_f32_16x16x32_bf16 v[116:119], v[212:215], a[40:43], v[116:119]
    ds_read_b64_tr_b16 v[196:197], v229 offset:4096
    v_mfma_f32_16x16x32_bf16 v[124:127], v[212:215], a[44:47], v[124:127]
    buffer_load_dwordx4 v235, s[20:23], s45 offen  lds
    v_mfma_f32_16x16x32_bf16 v[132:135], v[212:215], a[184:187], v[132:135]
    ds_read_b64_tr_b16 v[198:199], v229 offset:6144
    v_mfma_f32_16x16x32_bf16 v[140:143], v[212:215], a[188:191], v[140:143]
    s_waitcnt lgkmcnt(4)
    v_mfma_f32_16x16x32_bf16 v[112:115], v[176:179], a[48:51], v[112:115]
    ds_read_b64_tr_b16 v[208:209], v228 offset:0
    v_mfma_f32_16x16x32_bf16 v[120:123], v[176:179], a[52:55], v[120:123]
    s_add_u32 m0, s40, 90112
    v_mfma_f32_16x16x32_bf16 v[128:131], v[176:179], a[192:195], v[128:131]
    ds_read_b64_tr_b16 v[210:211], v228 offset:2048
    v_mfma_f32_16x16x32_bf16 v[136:139], v[176:179], a[196:199], v[136:139]
    s_add_u32 s45, s38, 259072
    v_mfma_f32_16x16x32_bf16 v[116:119], v[180:183], a[48:51], v[116:119]
    ds_read_b64_tr_b16 v[212:213], v229 offset:0
    v_mfma_f32_16x16x32_bf16 v[124:127], v[180:183], a[52:55], v[124:127]
    buffer_load_dwordx4 v235, s[20:23], s45 offen  lds
    v_mfma_f32_16x16x32_bf16 v[132:135], v[180:183], a[192:195], v[132:135]
    ds_read_b64_tr_b16 v[214:215], v229 offset:2048
    v_mfma_f32_16x16x32_bf16 v[140:143], v[180:183], a[196:199], v[140:143]
    s_waitcnt lgkmcnt(4)
    v_mfma_f32_16x16x32_bf16 v[112:115], v[192:195], a[56:59], v[112:115]
    ds_read_b64_tr_b16 v[176:177], v224 offset:57344
    v_mfma_f32_16x16x32_bf16 v[120:123], v[192:195], a[60:63], v[120:123]
    s_add_u32 m0, s40, 69632
    v_mfma_f32_16x16x32_bf16 v[128:131], v[192:195], a[200:203], v[128:131]
    ds_read_b64_tr_b16 v[178:179], v224 offset:59392
    v_mfma_f32_16x16x32_bf16 v[136:139], v[192:195], a[204:207], v[136:139]
    s_add_u32 s45, s39, 1024
    v_mfma_f32_16x16x32_bf16 v[116:119], v[196:199], a[56:59], v[116:119]
    ds_read_b64_tr_b16 v[180:181], v225 offset:57344
    v_mfma_f32_16x16x32_bf16 v[124:127], v[196:199], a[60:63], v[124:127]
    buffer_load_dwordx4 v235, s[20:23], s45 offen  lds
    v_mfma_f32_16x16x32_bf16 v[132:135], v[196:199], a[200:203], v[132:135]
    ds_read_b64_tr_b16 v[182:183], v225 offset:59392
    v_mfma_f32_16x16x32_bf16 v[140:143], v[196:199], a[204:207], v[140:143]
    s_waitcnt lgkmcnt(4)
    v_mfma_f32_16x16x32_bf16 v[112:115], v[208:211], a[64:67], v[112:115]
    ds_read_b64_tr_b16 v[192:193], v224 offset:53248
    v_mfma_f32_16x16x32_bf16 v[120:123], v[208:211], a[68:71], v[120:123]
    v_mfma_f32_16x16x32_bf16 v[128:131], v[208:211], a[208:211], v[128:131]
    ds_read_b64_tr_b16 v[194:195], v224 offset:55296
    v_mfma_f32_16x16x32_bf16 v[136:139], v[208:211], a[212:215], v[136:139]
    v_mfma_f32_16x16x32_bf16 v[116:119], v[212:215], a[64:67], v[116:119]
    ds_read_b64_tr_b16 v[196:197], v225 offset:53248
    v_mfma_f32_16x16x32_bf16 v[124:127], v[212:215], a[68:71], v[124:127]
    v_mfma_f32_16x16x32_bf16 v[132:135], v[212:215], a[208:211], v[132:135]
    ds_read_b64_tr_b16 v[198:199], v225 offset:55296
    v_mfma_f32_16x16x32_bf16 v[140:143], v[212:215], a[212:215], v[140:143]
    s_waitcnt lgkmcnt(4)
    v_mfma_f32_16x16x32_bf16 v[80:83], v[176:179], a[0:3], 0
    ds_read_b64_tr_b16 v[208:209], v224 offset:49152
    v_mfma_f32_16x16x32_bf16 v[88:91], v[176:179], a[4:7], 0
    v_mfma_f32_16x16x32_bf16 v[96:99], v[176:179], a[144:147], 0
    ds_read_b64_tr_b16 v[210:211], v224 offset:51200
    v_mfma_f32_16x16x32_bf16 v[104:107], v[176:179], a[148:151], 0
    v_mfma_f32_16x16x32_bf16 v[84:87], v[180:183], a[0:3], 0
    ds_read_b64_tr_b16 v[212:213], v225 offset:49152
    v_mfma_f32_16x16x32_bf16 v[92:95], v[180:183], a[4:7], 0
    v_mfma_f32_16x16x32_bf16 v[100:103], v[180:183], a[144:147], 0
    ds_read_b64_tr_b16 v[214:215], v225 offset:51200
    v_mfma_f32_16x16x32_bf16 v[108:111], v[180:183], a[148:151], 0
    s_waitcnt lgkmcnt(4)
    v_mfma_f32_16x16x32_bf16 v[80:83], v[192:195], a[8:11], v[80:83]
    s_barrier
    v_cvt_pk_bf16_f32 v32, v112, v113
    v_cvt_pk_bf16_f32 v33, v114, v115
    v_mfma_f32_16x16x32_bf16 v[88:91], v[192:195], a[12:15], v[88:91]
    ds_read_b64_tr_b16 v[176:177], v224 offset:45056
    v_cvt_pk_bf16_f32 v34, v116, v117
    v_mfma_f32_16x16x32_bf16 v[96:99], v[192:195], a[152:155], v[96:99]
    s_add_u32 s46, s58, 20480
    v_cvt_pk_bf16_f32 v35, v118, v119
    v_cvt_pk_bf16_f32 v36, v120, v121
    v_mfma_f32_16x16x32_bf16 v[104:107], v[192:195], a[156:159], v[104:107]
    ds_read_b64_tr_b16 v[178:179], v224 offset:47104
    v_cvt_pk_bf16_f32 v37, v122, v123
    v_mfma_f32_16x16x32_bf16 v[84:87], v[196:199], a[8:11], v[84:87]
    ds_read_b64_tr_b16 v[180:181], v225 offset:45056
    v_cvt_pk_bf16_f32 v38, v124, v125
    v_mfma_f32_16x16x32_bf16 v[92:95], v[196:199], a[12:15], v[92:95]
    s_add_u32 s47, s59, 20480
    v_cvt_pk_bf16_f32 v39, v126, v127
    v_cvt_pk_bf16_f32 v40, v128, v129
    v_mfma_f32_16x16x32_bf16 v[100:103], v[196:199], a[152:155], v[100:103]
    ds_read_b64_tr_b16 v[182:183], v225 offset:47104
    v_cvt_pk_bf16_f32 v41, v130, v131
    v_mfma_f32_16x16x32_bf16 v[108:111], v[196:199], a[156:159], v[108:111]
    s_waitcnt lgkmcnt(4)
    v_cvt_pk_bf16_f32 v42, v132, v133
    v_cvt_pk_bf16_f32 v43, v134, v135
    v_mfma_f32_16x16x32_bf16 v[80:83], v[208:211], a[16:19], v[80:83]
    ds_read_b64_tr_b16 v[192:193], v226 offset:61440
    v_cvt_pk_bf16_f32 v44, v136, v137
    v_mfma_f32_16x16x32_bf16 v[88:91], v[208:211], a[20:23], v[88:91]
    buffer_store_dwordx4 v[32:35], v236, s[48:51], s46 offen offset:0 sc1
    v_mfma_f32_16x16x32_bf16 v[96:99], v[208:211], a[160:163], v[96:99]
    ds_read_b64_tr_b16 v[194:195], v226 offset:63488
    v_cvt_pk_bf16_f32 v45, v138, v139
    v_mfma_f32_16x16x32_bf16 v[104:107], v[208:211], a[164:167], v[104:107]
    v_cvt_pk_bf16_f32 v46, v140, v141
    v_cvt_pk_bf16_f32 v47, v142, v143
    v_mfma_f32_16x16x32_bf16 v[84:87], v[212:215], a[16:19], v[84:87]
    ds_read_b64_tr_b16 v[196:197], v227 offset:61440
    v_mfma_f32_16x16x32_bf16 v[92:95], v[212:215], a[20:23], v[92:95]
    buffer_store_dwordx4 v[36:39], v236, s[48:51], s46 offen offset:256 sc1
    v_mfma_f32_16x16x32_bf16 v[100:103], v[212:215], a[160:163], v[100:103]
    ds_read_b64_tr_b16 v[198:199], v227 offset:63488
    v_mfma_f32_16x16x32_bf16 v[108:111], v[212:215], a[164:167], v[108:111]
    s_waitcnt lgkmcnt(4)
    v_mfma_f32_16x16x32_bf16 v[80:83], v[176:179], a[24:27], v[80:83]
    ds_read_b64_tr_b16 v[208:209], v226 offset:57344
    v_mfma_f32_16x16x32_bf16 v[88:91], v[176:179], a[28:31], v[88:91]
    buffer_store_dwordx4 v[40:43], v236, s[48:51], s47 offen offset:0 sc1
    v_mfma_f32_16x16x32_bf16 v[96:99], v[176:179], a[168:171], v[96:99]
    ds_read_b64_tr_b16 v[210:211], v226 offset:59392
    v_mfma_f32_16x16x32_bf16 v[104:107], v[176:179], a[172:175], v[104:107]
    v_mfma_f32_16x16x32_bf16 v[84:87], v[180:183], a[24:27], v[84:87]
    ds_read_b64_tr_b16 v[212:213], v227 offset:57344
    v_mfma_f32_16x16x32_bf16 v[92:95], v[180:183], a[28:31], v[92:95]
    buffer_store_dwordx4 v[44:47], v236, s[48:51], s47 offen offset:256 sc1
    v_mfma_f32_16x16x32_bf16 v[100:103], v[180:183], a[168:171], v[100:103]
    ds_read_b64_tr_b16 v[214:215], v227 offset:59392
    v_mfma_f32_16x16x32_bf16 v[108:111], v[180:183], a[172:175], v[108:111]
    s_waitcnt lgkmcnt(4)
    v_mfma_f32_16x16x32_bf16 v[80:83], v[192:195], a[32:35], v[80:83]
    ds_read_b64_tr_b16 v[176:177], v226 offset:53248
    v_mfma_f32_16x16x32_bf16 v[88:91], v[192:195], a[36:39], v[88:91]
    v_mfma_f32_16x16x32_bf16 v[96:99], v[192:195], a[176:179], v[96:99]
    ds_read_b64_tr_b16 v[178:179], v226 offset:55296
    v_mfma_f32_16x16x32_bf16 v[104:107], v[192:195], a[180:183], v[104:107]
    v_mfma_f32_16x16x32_bf16 v[84:87], v[196:199], a[32:35], v[84:87]
    ds_read_b64_tr_b16 v[180:181], v227 offset:53248
    v_mfma_f32_16x16x32_bf16 v[92:95], v[196:199], a[36:39], v[92:95]
    v_mfma_f32_16x16x32_bf16 v[100:103], v[196:199], a[176:179], v[100:103]
    ds_read_b64_tr_b16 v[182:183], v227 offset:55296
    v_mfma_f32_16x16x32_bf16 v[108:111], v[196:199], a[180:183], v[108:111]
    s_waitcnt lgkmcnt(4)
    v_mfma_f32_16x16x32_bf16 v[80:83], v[208:211], a[40:43], v[80:83]
    ds_read_b64_tr_b16 v[192:193], v226 offset:49152
    v_mfma_f32_16x16x32_bf16 v[88:91], v[208:211], a[44:47], v[88:91]
    v_mfma_f32_16x16x32_bf16 v[96:99], v[208:211], a[184:187], v[96:99]
    ds_read_b64_tr_b16 v[194:195], v226 offset:51200
    v_mfma_f32_16x16x32_bf16 v[104:107], v[208:211], a[188:191], v[104:107]
    v_mfma_f32_16x16x32_bf16 v[84:87], v[212:215], a[40:43], v[84:87]
    ds_read_b64_tr_b16 v[196:197], v227 offset:49152
    v_mfma_f32_16x16x32_bf16 v[92:95], v[212:215], a[44:47], v[92:95]
    v_mfma_f32_16x16x32_bf16 v[100:103], v[212:215], a[184:187], v[100:103]
    ds_read_b64_tr_b16 v[198:199], v227 offset:51200
    v_mfma_f32_16x16x32_bf16 v[108:111], v[212:215], a[188:191], v[108:111]
    s_waitcnt lgkmcnt(4)
    v_mfma_f32_16x16x32_bf16 v[80:83], v[176:179], a[48:51], v[80:83]
    ds_read_b64_tr_b16 v[208:209], v226 offset:20480
    v_mfma_f32_16x16x32_bf16 v[88:91], v[176:179], a[52:55], v[88:91]
    v_mfma_f32_16x16x32_bf16 v[96:99], v[176:179], a[192:195], v[96:99]
    ds_read_b64_tr_b16 v[210:211], v226 offset:22528
    v_mfma_f32_16x16x32_bf16 v[104:107], v[176:179], a[196:199], v[104:107]
    v_mfma_f32_16x16x32_bf16 v[84:87], v[180:183], a[48:51], v[84:87]
    ds_read_b64_tr_b16 v[212:213], v227 offset:20480
    v_mfma_f32_16x16x32_bf16 v[92:95], v[180:183], a[52:55], v[92:95]
    v_mfma_f32_16x16x32_bf16 v[100:103], v[180:183], a[192:195], v[100:103]
    ds_read_b64_tr_b16 v[214:215], v227 offset:22528
    v_mfma_f32_16x16x32_bf16 v[108:111], v[180:183], a[196:199], v[108:111]
    s_waitcnt lgkmcnt(4)
    v_mfma_f32_16x16x32_bf16 v[80:83], v[192:195], a[56:59], v[80:83]
    ds_read_b64_tr_b16 v[176:177], v226 offset:16384
    v_mfma_f32_16x16x32_bf16 v[88:91], v[192:195], a[60:63], v[88:91]
    v_mfma_f32_16x16x32_bf16 v[96:99], v[192:195], a[200:203], v[96:99]
    ds_read_b64_tr_b16 v[178:179], v226 offset:18432
    v_mfma_f32_16x16x32_bf16 v[104:107], v[192:195], a[204:207], v[104:107]
    v_mfma_f32_16x16x32_bf16 v[84:87], v[196:199], a[56:59], v[84:87]
    ds_read_b64_tr_b16 v[180:181], v227 offset:16384
    v_mfma_f32_16x16x32_bf16 v[92:95], v[196:199], a[60:63], v[92:95]
    v_mfma_f32_16x16x32_bf16 v[100:103], v[196:199], a[200:203], v[100:103]
    ds_read_b64_tr_b16 v[182:183], v227 offset:18432
    v_mfma_f32_16x16x32_bf16 v[108:111], v[196:199], a[204:207], v[108:111]
    s_waitcnt lgkmcnt(4)
    v_mfma_f32_16x16x32_bf16 v[80:83], v[208:211], a[64:67], v[80:83]
    ds_read_b64_tr_b16 v[192:193], v224 offset:40960
    v_mfma_f32_16x16x32_bf16 v[88:91], v[208:211], a[68:71], v[88:91]
    v_mfma_f32_16x16x32_bf16 v[96:99], v[208:211], a[208:211], v[96:99]
    ds_read_b64_tr_b16 v[194:195], v224 offset:43008
    v_mfma_f32_16x16x32_bf16 v[104:107], v[208:211], a[212:215], v[104:107]
    v_mfma_f32_16x16x32_bf16 v[84:87], v[212:215], a[64:67], v[84:87]
    ds_read_b64_tr_b16 v[196:197], v225 offset:40960
    v_mfma_f32_16x16x32_bf16 v[92:95], v[212:215], a[68:71], v[92:95]
    v_mfma_f32_16x16x32_bf16 v[100:103], v[212:215], a[208:211], v[100:103]
    ds_read_b64_tr_b16 v[198:199], v225 offset:43008
    v_mfma_f32_16x16x32_bf16 v[108:111], v[212:215], a[212:215], v[108:111]
    s_waitcnt lgkmcnt(4)
    v_mfma_f32_16x16x32_bf16 v[112:115], v[176:179], a[0:3], 0
    s_waitcnt vmcnt(16)
    v_mfma_f32_16x16x32_bf16 v[120:123], v[176:179], a[4:7], 0
    s_barrier
    v_mfma_f32_16x16x32_bf16 v[128:131], v[176:179], a[144:147], 0
    ds_read_b64_tr_b16 v[208:209], v224 offset:36864
    v_mfma_f32_16x16x32_bf16 v[136:139], v[176:179], a[148:151], 0
    v_mfma_f32_16x16x32_bf16 v[116:119], v[180:183], a[0:3], 0
    ds_read_b64_tr_b16 v[210:211], v224 offset:38912
    v_mfma_f32_16x16x32_bf16 v[124:127], v[180:183], a[4:7], 0
    ds_read_b64_tr_b16 v[212:213], v225 offset:36864
    v_mfma_f32_16x16x32_bf16 v[132:135], v[180:183], a[144:147], 0
    ds_read_b64_tr_b16 v[214:215], v225 offset:38912
    v_mfma_f32_16x16x32_bf16 v[140:143], v[180:183], a[148:151], 0
    s_waitcnt lgkmcnt(4)
    v_mfma_f32_16x16x32_bf16 v[112:115], v[192:195], a[8:11], v[112:115]
    ds_read_b64_tr_b16 v[176:177], v226 offset:45056
    v_cvt_pk_bf16_f32 v16, v80, v81
    v_mfma_f32_16x16x32_bf16 v[120:123], v[192:195], a[12:15], v[120:123]
    s_add_u32 s46, s58, 24576
    v_cvt_pk_bf16_f32 v17, v82, v83
    v_cvt_pk_bf16_f32 v18, v84, v85
    v_mfma_f32_16x16x32_bf16 v[128:131], v[192:195], a[152:155], v[128:131]
    ds_read_b64_tr_b16 v[178:179], v226 offset:47104
    v_cvt_pk_bf16_f32 v19, v86, v87
    v_mfma_f32_16x16x32_bf16 v[136:139], v[192:195], a[156:159], v[136:139]
    v_cvt_pk_bf16_f32 v20, v88, v89
    v_cvt_pk_bf16_f32 v21, v90, v91
    v_mfma_f32_16x16x32_bf16 v[116:119], v[196:199], a[8:11], v[116:119]
    ds_read_b64_tr_b16 v[180:181], v227 offset:45056
    v_cvt_pk_bf16_f32 v22, v92, v93
    v_mfma_f32_16x16x32_bf16 v[124:127], v[196:199], a[12:15], v[124:127]
    s_add_u32 s47, s59, 24576
    v_cvt_pk_bf16_f32 v23, v94, v95
    v_cvt_pk_bf16_f32 v24, v96, v97
    v_mfma_f32_16x16x32_bf16 v[132:135], v[196:199], a[152:155], v[132:135]
    ds_read_b64_tr_b16 v[182:183], v227 offset:47104
    v_cvt_pk_bf16_f32 v25, v98, v99
    v_mfma_f32_16x16x32_bf16 v[140:143], v[196:199], a[156:159], v[140:143]
    s_waitcnt lgkmcnt(4)
    v_cvt_pk_bf16_f32 v26, v100, v101
    v_cvt_pk_bf16_f32 v27, v102, v103
    v_mfma_f32_16x16x32_bf16 v[112:115], v[208:211], a[16:19], v[112:115]
    ds_read_b64_tr_b16 v[192:193], v226 offset:40960
    v_cvt_pk_bf16_f32 v28, v104, v105
    v_mfma_f32_16x16x32_bf16 v[120:123], v[208:211], a[20:23], v[120:123]
    buffer_store_dwordx4 v[16:19], v236, s[48:51], s46 offen offset:0 sc1
    v_mfma_f32_16x16x32_bf16 v[128:131], v[208:211], a[160:163], v[128:131]
    ds_read_b64_tr_b16 v[194:195], v226 offset:43008
    v_cvt_pk_bf16_f32 v29, v106, v107
    v_mfma_f32_16x16x32_bf16 v[136:139], v[208:211], a[164:167], v[136:139]
    v_cvt_pk_bf16_f32 v30, v108, v109
    v_cvt_pk_bf16_f32 v31, v110, v111
    v_mfma_f32_16x16x32_bf16 v[116:119], v[212:215], a[16:19], v[116:119]
    ds_read_b64_tr_b16 v[196:197], v227 offset:40960
    v_mfma_f32_16x16x32_bf16 v[124:127], v[212:215], a[20:23], v[124:127]
    buffer_store_dwordx4 v[20:23], v236, s[48:51], s46 offen offset:256 sc1
    v_mfma_f32_16x16x32_bf16 v[132:135], v[212:215], a[160:163], v[132:135]
    ds_read_b64_tr_b16 v[198:199], v227 offset:43008
    v_mfma_f32_16x16x32_bf16 v[140:143], v[212:215], a[164:167], v[140:143]
    s_waitcnt lgkmcnt(4)
    v_mfma_f32_16x16x32_bf16 v[112:115], v[176:179], a[24:27], v[112:115]
    ds_read_b64_tr_b16 v[208:209], v226 offset:36864
    v_mfma_f32_16x16x32_bf16 v[120:123], v[176:179], a[28:31], v[120:123]
    buffer_store_dwordx4 v[24:27], v236, s[48:51], s47 offen offset:0 sc1
    v_mfma_f32_16x16x32_bf16 v[128:131], v[176:179], a[168:171], v[128:131]
    ds_read_b64_tr_b16 v[210:211], v226 offset:38912
    v_mfma_f32_16x16x32_bf16 v[136:139], v[176:179], a[172:175], v[136:139]
    v_mfma_f32_16x16x32_bf16 v[116:119], v[180:183], a[24:27], v[116:119]
    ds_read_b64_tr_b16 v[212:213], v227 offset:36864
    v_mfma_f32_16x16x32_bf16 v[124:127], v[180:183], a[28:31], v[124:127]
    buffer_store_dwordx4 v[28:31], v236, s[48:51], s47 offen offset:256 sc1
    v_mfma_f32_16x16x32_bf16 v[132:135], v[180:183], a[168:171], v[132:135]
    ds_read_b64_tr_b16 v[214:215], v227 offset:38912
    v_mfma_f32_16x16x32_bf16 v[140:143], v[180:183], a[172:175], v[140:143]
    s_waitcnt lgkmcnt(4)
    v_mfma_f32_16x16x32_bf16 v[112:115], v[192:195], a[32:35], v[112:115]
    ds_read_b64_tr_b16 v[176:177], v226 offset:32768
    v_mfma_f32_16x16x32_bf16 v[120:123], v[192:195], a[36:39], v[120:123]
    v_mfma_f32_16x16x32_bf16 v[128:131], v[192:195], a[176:179], v[128:131]
    ds_read_b64_tr_b16 v[178:179], v226 offset:34816
    v_mfma_f32_16x16x32_bf16 v[136:139], v[192:195], a[180:183], v[136:139]
    v_mfma_f32_16x16x32_bf16 v[116:119], v[196:199], a[32:35], v[116:119]
    ds_read_b64_tr_b16 v[180:181], v227 offset:32768
    v_mfma_f32_16x16x32_bf16 v[124:127], v[196:199], a[36:39], v[124:127]
    v_mfma_f32_16x16x32_bf16 v[132:135], v[196:199], a[176:179], v[132:135]
    ds_read_b64_tr_b16 v[182:183], v227 offset:34816
    v_mfma_f32_16x16x32_bf16 v[140:143], v[196:199], a[180:183], v[140:143]
    s_waitcnt lgkmcnt(4)
    v_mfma_f32_16x16x32_bf16 v[112:115], v[208:211], a[40:43], v[112:115]
    s_waitcnt vmcnt(4)
    v_mfma_f32_16x16x32_bf16 v[120:123], v[208:211], a[44:47], v[120:123]
    s_barrier
    v_mfma_f32_16x16x32_bf16 v[128:131], v[208:211], a[184:187], v[128:131]
    s_cmp_lg_u32 s28, 0
    s_cbranch_scc1 K3_SA2
    s_mov_b64 exec, 1
    buffer_atomic_add v254, v250, s[60:63], s68 offen offset:256 sc1
    s_mov_b64 exec, -1
K3_SA2:
    v_mfma_f32_16x16x32_bf16 v[136:139], v[208:211], a[188:191], v[136:139]
    ds_read_b64_tr_b16 v[192:193], v226 offset:12288
    v_mfma_f32_16x16x32_bf16 v[116:119], v[212:215], a[40:43], v[116:119]
    ds_read_b64_tr_b16 v[194:195], v226 offset:14336
    v_mfma_f32_16x16x32_bf16 v[124:127], v[212:215], a[44:47], v[124:127]
    ds_read_b64_tr_b16 v[196:197], v227 offset:12288
    v_mfma_f32_16x16x32_bf16 v[132:135], v[212:215], a[184:187], v[132:135]
    ds_read_b64_tr_b16 v[198:199], v227 offset:14336
    v_mfma_f32_16x16x32_bf16 v[140:143], v[212:215], a[188:191], v[140:143]
    s_waitcnt lgkmcnt(4)
    v_mfma_f32_16x16x32_bf16 v[112:115], v[176:179], a[48:51], v[112:115]
    ds_read_b64_tr_b16 v[208:209], v226 offset:8192
    v_mfma_f32_16x16x32_bf16 v[120:123], v[176:179], a[52:55], v[120:123]
    v_mfma_f32_16x16x32_bf16 v[128:131], v[176:179], a[192:195], v[128:131]
    ds_read_b64_tr_b16 v[210:211], v226 offset:10240
    v_mfma_f32_16x16x32_bf16 v[136:139], v[176:179], a[196:199], v[136:139]
    v_mfma_f32_16x16x32_bf16 v[116:119], v[180:183], a[48:51], v[116:119]
    ds_read_b64_tr_b16 v[212:213], v227 offset:8192
    v_mfma_f32_16x16x32_bf16 v[124:127], v[180:183], a[52:55], v[124:127]
    v_mfma_f32_16x16x32_bf16 v[132:135], v[180:183], a[192:195], v[132:135]
    ds_read_b64_tr_b16 v[214:215], v227 offset:10240
    v_mfma_f32_16x16x32_bf16 v[140:143], v[180:183], a[196:199], v[140:143]
    s_waitcnt lgkmcnt(4)
    v_mfma_f32_16x16x32_bf16 v[112:115], v[192:195], a[56:59], v[112:115]
    ds_read_b64_tr_b16 v[176:177], v224 offset:32768
    v_mfma_f32_16x16x32_bf16 v[120:123], v[192:195], a[60:63], v[120:123]
    v_mfma_f32_16x16x32_bf16 v[128:131], v[192:195], a[200:203], v[128:131]
    ds_read_b64_tr_b16 v[178:179], v224 offset:34816
    v_mfma_f32_16x16x32_bf16 v[136:139], v[192:195], a[204:207], v[136:139]
    v_mfma_f32_16x16x32_bf16 v[116:119], v[196:199], a[56:59], v[116:119]
    ds_read_b64_tr_b16 v[180:181], v225 offset:32768
    v_mfma_f32_16x16x32_bf16 v[124:127], v[196:199], a[60:63], v[124:127]
    v_mfma_f32_16x16x32_bf16 v[132:135], v[196:199], a[200:203], v[132:135]
    ds_read_b64_tr_b16 v[182:183], v225 offset:34816
    v_mfma_f32_16x16x32_bf16 v[140:143], v[196:199], a[204:207], v[140:143]
    s_waitcnt lgkmcnt(4)
    v_mfma_f32_16x16x32_bf16 v[112:115], v[208:211], a[64:67], v[112:115]
    ds_read_b64_tr_b16 v[192:193], v224 offset:28672
    v_mfma_f32_16x16x32_bf16 v[120:123], v[208:211], a[68:71], v[120:123]
    v_mfma_f32_16x16x32_bf16 v[128:131], v[208:211], a[208:211], v[128:131]
    ds_read_b64_tr_b16 v[194:195], v224 offset:30720
    v_mfma_f32_16x16x32_bf16 v[136:139], v[208:211], a[212:215], v[136:139]
    v_mfma_f32_16x16x32_bf16 v[116:119], v[212:215], a[64:67], v[116:119]
    ds_read_b64_tr_b16 v[196:197], v225 offset:28672
    v_mfma_f32_16x16x32_bf16 v[124:127], v[212:215], a[68:71], v[124:127]
    v_mfma_f32_16x16x32_bf16 v[132:135], v[212:215], a[208:211], v[132:135]
    ds_read_b64_tr_b16 v[198:199], v225 offset:30720
    v_mfma_f32_16x16x32_bf16 v[140:143], v[212:215], a[212:215], v[140:143]
    s_waitcnt lgkmcnt(4)
    v_mfma_f32_16x16x32_bf16 v[80:83], v[176:179], a[0:3], 0
    ds_read_b64_tr_b16 v[208:209], v228 offset:28672
    v_mfma_f32_16x16x32_bf16 v[88:91], v[176:179], a[4:7], 0
    v_mfma_f32_16x16x32_bf16 v[96:99], v[176:179], a[144:147], 0
    ds_read_b64_tr_b16 v[210:211], v228 offset:30720
    v_mfma_f32_16x16x32_bf16 v[104:107], v[176:179], a[148:151], 0
    v_mfma_f32_16x16x32_bf16 v[84:87], v[180:183], a[0:3], 0
    ds_read_b64_tr_b16 v[212:213], v229 offset:28672
    v_mfma_f32_16x16x32_bf16 v[92:95], v[180:183], a[4:7], 0
    v_mfma_f32_16x16x32_bf16 v[100:103], v[180:183], a[144:147], 0
    ds_read_b64_tr_b16 v[214:215], v229 offset:30720
    v_mfma_f32_16x16x32_bf16 v[108:111], v[180:183], a[148:151], 0
    s_waitcnt lgkmcnt(4)
    v_mfma_f32_16x16x32_bf16 v[80:83], v[192:195], a[8:11], v[80:83]
    ds_read_b64_tr_b16 v[176:177], v228 offset:24576
    v_cvt_pk_bf16_f32 v32, v112, v113
    v_mfma_f32_16x16x32_bf16 v[88:91], v[192:195], a[12:15], v[88:91]
    s_add_u32 s46, s58, 28672
    v_cvt_pk_bf16_f32 v33, v114, v115
    v_cvt_pk_bf16_f32 v34, v116, v117
    v_mfma_f32_16x16x32_bf16 v[96:99], v[192:195], a[152:155], v[96:99]
    ds_read_b64_tr_b16 v[178:179], v228 offset:26624
    v_cvt_pk_bf16_f32 v35, v118, v119
    v_mfma_f32_16x16x32_bf16 v[104:107], v[192:195], a[156:159], v[104:107]
    v_cvt_pk_bf16_f32 v36, v120, v121
    v_cvt_pk_bf16_f32 v37, v122, v123
    v_mfma_f32_16x16x32_bf16 v[84:87], v[196:199], a[8:11], v[84:87]
    ds_read_b64_tr_b16 v[180:181], v229 offset:24576
    v_cvt_pk_bf16_f32 v38, v124, v125
    v_mfma_f32_16x16x32_bf16 v[92:95], v[196:199], a[12:15], v[92:95]
    s_add_u32 s47, s59, 28672
    v_cvt_pk_bf16_f32 v39, v126, v127
    v_cvt_pk_bf16_f32 v40, v128, v129
    v_mfma_f32_16x16x32_bf16 v[100:103], v[196:199], a[152:155], v[100:103]
    ds_read_b64_tr_b16 v[182:183], v229 offset:26624
    v_cvt_pk_bf16_f32 v41, v130, v131
    v_mfma_f32_16x16x32_bf16 v[108:111], v[196:199], a[156:159], v[108:111]
    s_waitcnt lgkmcnt(4)
    v_cvt_pk_bf16_f32 v42, v132, v133
    v_cvt_pk_bf16_f32 v43, v134, v135
    v_mfma_f32_16x16x32_bf16 v[80:83], v[208:211], a[16:19], v[80:83]
    ds_read_b64_tr_b16 v[192:193], v228 offset:20480
    v_cvt_pk_bf16_f32 v44, v136, v137
    v_mfma_f32_16x16x32_bf16 v[88:91], v[208:211], a[20:23], v[88:91]
    buffer_store_dwordx4 v[32:35], v236, s[48:51], s46 offen offset:0 sc1
    v_mfma_f32_16x16x32_bf16 v[96:99], v[208:211], a[160:163], v[96:99]
    ds_read_b64_tr_b16 v[194:195], v228 offset:22528
    v_cvt_pk_bf16_f32 v45, v138, v139
    v_mfma_f32_16x16x32_bf16 v[104:107], v[208:211], a[164:167], v[104:107]
    v_cvt_pk_bf16_f32 v46, v140, v141
    v_cvt_pk_bf16_f32 v47, v142, v143
    v_mfma_f32_16x16x32_bf16 v[84:87], v[212:215], a[16:19], v[84:87]
    ds_read_b64_tr_b16 v[196:197], v229 offset:20480
    v_mfma_f32_16x16x32_bf16 v[92:95], v[212:215], a[20:23], v[92:95]
    buffer_store_dwordx4 v[36:39], v236, s[48:51], s46 offen offset:256 sc1
    v_mfma_f32_16x16x32_bf16 v[100:103], v[212:215], a[160:163], v[100:103]
    ds_read_b64_tr_b16 v[198:199], v229 offset:22528
    v_mfma_f32_16x16x32_bf16 v[108:111], v[212:215], a[164:167], v[108:111]
    s_waitcnt lgkmcnt(4)
    v_mfma_f32_16x16x32_bf16 v[80:83], v[176:179], a[24:27], v[80:83]
    ds_read_b64_tr_b16 v[208:209], v228 offset:16384
    v_mfma_f32_16x16x32_bf16 v[88:91], v[176:179], a[28:31], v[88:91]
    buffer_store_dwordx4 v[40:43], v236, s[48:51], s47 offen offset:0 sc1
    v_mfma_f32_16x16x32_bf16 v[96:99], v[176:179], a[168:171], v[96:99]
    ds_read_b64_tr_b16 v[210:211], v228 offset:18432
    v_mfma_f32_16x16x32_bf16 v[104:107], v[176:179], a[172:175], v[104:107]
    v_mfma_f32_16x16x32_bf16 v[84:87], v[180:183], a[24:27], v[84:87]
    ds_read_b64_tr_b16 v[212:213], v229 offset:16384
    v_mfma_f32_16x16x32_bf16 v[92:95], v[180:183], a[28:31], v[92:95]
    buffer_store_dwordx4 v[44:47], v236, s[48:51], s47 offen offset:256 sc1
    v_mfma_f32_16x16x32_bf16 v[100:103], v[180:183], a[168:171], v[100:103]
    ds_read_b64_tr_b16 v[214:215], v229 offset:18432
    v_mfma_f32_16x16x32_bf16 v[108:111], v[180:183], a[172:175], v[108:111]
    s_waitcnt lgkmcnt(4)
    v_mfma_f32_16x16x32_bf16 v[80:83], v[192:195], a[32:35], v[80:83]
    s_barrier
    v_mfma_f32_16x16x32_bf16 v[88:91], v[192:195], a[36:39], v[88:91]
    v_mfma_f32_16x16x32_bf16 v[96:99], v[192:195], a[176:179], v[96:99]
    ds_read_b64_tr_b16 v[176:177], v226 offset:28672
    v_mfma_f32_16x16x32_bf16 v[104:107], v[192:195], a[180:183], v[104:107]
    ds_read_b64_tr_b16 v[178:179], v226 offset:30720
    v_mfma_f32_16x16x32_bf16 v[84:87], v[196:199], a[32:35], v[84:87]
    ds_read_b64_tr_b16 v[180:181], v227 offset:28672
    v_mfma_f32_16x16x32_bf16 v[92:95], v[196:199], a[36:39], v[92:95]
    v_mfma_f32_16x16x32_bf16 v[100:103], v[196:199], a[176:179], v[100:103]
    ds_read_b64_tr_b16 v[182:183], v227 offset:30720
    v_mfma_f32_16x16x32_bf16 v[108:111], v[196:199], a[180:183], v[108:111]
    s_waitcnt lgkmcnt(4)
    v_mfma_f32_16x16x32_bf16 v[80:83], v[208:211], a[40:43], v[80:83]
    ds_read_b64_tr_b16 v[192:193], v226 offset:24576
    v_mfma_f32_16x16x32_bf16 v[88:91], v[208:211], a[44:47], v[88:91]
    v_mfma_f32_16x16x32_bf16 v[96:99], v[208:211], a[184:187], v[96:99]
    ds_read_b64_tr_b16 v[194:195], v226 offset:26624
    v_mfma_f32_16x16x32_bf16 v[104:107], v[208:211], a[188:191], v[104:107]
    v_mfma_f32_16x16x32_bf16 v[84:87], v[212:215], a[40:43], v[84:87]
    ds_read_b64_tr_b16 v[196:197], v227 offset:24576
    v_mfma_f32_16x16x32_bf16 v[92:95], v[212:215], a[44:47], v[92:95]
    v_mfma_f32_16x16x32_bf16 v[100:103], v[212:215], a[184:187], v[100:103]
    ds_read_b64_tr_b16 v[198:199], v227 offset:26624
    v_mfma_f32_16x16x32_bf16 v[108:111], v[212:215], a[188:191], v[108:111]
    s_waitcnt lgkmcnt(4)
    v_mfma_f32_16x16x32_bf16 v[80:83], v[176:179], a[48:51], v[80:83]
    ds_read_b64_tr_b16 v[208:209], v226 offset:4096
    v_mfma_f32_16x16x32_bf16 v[88:91], v[176:179], a[52:55], v[88:91]
    v_mfma_f32_16x16x32_bf16 v[96:99], v[176:179], a[192:195], v[96:99]
    ds_read_b64_tr_b16 v[210:211], v226 offset:6144
    v_mfma_f32_16x16x32_bf16 v[104:107], v[176:179], a[196:199], v[104:107]
    v_mfma_f32_16x16x32_bf16 v[84:87], v[180:183], a[48:51], v[84:87]
    ds_read_b64_tr_b16 v[212:213], v227 offset:4096
    v_mfma_f32_16x16x32_bf16 v[92:95], v[180:183], a[52:55], v[92:95]
    v_mfma_f32_16x16x32_bf16 v[100:103], v[180:183], a[192:195], v[100:103]
    ds_read_b64_tr_b16 v[214:215], v227 offset:6144
    v_mfma_f32_16x16x32_bf16 v[108:111], v[180:183], a[196:199], v[108:111]
    s_waitcnt lgkmcnt(4)
    v_mfma_f32_16x16x32_bf16 v[80:83], v[192:195], a[56:59], v[80:83]
    v_mfma_f32_16x16x32_bf16 v[88:91], v[192:195], a[60:63], v[88:91]
    v_mfma_f32_16x16x32_bf16 v[96:99], v[192:195], a[200:203], v[96:99]
    v_mfma_f32_16x16x32_bf16 v[104:107], v[192:195], a[204:207], v[104:107]
    v_mfma_f32_16x16x32_bf16 v[84:87], v[196:199], a[56:59], v[84:87]
    v_mfma_f32_16x16x32_bf16 v[92:95], v[196:199], a[60:63], v[92:95]
    v_mfma_f32_16x16x32_bf16 v[100:103], v[196:199], a[200:203], v[100:103]
    v_mfma_f32_16x16x32_bf16 v[108:111], v[196:199], a[204:207], v[108:111]
    s_waitcnt lgkmcnt(0)
    v_mfma_f32_16x16x32_bf16 v[80:83], v[208:211], a[64:67], v[80:83]
    v_mfma_f32_16x16x32_bf16 v[88:91], v[208:211], a[68:71], v[88:91]
    v_mfma_f32_16x16x32_bf16 v[96:99], v[208:211], a[208:211], v[96:99]
    v_mfma_f32_16x16x32_bf16 v[104:107], v[208:211], a[212:215], v[104:107]
    v_mfma_f32_16x16x32_bf16 v[84:87], v[212:215], a[64:67], v[84:87]
    v_mfma_f32_16x16x32_bf16 v[92:95], v[212:215], a[68:71], v[92:95]
    v_mfma_f32_16x16x32_bf16 v[100:103], v[212:215], a[208:211], v[100:103]
    v_mfma_f32_16x16x32_bf16 v[108:111], v[212:215], a[212:215], v[108:111]
    buffer_load_dword v246, v250, s[60:63], s68 offen offset:0 sc0 sc1
    buffer_load_dword v247, v250, s[60:63], s68 offen offset:256 sc0 sc1
    s_nop 12
    s_add_u32 s46, s58, 32768
    v_cvt_pk_bf16_f32 v16, v80, v81
    v_cvt_pk_bf16_f32 v17, v82, v83
    v_cvt_pk_bf16_f32 v18, v84, v85
    v_cvt_pk_bf16_f32 v19, v86, v87
    buffer_store_dwordx4 v[16:19], v236, s[48:51], s46 offen offset:0 sc1
    v_cvt_pk_bf16_f32 v20, v88, v89
    v_cvt_pk_bf16_f32 v21, v90, v91
    v_cvt_pk_bf16_f32 v22, v92, v93
    v_cvt_pk_bf16_f32 v23, v94, v95
    buffer_store_dwordx4 v[20:23], v236, s[48:51], s46 offen offset:256 sc1
    s_add_u32 s47, s59, 32768
    v_cvt_pk_bf16_f32 v24, v96, v97
    v_cvt_pk_bf16_f32 v25, v98, v99
    v_cvt_pk_bf16_f32 v26, v100, v101
    v_cvt_pk_bf16_f32 v27, v102, v103
    buffer_store_dwordx4 v[24:27], v236, s[48:51], s47 offen offset:0 sc1
    v_cvt_pk_bf16_f32 v28, v104, v105
    v_cvt_pk_bf16_f32 v29, v106, v107
    v_cvt_pk_bf16_f32 v30, v108, v109
    v_cvt_pk_bf16_f32 v31, v110, v111
    buffer_store_dwordx4 v[28:31], v236, s[48:51], s47 offen offset:256 sc1
    s_mov_b32 s78, 0x00003f80
    s_mov_b32 s79, 0x3f800000
    v_and_b32 v228, 16, v252
    v_cmp_ne_u32 vcc, 0, v228
    s_waitcnt vmcnt(0)
    s_barrier
    s_cmp_lg_u32 s28, 0
    s_cbranch_scc1 K3_SB1
    s_mov_b64 exec, 1
    buffer_atomic_add v254, v250, s[60:63], s68 offen offset:128 sc1
    s_mov_b64 exec, -1
K3_SB1:
    v_readfirstlane_b32 s76, v246
    v_readfirstlane_b32 s77, v247
    s_cmp_ge_u32 s76, 16
    s_cbranch_scc1 K3_PA_ok
    s_mov_b32 s3, 0
K3_PA:
    buffer_load_dword v246, v250, s[60:63], s68 offen offset:0 sc0 sc1
    s_waitcnt vmcnt(0)
    v_readfirstlane_b32 s76, v246
    s_nop 0
    s_cmp_ge_u32 s76, 16
    s_cbranch_scc1 K3_PA_ok
    s_sleep 2
    s_add_u32 s3, s3, 1
    s_cmp_lt_u32 s3, 0x200000
    s_cbranch_scc1 K3_PA
K3_PA_ok:
    s_lshl_b32 s74, s28, 12
    s_add_u32 s74, s74, s69
    s_lshl_b32 s75, s28, 7
    s_add_u32 s75, s75, 5760
    buffer_load_dwordx4 v[80:83], v252, s[60:63], s75 offen
    s_add_u32 s75, s74, 9502720
    buffer_load_dwordx4 v[16:19], v251, s[60:63], s75 offen sc1
    s_add_u32 s75, s74, 11862016
    buffer_load_dwordx4 v[20:23], v251, s[60:63], s75 offen sc1
    s_add_u32 s75, s74, 14221312
    buffer_load_dwordx4 v[24:27], v251, s[60:63], s75 offen sc1
    s_add_u32 s75, s74, 16580608
    buffer_load_dwordx4 v[28:31], v251, s[60:63], s75 offen sc1
    s_add_u32 s75, s74, 18939904
    buffer_load_dwordx4 v[32:35], v251, s[60:63], s75 offen sc1
    s_add_u32 s75, s74, 21299200
    buffer_load_dwordx4 v[36:39], v251, s[60:63], s75 offen sc1
    s_add_u32 s75, s74, 23658496
    buffer_load_dwordx4 v[40:43], v251, s[60:63], s75 offen sc1
    s_add_u32 s75, s74, 26017792
    buffer_load_dwordx4 v[44:47], v251, s[60:63], s75 offen sc1
    s_add_u32 s75, s74, 28377088
    buffer_load_dwordx4 v[48:51], v251, s[60:63], s75 offen sc1
    s_add_u32 s75, s74, 30736384
    buffer_load_dwordx4 v[52:55], v251, s[60:63], s75 offen sc1
    s_add_u32 s75, s74, 33095680
    buffer_load_dwordx4 v[56:59], v251, s[60:63], s75 offen sc1
    s_add_u32 s75, s74, 35454976
    buffer_load_dwordx4 v[60:63], v251, s[60:63], s75 offen sc1
    s_add_u32 s75, s74, 37814272
    buffer_load_dwordx4 v[64:67], v251, s[60:63], s75 offen sc1
    s_add_u32 s75, s74, 40173568
    buffer_load_dwordx4 v[68:71], v251, s[60:63], s75 offen sc1
    s_add_u32 s75, s74, 42532864
    buffer_load_dwordx4 v[72:75], v251, s[60:63], s75 offen sc1
    s_add_u32 s75, s74, 44892160
    buffer_load_dwordx4 v[76:79], v251, s[60:63], s75 offen sc1
    s_cmp_ge_u32 s28, 1
    s_cbranch_scc1 K3_P23
    s_mov_b32 s3, 0
K3_PA2:
    buffer_load_dword v246, v250, s[60:63], s68 offen offset:256 sc0 sc1
    s_waitcnt vmcnt(0)
    v_readfirstlane_b32 s76, v246
    s_nop 0
    s_cmp_ge_u32 s76, 16
    s_cbranch_scc1 K3_PA2_ok
    s_sleep 2
    s_add_u32 s3, s3, 1
    s_cmp_lt_u32 s3, 0x200000
    s_cbranch_scc1 K3_PA2
K3_PA2_ok:
    s_lshl_b32 s74, s73, 12
    s_add_u32 s74, s74, s69
    s_lshl_b32 s75, s73, 7
    s_add_u32 s75, s75, 5760
    buffer_load_dwordx4 v[148:151], v252, s[60:63], s75 offen
    s_add_u32 s75, s74, 9502720
    buffer_load_dwordx4 v[84:87], v251, s[60:63], s75 offen sc1
    s_add_u32 s75, s74, 11862016
    buffer_load_dwordx4 v[88:91], v251, s[60:63], s75 offen sc1
    s_add_u32 s75, s74, 14221312
    buffer_load_dwordx4 v[92:95], v251, s[60:63], s75 offen sc1
    s_add_u32 s75, s74, 16580608
    buffer_load_dwordx4 v[96:99], v251, s[60:63], s75 offen sc1
    s_add_u32 s75, s74, 18939904
    buffer_load_dwordx4 v[100:103], v251, s[60:63], s75 offen sc1
    s_add_u32 s75, s74, 21299200
    buffer_load_dwordx4 v[104:107], v251, s[60:63], s75 offen sc1
    s_add_u32 s75, s74, 23658496
    buffer_load_dwordx4 v[108:111], v251, s[60:63], s75 offen sc1
    s_add_u32 s75, s74, 26017792
    buffer_load_dwordx4 v[112:115], v251, s[60:63], s75 offen sc1
    s_add_u32 s75, s74, 28377088
    buffer_load_dwordx4 v[116:119], v251, s[60:63], s75 offen sc1
    s_add_u32 s75, s74, 30736384
    buffer_load_dwordx4 v[120:123], v251, s[60:63], s75 offen sc1
    s_add_u32 s75, s74, 33095680
    buffer_load_dwordx4 v[124:127], v251, s[60:63], s75 offen sc1
    s_add_u32 s75, s74, 35454976
    buffer_load_dwordx4 v[128:131], v251, s[60:63], s75 offen sc1
    s_add_u32 s75, s74, 37814272
    buffer_load_dwordx4 v[132:135], v251, s[60:63], s75 offen sc1
    s_add_u32 s75, s74, 40173568
    buffer_load_dwordx4 v[136:139], v251, s[60:63], s75 offen sc1
    s_add_u32 s75, s74, 42532864
    buffer_load_dwordx4 v[140:143], v251, s[60:63], s75 offen sc1
    s_add_u32 s75, s74, 44892160
    buffer_load_dwordx4 v[144:147], v251, s[60:63], s75 offen sc1
    s_lshl_b32 s74, s72, 12
    s_add_u32 s74, s74, s69
    s_lshl_b32 s75, s72, 7
    s_add_u32 s75, s75, 5760
    buffer_load_dwordx4 v[216:219], v252, s[60:63], s75 offen
    s_add_u32 s75, s74, 9502720
    buffer_load_dwordx4 v[152:155], v251, s[60:63], s75 offen sc1
    s_add_u32 s75, s74, 11862016
    buffer_load_dwordx4 v[156:159], v251, s[60:63], s75 offen sc1
    s_add_u32 s75, s74, 14221312
    buffer_load_dwordx4 v[160:163], v251, s[60:63], s75 offen sc1
    s_add_u32 s75, s74, 16580608
    buffer_load_dwordx4 v[164:167], v251, s[60:63], s75 offen sc1
    s_add_u32 s75, s74, 18939904
    buffer_load_dwordx4 v[168:171], v251, s[60:63], s75 offen sc1
    s_add_u32 s75, s74, 21299200
    buffer_load_dwordx4 v[172:175], v251, s[60:63], s75 offen sc1
    s_add_u32 s75, s74, 23658496
    buffer_load_dwordx4 v[176:179], v251, s[60:63], s75 offen sc1
    s_add_u32 s75, s74, 26017792
    buffer_load_dwordx4 v[180:183], v251, s[60:63], s75 offen sc1
    s_add_u32 s75, s74, 28377088
    buffer_load_dwordx4 v[184:187], v251, s[60:63], s75 offen sc1
    s_add_u32 s75, s74, 30736384
    buffer_load_dwordx4 v[188:191], v251, s[60:63], s75 offen sc1
    s_add_u32 s75, s74, 33095680
    buffer_load_dwordx4 v[192:195], v251, s[60:63], s75 offen sc1
    s_add_u32 s75, s74, 35454976
    buffer_load_dwordx4 v[196:199], v251, s[60:63], s75 offen sc1
    s_add_u32 s75, s74, 37814272
    buffer_load_dwordx4 v[200:203], v251, s[60:63], s75 offen sc1
    s_add_u32 s75, s74, 40173568
    buffer_load_dwordx4 v[204:207], v251, s[60:63], s75 offen sc1
    s_add_u32 s75, s74, 42532864
    buffer_load_dwordx4 v[208:211], v251, s[60:63], s75 offen sc1
    s_add_u32 s75, s74, 44892160
    buffer_load_dwordx4 v[212:215], v251, s[60:63], s75 offen sc1
    s_waitcnt vmcnt(48)
    v_lshlrev_b32 v220, 16, v16
    v_and_b32 v221, 0xffff0000, v16
    v_lshlrev_b32 v222, 16, v17
    v_and_b32 v223, 0xffff0000, v17
    v_lshlrev_b32 v224, 16, v18
    v_and_b32 v225, 0xffff0000, v18
    v_lshlrev_b32 v226, 16, v19
    v_and_b32 v227, 0xffff0000, v19
    v_dot2c_f32_bf16 v220, s78, v20
    v_dot2c_f32_bf16 v221, s79, v20
    v_dot2c_f32_bf16 v222, s78, v21
    v_dot2c_f32_bf16 v223, s79, v21
    v_dot2c_f32_bf16 v224, s78, v22
    v_dot2c_f32_bf16 v225, s79, v22
    v_dot2c_f32_bf16 v226, s78, v23
    v_dot2c_f32_bf16 v227, s79, v23
    s_waitcnt vmcnt(46)
    v_dot2c_f32_bf16 v220, s78, v24
    v_dot2c_f32_bf16 v221, s79, v24
    v_dot2c_f32_bf16 v222, s78, v25
    v_dot2c_f32_bf16 v223, s79, v25
    v_dot2c_f32_bf16 v224, s78, v26
    v_dot2c_f32_bf16 v225, s79, v26
    v_dot2c_f32_bf16 v226, s78, v27
    v_dot2c_f32_bf16 v227, s79, v27
    v_dot2c_f32_bf16 v220, s78, v28
    v_dot2c_f32_bf16 v221, s79, v28
    v_dot2c_f32_bf16 v222, s78, v29
    v_dot2c_f32_bf16 v223, s79, v29
    v_dot2c_f32_bf16 v224, s78, v30
    v_dot2c_f32_bf16 v225, s79, v30
    v_dot2c_f32_bf16 v226, s78, v31
    v_dot2c_f32_bf16 v227, s79, v31
    s_waitcnt vmcnt(44)
    v_dot2c_f32_bf16 v220, s78, v32
    v_dot2c_f32_bf16 v221, s79, v32
    v_dot2c_f32_bf16 v222, s78, v33
    v_dot2c_f32_bf16 v223, s79, v33
    v_dot2c_f32_bf16 v224, s78, v34
    v_dot2c_f32_bf16 v225, s79, v34
    v_dot2c_f32_bf16 v226, s78, v35
    v_dot2c_f32_bf16 v227, s79, v35
    v_dot2c_f32_bf16 v220, s78, v36
    v_dot2c_f32_bf16 v221, s79, v36
    v_dot2c_f32_bf16 v222, s78, v37
    v_dot2c_f32_bf16 v223, s79, v37
    v_dot2c_f32_bf16 v224, s78, v38
    v_dot2c_f32_bf16 v225, s79, v38
    v_dot2c_f32_bf16 v226, s78, v39
    v_dot2c_f32_bf16 v227, s79, v39
    s_waitcnt vmcnt(42)
    v_dot2c_f32_bf16 v220, s78, v40
    v_dot2c_f32_bf16 v221, s79, v40
    v_dot2c_f32_bf16 v222, s78, v41
    v_dot2c_f32_bf16 v223, s79, v41
    v_dot2c_f32_bf16 v224, s78, v42
    v_dot2c_f32_bf16 v225, s79, v42
    v_dot2c_f32_bf16 v226, s78, v43
    v_dot2c_f32_bf16 v227, s79, v43
    v_dot2c_f32_bf16 v220, s78, v44
    v_dot2c_f32_bf16 v221, s79, v44
    v_dot2c_f32_bf16 v222, s78, v45
    v_dot2c_f32_bf16 v223, s79, v45
    v_dot2c_f32_bf16 v224, s78, v46
    v_dot2c_f32_bf16 v225, s79, v46
    v_dot2c_f32_bf16 v226, s78, v47
    v_dot2c_f32_bf16 v227, s79, v47
    s_waitcnt vmcnt(40)
    v_dot2c_f32_bf16 v220, s78, v48
    v_dot2c_f32_bf16 v221, s79, v48
    v_dot2c_f32_bf16 v222, s78, v49
    v_dot2c_f32_bf16 v223, s79, v49
    v_dot2c_f32_bf16 v224, s78, v50
    v_dot2c_f32_bf16 v225, s79, v50
    v_dot2c_f32_bf16 v226, s78, v51
    v_dot2c_f32_bf16 v227, s79, v51
    v_dot2c_f32_bf16 v220, s78, v52
    v_dot2c_f32_bf16 v221, s79, v52
    v_dot2c_f32_bf16 v222, s78, v53
    v_dot2c_f32_bf16 v223, s79, v53
    v_dot2c_f32_bf16 v224, s78, v54
    v_dot2c_f32_bf16 v225, s79, v54
    v_dot2c_f32_bf16 v226, s78, v55
    v_dot2c_f32_bf16 v227, s79, v55
    s_waitcnt vmcnt(38)
    v_dot2c_f32_bf16 v220, s78, v56
    v_dot2c_f32_bf16 v221, s79, v56
    v_dot2c_f32_bf16 v222, s78, v57
    v_dot2c_f32_bf16 v223, s79, v57
    v_dot2c_f32_bf16 v224, s78, v58
    v_dot2c_f32_bf16 v225, s79, v58
    v_dot2c_f32_bf16 v226, s78, v59
    v_dot2c_f32_bf16 v227, s79, v59
    v_dot2c_f32_bf16 v220, s78, v60
    v_dot2c_f32_bf16 v221, s79, v60
    v_dot2c_f32_bf16 v222, s78, v61
    v_dot2c_f32_bf16 v223, s79, v61
    v_dot2c_f32_bf16 v224, s78, v62
    v_dot2c_f32_bf16 v225, s79, v62
    v_dot2c_f32_bf16 v226, s78, v63
    v_dot2c_f32_bf16 v227, s79, v63
    s_waitcnt vmcnt(36)
    v_dot2c_f32_bf16 v220, s78, v64
    v_dot2c_f32_bf16 v221, s79, v64
    v_dot2c_f32_bf16 v222, s78, v65
    v_dot2c_f32_bf16 v223, s79, v65
    v_dot2c_f32_bf16 v224, s78, v66
    v_dot2c_f32_bf16 v225, s79, v66
    v_dot2c_f32_bf16 v226, s78, v67
    v_dot2c_f32_bf16 v227, s79, v67
    v_dot2c_f32_bf16 v220, s78, v68
    v_dot2c_f32_bf16 v221, s79, v68
    v_dot2c_f32_bf16 v222, s78, v69
    v_dot2c_f32_bf16 v223, s79, v69
    v_dot2c_f32_bf16 v224, s78, v70
    v_dot2c_f32_bf16 v225, s79, v70
    v_dot2c_f32_bf16 v226, s78, v71
    v_dot2c_f32_bf16 v227, s79, v71
    s_waitcnt vmcnt(34)
    v_dot2c_f32_bf16 v220, s78, v72
    v_dot2c_f32_bf16 v221, s79, v72
    v_dot2c_f32_bf16 v222, s78, v73
    v_dot2c_f32_bf16 v223, s79, v73
    v_dot2c_f32_bf16 v224, s78, v74
    v_dot2c_f32_bf16 v225, s79, v74
    v_dot2c_f32_bf16 v226, s78, v75
    v_dot2c_f32_bf16 v227, s79, v75
    v_dot2c_f32_bf16 v220, s78, v76
    v_dot2c_f32_bf16 v221, s79, v76
    v_dot2c_f32_bf16 v222, s78, v77
    v_dot2c_f32_bf16 v223, s79, v77
    v_dot2c_f32_bf16 v224, s78, v78
    v_dot2c_f32_bf16 v225, s79, v78
    v_dot2c_f32_bf16 v226, s78, v79
    v_dot2c_f32_bf16 v227, s79, v79
    v_lshlrev_b32 v16, 16, v4
    v_and_b32 v17, 0xffff0000, v4
    v_lshlrev_b32 v18, 16, v5
    v_and_b32 v19, 0xffff0000, v5
    v_lshlrev_b32 v20, 16, v6
    v_and_b32 v21, 0xffff0000, v6
    v_lshlrev_b32 v22, 16, v7
    v_and_b32 v23, 0xffff0000, v7
    v_lshlrev_b32 v32, 16, v80
    v_and_b32 v33, 0xffff0000, v80
    v_lshlrev_b32 v34, 16, v81
    v_and_b32 v35, 0xffff0000, v81
    v_lshlrev_b32 v36, 16, v82
    v_and_b32 v37, 0xffff0000, v82
    v_lshlrev_b32 v38, 16, v83
    v_and_b32 v39, 0xffff0000, v83
    v_cndmask_b32 v228, v220, v224, vcc
    v_cndmask_b32 v232, v224, v220, vcc
    v_cndmask_b32 v229, v221, v225, vcc
    v_cndmask_b32 v233, v225, v221, vcc
    v_cndmask_b32 v230, v222, v226, vcc
    v_cndmask_b32 v234, v226, v222, vcc
    v_cndmask_b32 v231, v223, v227, vcc
    v_cndmask_b32 v235, v227, v223, vcc
    v_pk_fma_f32 v[228:229], v[228:229], v[32:33], v[16:17]
    v_pk_fma_f32 v[230:231], v[230:231], v[34:35], v[18:19]
    v_pk_fma_f32 v[232:233], v[232:233], v[36:37], v[20:21]
    v_pk_fma_f32 v[234:235], v[234:235], v[38:39], v[22:23]
    v_cvt_pk_bf16_f32 v24, v228, v229
    v_cvt_pk_bf16_f32 v25, v230, v231
    v_cvt_pk_bf16_f32 v26, v232, v233
    v_cvt_pk_bf16_f32 v27, v234, v235
    s_lshl_b32 s75, s28, 7
    s_add_u32 s75, s75, s70
    buffer_store_dwordx4 v[24:27], v253, s[64:67], s75 offen sc1
    s_waitcnt vmcnt(32)
    v_lshlrev_b32 v220, 16, v84
    v_and_b32 v221, 0xffff0000, v84
    v_lshlrev_b32 v222, 16, v85
    v_and_b32 v223, 0xffff0000, v85
    v_lshlrev_b32 v224, 16, v86
    v_and_b32 v225, 0xffff0000, v86
    v_lshlrev_b32 v226, 16, v87
    v_and_b32 v227, 0xffff0000, v87
    v_dot2c_f32_bf16 v220, s78, v88
    v_dot2c_f32_bf16 v221, s79, v88
    v_dot2c_f32_bf16 v222, s78, v89
    v_dot2c_f32_bf16 v223, s79, v89
    v_dot2c_f32_bf16 v224, s78, v90
    v_dot2c_f32_bf16 v225, s79, v90
    v_dot2c_f32_bf16 v226, s78, v91
    v_dot2c_f32_bf16 v227, s79, v91
    s_waitcnt vmcnt(30)
    v_dot2c_f32_bf16 v220, s78, v92
    v_dot2c_f32_bf16 v221, s79, v92
    v_dot2c_f32_bf16 v222, s78, v93
    v_dot2c_f32_bf16 v223, s79, v93
    v_dot2c_f32_bf16 v224, s78, v94
    v_dot2c_f32_bf16 v225, s79, v94
    v_dot2c_f32_bf16 v226, s78, v95
    v_dot2c_f32_bf16 v227, s79, v95
    v_dot2c_f32_bf16 v220, s78, v96
    v_dot2c_f32_bf16 v221, s79, v96
    v_dot2c_f32_bf16 v222, s78, v97
    v_dot2c_f32_bf16 v223, s79, v97
    v_dot2c_f32_bf16 v224, s78, v98
    v_dot2c_f32_bf16 v225, s79, v98
    v_dot2c_f32_bf16 v226, s78, v99
    v_dot2c_f32_bf16 v227, s79, v99
    s_waitcnt vmcnt(28)
    v_dot2c_f32_bf16 v220, s78, v100
    v_dot2c_f32_bf16 v221, s79, v100
    v_dot2c_f32_bf16 v222, s78, v101
    v_dot2c_f32_bf16 v223, s79, v101
    v_dot2c_f32_bf16 v224, s78, v102
    v_dot2c_f32_bf16 v225, s79, v102
    v_dot2c_f32_bf16 v226, s78, v103
    v_dot2c_f32_bf16 v227, s79, v103
    v_dot2c_f32_bf16 v220, s78, v104
    v_dot2c_f32_bf16 v221, s79, v104
    v_dot2c_f32_bf16 v222, s78, v105
    v_dot2c_f32_bf16 v223, s79, v105
    v_dot2c_f32_bf16 v224, s78, v106
    v_dot2c_f32_bf16 v225, s79, v106
    v_dot2c_f32_bf16 v226, s78, v107
    v_dot2c_f32_bf16 v227, s79, v107
    s_waitcnt vmcnt(26)
    v_dot2c_f32_bf16 v220, s78, v108
    v_dot2c_f32_bf16 v221, s79, v108
    v_dot2c_f32_bf16 v222, s78, v109
    v_dot2c_f32_bf16 v223, s79, v109
    v_dot2c_f32_bf16 v224, s78, v110
    v_dot2c_f32_bf16 v225, s79, v110
    v_dot2c_f32_bf16 v226, s78, v111
    v_dot2c_f32_bf16 v227, s79, v111
    v_dot2c_f32_bf16 v220, s78, v112
    v_dot2c_f32_bf16 v221, s79, v112
    v_dot2c_f32_bf16 v222, s78, v113
    v_dot2c_f32_bf16 v223, s79, v113
    v_dot2c_f32_bf16 v224, s78, v114
    v_dot2c_f32_bf16 v225, s79, v114
    v_dot2c_f32_bf16 v226, s78, v115
    v_dot2c_f32_bf16 v227, s79, v115
    s_waitcnt vmcnt(24)
    v_dot2c_f32_bf16 v220, s78, v116
    v_dot2c_f32_bf16 v221, s79, v116
    v_dot2c_f32_bf16 v222, s78, v117
    v_dot2c_f32_bf16 v223, s79, v117
    v_dot2c_f32_bf16 v224, s78, v118
    v_dot2c_f32_bf16 v225, s79, v118
    v_dot2c_f32_bf16 v226, s78, v119
    v_dot2c_f32_bf16 v227, s79, v119
    v_dot2c_f32_bf16 v220, s78, v120
    v_dot2c_f32_bf16 v221, s79, v120
    v_dot2c_f32_bf16 v222, s78, v121
    v_dot2c_f32_bf16 v223, s79, v121
    v_dot2c_f32_bf16 v224, s78, v122
    v_dot2c_f32_bf16 v225, s79, v122
    v_dot2c_f32_bf16 v226, s78, v123
    v_dot2c_f32_bf16 v227, s79, v123
    s_waitcnt vmcnt(22)
    v_dot2c_f32_bf16 v220, s78, v124
    v_dot2c_f32_bf16 v221, s79, v124
    v_dot2c_f32_bf16 v222, s78, v125
    v_dot2c_f32_bf16 v223, s79, v125
    v_dot2c_f32_bf16 v224, s78, v126
    v_dot2c_f32_bf16 v225, s79, v126
    v_dot2c_f32_bf16 v226, s78, v127
    v_dot2c_f32_bf16 v227, s79, v127
    v_dot2c_f32_bf16 v220, s78, v128
    v_dot2c_f32_bf16 v221, s79, v128
    v_dot2c_f32_bf16 v222, s78, v129
    v_dot2c_f32_bf16 v223, s79, v129
    v_dot2c_f32_bf16 v224, s78, v130
    v_dot2c_f32_bf16 v225, s79, v130
    v_dot2c_f32_bf16 v226, s78, v131
    v_dot2c_f32_bf16 v227, s79, v131
    s_waitcnt vmcnt(20)
    v_dot2c_f32_bf16 v220, s78, v132
    v_dot2c_f32_bf16 v221, s79, v132
    v_dot2c_f32_bf16 v222, s78, v133
    v_dot2c_f32_bf16 v223, s79, v133
    v_dot2c_f32_bf16 v224, s78, v134
    v_dot2c_f32_bf16 v225, s79, v134
    v_dot2c_f32_bf16 v226, s78, v135
    v_dot2c_f32_bf16 v227, s79, v135
    v_dot2c_f32_bf16 v220, s78, v136
    v_dot2c_f32_bf16 v221, s79, v136
    v_dot2c_f32_bf16 v222, s78, v137
    v_dot2c_f32_bf16 v223, s79, v137
    v_dot2c_f32_bf16 v224, s78, v138
    v_dot2c_f32_bf16 v225, s79, v138
    v_dot2c_f32_bf16 v226, s78, v139
    v_dot2c_f32_bf16 v227, s79, v139
    s_waitcnt vmcnt(18)
    v_dot2c_f32_bf16 v220, s78, v140
    v_dot2c_f32_bf16 v221, s79, v140
    v_dot2c_f32_bf16 v222, s78, v141
    v_dot2c_f32_bf16 v223, s79, v141
    v_dot2c_f32_bf16 v224, s78, v142
    v_dot2c_f32_bf16 v225, s79, v142
    v_dot2c_f32_bf16 v226, s78, v143
    v_dot2c_f32_bf16 v227, s79, v143
    v_dot2c_f32_bf16 v220, s78, v144
    v_dot2c_f32_bf16 v221, s79, v144
    v_dot2c_f32_bf16 v222, s78, v145
    v_dot2c_f32_bf16 v223, s79, v145
    v_dot2c_f32_bf16 v224, s78, v146
    v_dot2c_f32_bf16 v225, s79, v146
    v_dot2c_f32_bf16 v226, s78, v147
    v_dot2c_f32_bf16 v227, s79, v147
    v_lshlrev_b32 v84, 16, v8
    v_and_b32 v85, 0xffff0000, v8
    v_lshlrev_b32 v86, 16, v9
    v_and_b32 v87, 0xffff0000, v9
    v_lshlrev_b32 v88, 16, v10
    v_and_b32 v89, 0xffff0000, v10
    v_lshlrev_b32 v90, 16, v11
    v_and_b32 v91, 0xffff0000, v11
    v_lshlrev_b32 v100, 16, v148
    v_and_b32 v101, 0xffff0000, v148
    v_lshlrev_b32 v102, 16, v149
    v_and_b32 v103, 0xffff0000, v149
    v_lshlrev_b32 v104, 16, v150
    v_and_b32 v105, 0xffff0000, v150
    v_lshlrev_b32 v106, 16, v151
    v_and_b32 v107, 0xffff0000, v151
    v_cndmask_b32 v228, v220, v224, vcc
    v_cndmask_b32 v232, v224, v220, vcc
    v_cndmask_b32 v229, v221, v225, vcc
    v_cndmask_b32 v233, v225, v221, vcc
    v_cndmask_b32 v230, v222, v226, vcc
    v_cndmask_b32 v234, v226, v222, vcc
    v_cndmask_b32 v231, v223, v227, vcc
    v_cndmask_b32 v235, v227, v223, vcc
    v_pk_fma_f32 v[228:229], v[228:229], v[100:101], v[84:85]
    v_pk_fma_f32 v[230:231], v[230:231], v[102:103], v[86:87]
    v_pk_fma_f32 v[232:233], v[232:233], v[104:105], v[88:89]
    v_pk_fma_f32 v[234:235], v[234:235], v[106:107], v[90:91]
    v_cvt_pk_bf16_f32 v92, v228, v229
    v_cvt_pk_bf16_f32 v93, v230, v231
    v_cvt_pk_bf16_f32 v94, v232, v233
    v_cvt_pk_bf16_f32 v95, v234, v235
    s_lshl_b32 s75, s73, 7
    s_add_u32 s75, s75, s70
    buffer_store_dwordx4 v[92:95], v253, s[64:67], s75 offen sc1
    s_waitcnt vmcnt(16)
    v_lshlrev_b32 v220, 16, v152
    v_and_b32 v221, 0xffff0000, v152
    v_lshlrev_b32 v222, 16, v153
    v_and_b32 v223, 0xffff0000, v153
    v_lshlrev_b32 v224, 16, v154
    v_and_b32 v225, 0xffff0000, v154
    v_lshlrev_b32 v226, 16, v155
    v_and_b32 v227, 0xffff0000, v155
    v_dot2c_f32_bf16 v220, s78, v156
    v_dot2c_f32_bf16 v221, s79, v156
    v_dot2c_f32_bf16 v222, s78, v157
    v_dot2c_f32_bf16 v223, s79, v157
    v_dot2c_f32_bf16 v224, s78, v158
    v_dot2c_f32_bf16 v225, s79, v158
    v_dot2c_f32_bf16 v226, s78, v159
    v_dot2c_f32_bf16 v227, s79, v159
    s_waitcnt vmcnt(14)
    v_dot2c_f32_bf16 v220, s78, v160
    v_dot2c_f32_bf16 v221, s79, v160
    v_dot2c_f32_bf16 v222, s78, v161
    v_dot2c_f32_bf16 v223, s79, v161
    v_dot2c_f32_bf16 v224, s78, v162
    v_dot2c_f32_bf16 v225, s79, v162
    v_dot2c_f32_bf16 v226, s78, v163
    v_dot2c_f32_bf16 v227, s79, v163
    v_dot2c_f32_bf16 v220, s78, v164
    v_dot2c_f32_bf16 v221, s79, v164
    v_dot2c_f32_bf16 v222, s78, v165
    v_dot2c_f32_bf16 v223, s79, v165
    v_dot2c_f32_bf16 v224, s78, v166
    v_dot2c_f32_bf16 v225, s79, v166
    v_dot2c_f32_bf16 v226, s78, v167
    v_dot2c_f32_bf16 v227, s79, v167
    s_waitcnt vmcnt(12)
    v_dot2c_f32_bf16 v220, s78, v168
    v_dot2c_f32_bf16 v221, s79, v168
    v_dot2c_f32_bf16 v222, s78, v169
    v_dot2c_f32_bf16 v223, s79, v169
    v_dot2c_f32_bf16 v224, s78, v170
    v_dot2c_f32_bf16 v225, s79, v170
    v_dot2c_f32_bf16 v226, s78, v171
    v_dot2c_f32_bf16 v227, s79, v171
    v_dot2c_f32_bf16 v220, s78, v172
    v_dot2c_f32_bf16 v221, s79, v172
    v_dot2c_f32_bf16 v222, s78, v173
    v_dot2c_f32_bf16 v223, s79, v173
    v_dot2c_f32_bf16 v224, s78, v174
    v_dot2c_f32_bf16 v225, s79, v174
    v_dot2c_f32_bf16 v226, s78, v175
    v_dot2c_f32_bf16 v227, s79, v175
    s_waitcnt vmcnt(10)
    v_dot2c_f32_bf16 v220, s78, v176
    v_dot2c_f32_bf16 v221, s79, v176
    v_dot2c_f32_bf16 v222, s78, v177
    v_dot2c_f32_bf16 v223, s79, v177
    v_dot2c_f32_bf16 v224, s78, v178
    v_dot2c_f32_bf16 v225, s79, v178
    v_dot2c_f32_bf16 v226, s78, v179
    v_dot2c_f32_bf16 v227, s79, v179
    v_dot2c_f32_bf16 v220, s78, v180
    v_dot2c_f32_bf16 v221, s79, v180
    v_dot2c_f32_bf16 v222, s78, v181
    v_dot2c_f32_bf16 v223, s79, v181
    v_dot2c_f32_bf16 v224, s78, v182
    v_dot2c_f32_bf16 v225, s79, v182
    v_dot2c_f32_bf16 v226, s78, v183
    v_dot2c_f32_bf16 v227, s79, v183
    s_waitcnt vmcnt(8)
    v_dot2c_f32_bf16 v220, s78, v184
    v_dot2c_f32_bf16 v221, s79, v184
    v_dot2c_f32_bf16 v222, s78, v185
    v_dot2c_f32_bf16 v223, s79, v185
    v_dot2c_f32_bf16 v224, s78, v186
    v_dot2c_f32_bf16 v225, s79, v186
    v_dot2c_f32_bf16 v226, s78, v187
    v_dot2c_f32_bf16 v227, s79, v187
    v_dot2c_f32_bf16 v220, s78, v188
    v_dot2c_f32_bf16 v221, s79, v188
    v_dot2c_f32_bf16 v222, s78, v189
    v_dot2c_f32_bf16 v223, s79, v189
    v_dot2c_f32_bf16 v224, s78, v190
    v_dot2c_f32_bf16 v225, s79, v190
    v_dot2c_f32_bf16 v226, s78, v191
    v_dot2c_f32_bf16 v227, s79, v191
    s_waitcnt vmcnt(6)
    v_dot2c_f32_bf16 v220, s78, v192
    v_dot2c_f32_bf16 v221, s79, v192
    v_dot2c_f32_bf16 v222, s78, v193
    v_dot2c_f32_bf16 v223, s79, v193
    v_dot2c_f32_bf16 v224, s78, v194
    v_dot2c_f32_bf16 v225, s79, v194
    v_dot2c_f32_bf16 v226, s78, v195
    v_dot2c_f32_bf16 v227, s79, v195
    v_dot2c_f32_bf16 v220, s78, v196
    v_dot2c_f32_bf16 v221, s79, v196
    v_dot2c_f32_bf16 v222, s78, v197
    v_dot2c_f32_bf16 v223, s79, v197
    v_dot2c_f32_bf16 v224, s78, v198
    v_dot2c_f32_bf16 v225, s79, v198
    v_dot2c_f32_bf16 v226, s78, v199
    v_dot2c_f32_bf16 v227, s79, v199
    s_waitcnt vmcnt(4)
    v_dot2c_f32_bf16 v220, s78, v200
    v_dot2c_f32_bf16 v221, s79, v200
    v_dot2c_f32_bf16 v222, s78, v201
    v_dot2c_f32_bf16 v223, s79, v201
    v_dot2c_f32_bf16 v224, s78, v202
    v_dot2c_f32_bf16 v225, s79, v202
    v_dot2c_f32_bf16 v226, s78, v203
    v_dot2c_f32_bf16 v227, s79, v203
    v_dot2c_f32_bf16 v220, s78, v204
    v_dot2c_f32_bf16 v221, s79, v204
    v_dot2c_f32_bf16 v222, s78, v205
    v_dot2c_f32_bf16 v223, s79, v205
    v_dot2c_f32_bf16 v224, s78, v206
    v_dot2c_f32_bf16 v225, s79, v206
    v_dot2c_f32_bf16 v226, s78, v207
    v_dot2c_f32_bf16 v227, s79, v207
    s_waitcnt vmcnt(2)
    v_dot2c_f32_bf16 v220, s78, v208
    v_dot2c_f32_bf16 v221, s79, v208
    v_dot2c_f32_bf16 v222, s78, v209
    v_dot2c_f32_bf16 v223, s79, v209
    v_dot2c_f32_bf16 v224, s78, v210
    v_dot2c_f32_bf16 v225, s79, v210
    v_dot2c_f32_bf16 v226, s78, v211
    v_dot2c_f32_bf16 v227, s79, v211
    v_dot2c_f32_bf16 v220, s78, v212
    v_dot2c_f32_bf16 v221, s79, v212
    v_dot2c_f32_bf16 v222, s78, v213
    v_dot2c_f32_bf16 v223, s79, v213
    v_dot2c_f32_bf16 v224, s78, v214
    v_dot2c_f32_bf16 v225, s79, v214
    v_dot2c_f32_bf16 v226, s78, v215
    v_dot2c_f32_bf16 v227, s79, v215
    v_lshlrev_b32 v152, 16, v12
    v_and_b32 v153, 0xffff0000, v12
    v_lshlrev_b32 v154, 16, v13
    v_and_b32 v155, 0xffff0000, v13
    v_lshlrev_b32 v156, 16, v14
    v_and_b32 v157, 0xffff0000, v14
    v_lshlrev_b32 v158, 16, v15
    v_and_b32 v159, 0xffff0000, v15
    v_lshlrev_b32 v168, 16, v216
    v_and_b32 v169, 0xffff0000, v216
    v_lshlrev_b32 v170, 16, v217
    v_and_b32 v171, 0xffff0000, v217
    v_lshlrev_b32 v172, 16, v218
    v_and_b32 v173, 0xffff0000, v218
    v_lshlrev_b32 v174, 16, v219
    v_and_b32 v175, 0xffff0000, v219
    v_cndmask_b32 v228, v220, v224, vcc
    v_cndmask_b32 v232, v224, v220, vcc
    v_cndmask_b32 v229, v221, v225, vcc
    v_cndmask_b32 v233, v225, v221, vcc
    v_cndmask_b32 v230, v222, v226, vcc
    v_cndmask_b32 v234, v226, v222, vcc
    v_cndmask_b32 v231, v223, v227, vcc
    v_cndmask_b32 v235, v227, v223, vcc
    v_pk_fma_f32 v[228:229], v[228:229], v[168:169], v[152:153]
    v_pk_fma_f32 v[230:231], v[230:231], v[170:171], v[154:155]
    v_pk_fma_f32 v[232:233], v[232:233], v[172:173], v[156:157]
    v_pk_fma_f32 v[234:235], v[234:235], v[174:175], v[158:159]
    v_cvt_pk_bf16_f32 v160, v228, v229
    v_cvt_pk_bf16_f32 v161, v230, v231
    v_cvt_pk_bf16_f32 v162, v232, v233
    v_cvt_pk_bf16_f32 v163, v234, v235
    s_lshl_b32 s75, s72, 7
    s_add_u32 s75, s75, s70
    buffer_store_dwordx4 v[160:163], v253, s[64:67], s75 offen sc1
    s_branch K3_FIN
K3_P23:
    s_mov_b32 s3, 0
K3_PB:
    buffer_load_dword v246, v250, s[60:63], s68 offen offset:128 sc0 sc1
    s_waitcnt vmcnt(0)
    v_readfirstlane_b32 s76, v246
    s_nop 0
    s_cmp_ge_u32 s76, 16
    s_cbranch_scc1 K3_PB_ok
    s_sleep 2
    s_add_u32 s3, s3, 1
    s_cmp_lt_u32 s3, 0x200000
    s_cbranch_scc1 K3_PB
K3_PB_ok:
    s_lshl_b32 s74, s73, 12
    s_add_u32 s74, s74, s69
    s_lshl_b32 s75, s73, 7
    s_add_u32 s75, s75, 5760
    buffer_load_dwordx4 v[148:151], v252, s[60:63], s75 offen
    s_add_u32 s75, s74, 9502720
    buffer_load_dwordx4 v[84:87], v251, s[60:63], s75 offen sc1
    s_add_u32 s75, s74, 11862016
    buffer_load_dwordx4 v[88:91], v251, s[60:63], s75 offen sc1
    s_add_u32 s75, s74, 14221312
    buffer_load_dwordx4 v[92:95], v251, s[60:63], s75 offen sc1
    s_add_u32 s75, s74, 16580608
    buffer_load_dwordx4 v[96:99], v251, s[60:63], s75 offen sc1
    s_add_u32 s75, s74, 18939904
    buffer_load_dwordx4 v[100:103], v251, s[60:63], s75 offen sc1
    s_add_u32 s75, s74, 21299200
    buffer_load_dwordx4 v[104:107], v251, s[60:63], s75 offen sc1
    s_add_u32 s75, s74, 23658496
    buffer_load_dwordx4 v[108:111], v251, s[60:63], s75 offen sc1
    s_add_u32 s75, s74, 26017792
    buffer_load_dwordx4 v[112:115], v251, s[60:63], s75 offen sc1
    s_add_u32 s75, s74, 28377088
    buffer_load_dwordx4 v[116:119], v251, s[60:63], s75 offen sc1
    s_add_u32 s75, s74, 30736384
    buffer_load_dwordx4 v[120:123], v251, s[60:63], s75 offen sc1
    s_add_u32 s75, s74, 33095680
    buffer_load_dwordx4 v[124:127], v251, s[60:63], s75 offen sc1
    s_add_u32 s75, s74, 35454976
    buffer_load_dwordx4 v[128:131], v251, s[60:63], s75 offen sc1
    s_add_u32 s75, s74, 37814272
    buffer_load_dwordx4 v[132:135], v251, s[60:63], s75 offen sc1
    s_add_u32 s75, s74, 40173568
    buffer_load_dwordx4 v[136:139], v251, s[60:63], s75 offen sc1
    s_add_u32 s75, s74, 42532864
    buffer_load_dwordx4 v[140:143], v251, s[60:63], s75 offen sc1
    s_add_u32 s75, s74, 44892160
    buffer_load_dwordx4 v[144:147], v251, s[60:63], s75 offen sc1
    v_lshlrev_b32 v220, 16, v16
    v_and_b32 v221, 0xffff0000, v16
    v_lshlrev_b32 v222, 16, v17
    v_and_b32 v223, 0xffff0000, v17
    v_lshlrev_b32 v224, 16, v18
    v_and_b32 v225, 0xffff0000, v18
    v_lshlrev_b32 v226, 16, v19
    v_and_b32 v227, 0xffff0000, v19
    v_dot2c_f32_bf16 v220, s78, v20
    v_dot2c_f32_bf16 v221, s79, v20
    v_dot2c_f32_bf16 v222, s78, v21
    v_dot2c_f32_bf16 v223, s79, v21
    v_dot2c_f32_bf16 v224, s78, v22
    v_dot2c_f32_bf16 v225, s79, v22
    v_dot2c_f32_bf16 v226, s78, v23
    v_dot2c_f32_bf16 v227, s79, v23
    v_dot2c_f32_bf16 v220, s78, v24
    v_dot2c_f32_bf16 v221, s79, v24
    v_dot2c_f32_bf16 v222, s78, v25
    v_dot2c_f32_bf16 v223, s79, v25
    v_dot2c_f32_bf16 v224, s78, v26
    v_dot2c_f32_bf16 v225, s79, v26
    v_dot2c_f32_bf16 v226, s78, v27
    v_dot2c_f32_bf16 v227, s79, v27
    v_dot2c_f32_bf16 v220, s78, v28
    v_dot2c_f32_bf16 v221, s79, v28
    v_dot2c_f32_bf16 v222, s78, v29
    v_dot2c_f32_bf16 v223, s79, v29
    v_dot2c_f32_bf16 v224, s78, v30
    v_dot2c_f32_bf16 v225, s79, v30
    v_dot2c_f32_bf16 v226, s78, v31
    v_dot2c_f32_bf16 v227, s79, v31
    v_dot2c_f32_bf16 v220, s78, v32
    v_dot2c_f32_bf16 v221, s79, v32
    v_dot2c_f32_bf16 v222, s78, v33
    v_dot2c_f32_bf16 v223, s79, v33
    v_dot2c_f32_bf16 v224, s78, v34
    v_dot2c_f32_bf16 v225, s79, v34
    v_dot2c_f32_bf16 v226, s78, v35
    v_dot2c_f32_bf16 v227, s79, v35
    v_dot2c_f32_bf16 v220, s78, v36
    v_dot2c_f32_bf16 v221, s79, v36
    v_dot2c_f32_bf16 v222, s78, v37
    v_dot2c_f32_bf16 v223, s79, v37
    v_dot2c_f32_bf16 v224, s78, v38
    v_dot2c_f32_bf16 v225, s79, v38
    v_dot2c_f32_bf16 v226, s78, v39
    v_dot2c_f32_bf16 v227, s79, v39
    v_dot2c_f32_bf16 v220, s78, v40
    v_dot2c_f32_bf16 v221, s79, v40
    v_dot2c_f32_bf16 v222, s78, v41
    v_dot2c_f32_bf16 v223, s79, v41
    v_dot2c_f32_bf16 v224, s78, v42
    v_dot2c_f32_bf16 v225, s79, v42
    v_dot2c_f32_bf16 v226, s78, v43
    v_dot2c_f32_bf16 v227, s79, v43
    v_dot2c_f32_bf16 v220, s78, v44
    v_dot2c_f32_bf16 v221, s79, v44
    v_dot2c_f32_bf16 v222, s78, v45
    v_dot2c_f32_bf16 v223, s79, v45
    v_dot2c_f32_bf16 v224, s78, v46
    v_dot2c_f32_bf16 v225, s79, v46
    v_dot2c_f32_bf16 v226, s78, v47
    v_dot2c_f32_bf16 v227, s79, v47
    v_dot2c_f32_bf16 v220, s78, v48
    v_dot2c_f32_bf16 v221, s79, v48
    v_dot2c_f32_bf16 v222, s78, v49
    v_dot2c_f32_bf16 v223, s79, v49
    v_dot2c_f32_bf16 v224, s78, v50
    v_dot2c_f32_bf16 v225, s79, v50
    v_dot2c_f32_bf16 v226, s78, v51
    v_dot2c_f32_bf16 v227, s79, v51
    v_dot2c_f32_bf16 v220, s78, v52
    v_dot2c_f32_bf16 v221, s79, v52
    v_dot2c_f32_bf16 v222, s78, v53
    v_dot2c_f32_bf16 v223, s79, v53
    v_dot2c_f32_bf16 v224, s78, v54
    v_dot2c_f32_bf16 v225, s79, v54
    v_dot2c_f32_bf16 v226, s78, v55
    v_dot2c_f32_bf16 v227, s79, v55
    v_dot2c_f32_bf16 v220, s78, v56
    v_dot2c_f32_bf16 v221, s79, v56
    v_dot2c_f32_bf16 v222, s78, v57
    v_dot2c_f32_bf16 v223, s79, v57
    v_dot2c_f32_bf16 v224, s78, v58
    v_dot2c_f32_bf16 v225, s79, v58
    v_dot2c_f32_bf16 v226, s78, v59
    v_dot2c_f32_bf16 v227, s79, v59
    v_dot2c_f32_bf16 v220, s78, v60
    v_dot2c_f32_bf16 v221, s79, v60
    v_dot2c_f32_bf16 v222, s78, v61
    v_dot2c_f32_bf16 v223, s79, v61
    v_dot2c_f32_bf16 v224, s78, v62
    v_dot2c_f32_bf16 v225, s79, v62
    v_dot2c_f32_bf16 v226, s78, v63
    v_dot2c_f32_bf16 v227, s79, v63
    v_dot2c_f32_bf16 v220, s78, v64
    v_dot2c_f32_bf16 v221, s79, v64
    v_dot2c_f32_bf16 v222, s78, v65
    v_dot2c_f32_bf16 v223, s79, v65
    v_dot2c_f32_bf16 v224, s78, v66
    v_dot2c_f32_bf16 v225, s79, v66
    v_dot2c_f32_bf16 v226, s78, v67
    v_dot2c_f32_bf16 v227, s79, v67
    v_dot2c_f32_bf16 v220, s78, v68
    v_dot2c_f32_bf16 v221, s79, v68
    v_dot2c_f32_bf16 v222, s78, v69
    v_dot2c_f32_bf16 v223, s79, v69
    v_dot2c_f32_bf16 v224, s78, v70
    v_dot2c_f32_bf16 v225, s79, v70
    v_dot2c_f32_bf16 v226, s78, v71
    v_dot2c_f32_bf16 v227, s79, v71
    v_dot2c_f32_bf16 v220, s78, v72
    v_dot2c_f32_bf16 v221, s79, v72
    v_dot2c_f32_bf16 v222, s78, v73
    v_dot2c_f32_bf16 v223, s79, v73
    v_dot2c_f32_bf16 v224, s78, v74
    v_dot2c_f32_bf16 v225, s79, v74
    v_dot2c_f32_bf16 v226, s78, v75
    v_dot2c_f32_bf16 v227, s79, v75
    v_dot2c_f32_bf16 v220, s78, v76
    v_dot2c_f32_bf16 v221, s79, v76
    v_dot2c_f32_bf16 v222, s78, v77
    v_dot2c_f32_bf16 v223, s79, v77
    v_dot2c_f32_bf16 v224, s78, v78
    v_dot2c_f32_bf16 v225, s79, v78
    v_dot2c_f32_bf16 v226, s78, v79
    v_dot2c_f32_bf16 v227, s79, v79
    v_lshlrev_b32 v16, 16, v4
    v_and_b32 v17, 0xffff0000, v4
    v_lshlrev_b32 v18, 16, v5
    v_and_b32 v19, 0xffff0000, v5
    v_lshlrev_b32 v20, 16, v6
    v_and_b32 v21, 0xffff0000, v6
    v_lshlrev_b32 v22, 16, v7
    v_and_b32 v23, 0xffff0000, v7
    v_lshlrev_b32 v32, 16, v80
    v_and_b32 v33, 0xffff0000, v80
    v_lshlrev_b32 v34, 16, v81
    v_and_b32 v35, 0xffff0000, v81
    v_lshlrev_b32 v36, 16, v82
    v_and_b32 v37, 0xffff0000, v82
    v_lshlrev_b32 v38, 16, v83
    v_and_b32 v39, 0xffff0000, v83
    v_cndmask_b32 v228, v220, v224, vcc
    v_cndmask_b32 v232, v224, v220, vcc
    v_cndmask_b32 v229, v221, v225, vcc
    v_cndmask_b32 v233, v225, v221, vcc
    v_cndmask_b32 v230, v222, v226, vcc
    v_cndmask_b32 v234, v226, v222, vcc
    v_cndmask_b32 v231, v223, v227, vcc
    v_cndmask_b32 v235, v227, v223, vcc
    v_pk_fma_f32 v[228:229], v[228:229], v[32:33], v[16:17]
    v_pk_fma_f32 v[230:231], v[230:231], v[34:35], v[18:19]
    v_pk_fma_f32 v[232:233], v[232:233], v[36:37], v[20:21]
    v_pk_fma_f32 v[234:235], v[234:235], v[38:39], v[22:23]
    v_cvt_pk_bf16_f32 v24, v228, v229
    v_cvt_pk_bf16_f32 v25, v230, v231
    v_cvt_pk_bf16_f32 v26, v232, v233
    v_cvt_pk_bf16_f32 v27, v234, v235
    s_lshl_b32 s75, s28, 7
    s_add_u32 s75, s75, s70
    buffer_store_dwordx4 v[24:27], v253, s[64:67], s75 offen sc1
    s_waitcnt vmcnt(15)
    v_lshlrev_b32 v220, 16, v84
    v_and_b32 v221, 0xffff0000, v84
    v_lshlrev_b32 v222, 16, v85
    v_and_b32 v223, 0xffff0000, v85
    v_lshlrev_b32 v224, 16, v86
    v_and_b32 v225, 0xffff0000, v86
    v_lshlrev_b32 v226, 16, v87
    v_and_b32 v227, 0xffff0000, v87
    v_dot2c_f32_bf16 v220, s78, v88
    v_dot2c_f32_bf16 v221, s79, v88
    v_dot2c_f32_bf16 v222, s78, v89
    v_dot2c_f32_bf16 v223, s79, v89
    v_dot2c_f32_bf16 v224, s78, v90
    v_dot2c_f32_bf16 v225, s79, v90
    v_dot2c_f32_bf16 v226, s78, v91
    v_dot2c_f32_bf16 v227, s79, v91
    s_waitcnt vmcnt(13)
    v_dot2c_f32_bf16 v220, s78, v92
    v_dot2c_f32_bf16 v221, s79, v92
    v_dot2c_f32_bf16 v222, s78, v93
    v_dot2c_f32_bf16 v223, s79, v93
    v_dot2c_f32_bf16 v224, s78, v94
    v_dot2c_f32_bf16 v225, s79, v94
    v_dot2c_f32_bf16 v226, s78, v95
    v_dot2c_f32_bf16 v227, s79, v95
    v_dot2c_f32_bf16 v220, s78, v96
    v_dot2c_f32_bf16 v221, s79, v96
    v_dot2c_f32_bf16 v222, s78, v97
    v_dot2c_f32_bf16 v223, s79, v97
    v_dot2c_f32_bf16 v224, s78, v98
    v_dot2c_f32_bf16 v225, s79, v98
    v_dot2c_f32_bf16 v226, s78, v99
    v_dot2c_f32_bf16 v227, s79, v99
    s_waitcnt vmcnt(11)
    v_dot2c_f32_bf16 v220, s78, v100
    v_dot2c_f32_bf16 v221, s79, v100
    v_dot2c_f32_bf16 v222, s78, v101
    v_dot2c_f32_bf16 v223, s79, v101
    v_dot2c_f32_bf16 v224, s78, v102
    v_dot2c_f32_bf16 v225, s79, v102
    v_dot2c_f32_bf16 v226, s78, v103
    v_dot2c_f32_bf16 v227, s79, v103
    v_dot2c_f32_bf16 v220, s78, v104
    v_dot2c_f32_bf16 v221, s79, v104
    v_dot2c_f32_bf16 v222, s78, v105
    v_dot2c_f32_bf16 v223, s79, v105
    v_dot2c_f32_bf16 v224, s78, v106
    v_dot2c_f32_bf16 v225, s79, v106
    v_dot2c_f32_bf16 v226, s78, v107
    v_dot2c_f32_bf16 v227, s79, v107
    s_waitcnt vmcnt(9)
    v_dot2c_f32_bf16 v220, s78, v108
    v_dot2c_f32_bf16 v221, s79, v108
    v_dot2c_f32_bf16 v222, s78, v109
    v_dot2c_f32_bf16 v223, s79, v109
    v_dot2c_f32_bf16 v224, s78, v110
    v_dot2c_f32_bf16 v225, s79, v110
    v_dot2c_f32_bf16 v226, s78, v111
    v_dot2c_f32_bf16 v227, s79, v111
    v_dot2c_f32_bf16 v220, s78, v112
    v_dot2c_f32_bf16 v221, s79, v112
    v_dot2c_f32_bf16 v222, s78, v113
    v_dot2c_f32_bf16 v223, s79, v113
    v_dot2c_f32_bf16 v224, s78, v114
    v_dot2c_f32_bf16 v225, s79, v114
    v_dot2c_f32_bf16 v226, s78, v115
    v_dot2c_f32_bf16 v227, s79, v115
    s_waitcnt vmcnt(7)
    v_dot2c_f32_bf16 v220, s78, v116
    v_dot2c_f32_bf16 v221, s79, v116
    v_dot2c_f32_bf16 v222, s78, v117
    v_dot2c_f32_bf16 v223, s79, v117
    v_dot2c_f32_bf16 v224, s78, v118
    v_dot2c_f32_bf16 v225, s79, v118
    v_dot2c_f32_bf16 v226, s78, v119
    v_dot2c_f32_bf16 v227, s79, v119
    v_dot2c_f32_bf16 v220, s78, v120
    v_dot2c_f32_bf16 v221, s79, v120
    v_dot2c_f32_bf16 v222, s78, v121
    v_dot2c_f32_bf16 v223, s79, v121
    v_dot2c_f32_bf16 v224, s78, v122
    v_dot2c_f32_bf16 v225, s79, v122
    v_dot2c_f32_bf16 v226, s78, v123
    v_dot2c_f32_bf16 v227, s79, v123
    s_waitcnt vmcnt(5)
    v_dot2c_f32_bf16 v220, s78, v124
    v_dot2c_f32_bf16 v221, s79, v124
    v_dot2c_f32_bf16 v222, s78, v125
    v_dot2c_f32_bf16 v223, s79, v125
    v_dot2c_f32_bf16 v224, s78, v126
    v_dot2c_f32_bf16 v225, s79, v126
    v_dot2c_f32_bf16 v226, s78, v127
    v_dot2c_f32_bf16 v227, s79, v127
    v_dot2c_f32_bf16 v220, s78, v128
    v_dot2c_f32_bf16 v221, s79, v128
    v_dot2c_f32_bf16 v222, s78, v129
    v_dot2c_f32_bf16 v223, s79, v129
    v_dot2c_f32_bf16 v224, s78, v130
    v_dot2c_f32_bf16 v225, s79, v130
    v_dot2c_f32_bf16 v226, s78, v131
    v_dot2c_f32_bf16 v227, s79, v131
    s_waitcnt vmcnt(3)
    v_dot2c_f32_bf16 v220, s78, v132
    v_dot2c_f32_bf16 v221, s79, v132
    v_dot2c_f32_bf16 v222, s78, v133
    v_dot2c_f32_bf16 v223, s79, v133
    v_dot2c_f32_bf16 v224, s78, v134
    v_dot2c_f32_bf16 v225, s79, v134
    v_dot2c_f32_bf16 v226, s78, v135
    v_dot2c_f32_bf16 v227, s79, v135
    v_dot2c_f32_bf16 v220, s78, v136
    v_dot2c_f32_bf16 v221, s79, v136
    v_dot2c_f32_bf16 v222, s78, v137
    v_dot2c_f32_bf16 v223, s79, v137
    v_dot2c_f32_bf16 v224, s78, v138
    v_dot2c_f32_bf16 v225, s79, v138
    v_dot2c_f32_bf16 v226, s78, v139
    v_dot2c_f32_bf16 v227, s79, v139
    s_waitcnt vmcnt(1)
    v_dot2c_f32_bf16 v220, s78, v140
    v_dot2c_f32_bf16 v221, s79, v140
    v_dot2c_f32_bf16 v222, s78, v141
    v_dot2c_f32_bf16 v223, s79, v141
    v_dot2c_f32_bf16 v224, s78, v142
    v_dot2c_f32_bf16 v225, s79, v142
    v_dot2c_f32_bf16 v226, s78, v143
    v_dot2c_f32_bf16 v227, s79, v143
    v_dot2c_f32_bf16 v220, s78, v144
    v_dot2c_f32_bf16 v221, s79, v144
    v_dot2c_f32_bf16 v222, s78, v145
    v_dot2c_f32_bf16 v223, s79, v145
    v_dot2c_f32_bf16 v224, s78, v146
    v_dot2c_f32_bf16 v225, s79, v146
    v_dot2c_f32_bf16 v226, s78, v147
    v_dot2c_f32_bf16 v227, s79, v147
    v_lshlrev_b32 v84, 16, v8
    v_and_b32 v85, 0xffff0000, v8
    v_lshlrev_b32 v86, 16, v9
    v_and_b32 v87, 0xffff0000, v9
    v_lshlrev_b32 v88, 16, v10
    v_and_b32 v89, 0xffff0000, v10
    v_lshlrev_b32 v90, 16, v11
    v_and_b32 v91, 0xffff0000, v11
    v_lshlrev_b32 v100, 16, v148
    v_and_b32 v101, 0xffff0000, v148
    v_lshlrev_b32 v102, 16, v149
    v_and_b32 v103, 0xffff0000, v149
    v_lshlrev_b32 v104, 16, v150
    v_and_b32 v105, 0xffff0000, v150
    v_lshlrev_b32 v106, 16, v151
    v_and_b32 v107, 0xffff0000, v151
    v_cndmask_b32 v228, v220, v224, vcc
    v_cndmask_b32 v232, v224, v220, vcc
    v_cndmask_b32 v229, v221, v225, vcc
    v_cndmask_b32 v233, v225, v221, vcc
    v_cndmask_b32 v230, v222, v226, vcc
    v_cndmask_b32 v234, v226, v222, vcc
    v_cndmask_b32 v231, v223, v227, vcc
    v_cndmask_b32 v235, v227, v223, vcc
    v_pk_fma_f32 v[228:229], v[228:229], v[100:101], v[84:85]
    v_pk_fma_f32 v[230:231], v[230:231], v[102:103], v[86:87]
    v_pk_fma_f32 v[232:233], v[232:233], v[104:105], v[88:89]
    v_pk_fma_f32 v[234:235], v[234:235], v[106:107], v[90:91]
    v_cvt_pk_bf16_f32 v92, v228, v229
    v_cvt_pk_bf16_f32 v93, v230, v231
    v_cvt_pk_bf16_f32 v94, v232, v233
    v_cvt_pk_bf16_f32 v95, v234, v235
    s_lshl_b32 s75, s73, 7
    s_add_u32 s75, s75, s70
    buffer_store_dwordx4 v[92:95], v253, s[64:67], s75 offen sc1
K3_FIN:
K3_END:
    s_endpgm
CODE_PF_END:
.section .rodata,"a"
.p2align 6
.amdhsa_kernel conv_kernel
  .amdhsa_next_free_vgpr 256
  .amdhsa_next_free_sgpr 80
  .amdhsa_accum_offset 128
  .amdhsa_group_segment_fixed_size 0
  .amdhsa_kernarg_size 120
  .amdhsa_user_sgpr_count 2
  .amdhsa_user_sgpr_kernarg_segment_ptr 1
  .amdhsa_system_sgpr_workgroup_id_x 1
  .amdhsa_float_denorm_mode_32 3
  .amdhsa_float_denorm_mode_16_64 3
.end_amdhsa_kernel
.p2align 6
.amdhsa_kernel mlp_kernel
  .amdhsa_next_free_vgpr 512
  .amdhsa_next_free_sgpr 80
  .amdhsa_accum_offset 256
  .amdhsa_group_segment_fixed_size 0
  .amdhsa_kernarg_size 120
  .amdhsa_user_sgpr_count 2
  .amdhsa_user_sgpr_kernarg_segment_ptr 1
  .amdhsa_system_sgpr_workgroup_id_x 1
  .amdhsa_float_denorm_mode_32 3
  .amdhsa_float_denorm_mode_16_64 3
.end_amdhsa_kernel
```
